```python
import torch

def _softmax(x, axis=-1):
    return torch.softmax(x, dim=axis)
def _gelu(x):
    return torch.nn.functional.gelu(x, approximate="tanh")
def _silu(x):
    return torch.nn.functional.silu(x)
def _sigmoid(x):
    return torch.sigmoid(x)
def _layernorm(x, axis=-1, eps=1e-5):
    m = x.mean(dim=axis, keepdim=True)
    v = x.var(dim=axis, keepdim=True, unbiased=False)
    return (x - m) / torch.sqrt(v + eps)
def _scatter_add(tgt, idx, src, axis=0):
    return tgt.clone().index_add_(axis, idx, src)
def _segment_sum(src, seg, n):
    out = torch.zeros((n,) + src.shape[1:], dtype=src.dtype)
    return out.index_add_(0, seg, src)
def _pad(x, pw):
    flat = tuple(v for pair in reversed(pw) for v in pair)
    return torch.nn.functional.pad(x, flat)

kernel_name = 'interleave_layers__ssm_conv_s4d__glu_gated_reglu__prompt'

def setup_inputs():

    _w = (lambda a: (lambda t: t.to(torch.bfloat16) if t.is_floating_point() else t)(torch.as_tensor(a)))
    def _A_setup():
        Bsz, L, D, N = 1, 2048, 512, 128
        return {
            "u": _w((lambda *s: torch.randn(*s, dtype=torch.bfloat16) * 0.05)(Bsz, L, D)),
            "log_A_real": _w((lambda *s: torch.randn(*s, dtype=torch.bfloat16) * 3.2)(D, N) * 0.5),
            "A_imag": _w((lambda *s: torch.randn(*s, dtype=torch.bfloat16) * 0.05)(D, N) * 3.14),
            "C_real": _w((lambda *s: torch.randn(*s, dtype=torch.bfloat16) * 0.05)(D, N) / N ** 0.5),
            "C_imag": _w((lambda *s: torch.randn(*s, dtype=torch.bfloat16) * 0.05)(D, N) / N ** 0.5),
            "log_dt": _w((lambda *s: torch.randn(*s, dtype=torch.bfloat16) * 0.05)(D) * 0.5 - 4.0),
            "D_skip": _w((lambda *s: torch.randn(*s, dtype=torch.bfloat16) * 0.05)(D)),
        }
    _A_in = _A_setup()

    def _B_setup():
        B, S, D, F = 1, 2048, 512, 1792
        return {
            "x": _w((lambda *s: torch.randn(*s, dtype=torch.bfloat16) * 0.05)(B, S, D)),
            "W_gate": _w((lambda *s: torch.randn(*s, dtype=torch.bfloat16) * 0.4)(D, F) * (2.0 / D) ** 0.5),
            "W_up": _w((lambda *s: torch.randn(*s, dtype=torch.bfloat16) * 0.4)(D, F) * (2.0 / D) ** 0.5),
            "W_down": _w((lambda *s: torch.randn(*s, dtype=torch.bfloat16) * 0.4)(F, D) * (1.0 / F) ** 0.5),
        }
    _B_in = _B_setup()

    return {
        "A_u": _A_in["u"],
        "A_log_A_real": _A_in["log_A_real"],
        "A_A_imag": _A_in["A_imag"],
        "A_C_real": _A_in["C_real"],
        "A_C_imag": _A_in["C_imag"],
        "A_log_dt": _A_in["log_dt"],
        "A_D_skip": _A_in["D_skip"],
        "B_x": _B_in["x"],
        "B_W_gate": _B_in["W_gate"],
        "B_W_up": _B_in["W_up"],
        "B_W_down": _B_in["W_down"],
    }

def reference(A_u, A_log_A_real, A_A_imag, A_C_real, A_C_imag, A_log_dt, A_D_skip, B_x, B_W_gate, B_W_up, B_W_down):
    def _A_ref(u, log_A_real, A_imag, C_real, C_imag, log_dt, D_skip):
        L = u.shape[1]
        dt = torch.exp(log_dt)
        A = -torch.exp(log_A_real) + 1j * A_imag
        C = (C_real + 1j * C_imag) * dt[:, None]
        pos = (lambda x, dt: x.to(dt))(torch.arange(L), log_dt.dtype)
        P = torch.exp((A * dt[:, None])[:, :, None] * pos[None, None, :])
        K = 2.0 * torch.einsum("dn,dnl->dl", C, P).real
        L2 = 2 * L
        u_t = (lambda x, *d: x.permute(*d))(u, 0, 2, 1)
        Kf = (lambda x, *a, **k: torch.fft.rfft(x.float(), *a, **k))(K, L2)
        Uf = (lambda x, *a, **k: torch.fft.rfft(x.float(), *a, **k))(u_t, L2)
        y = (lambda x, *a, **k: torch.fft.irfft(x, *a, **k).to(torch.bfloat16))(Uf * Kf[None, :, :], L2)[:, :, :L]
        y = (lambda x, *d: x.permute(*d))(y, 0, 2, 1)
        return y + u * D_skip[None, None, :]

    def _B_ref(x, W_gate, W_up, W_down):
        gate = torch.einsum("bsd,df->bsf", x, W_gate)
        up = torch.einsum("bsd,df->bsf", x, W_up)
        gate = gate * (lambda x, dt: x.to(dt))(gate > 0, gate.dtype)
        h = gate * up
        return torch.einsum("bsf,fd->bsd", h, W_down)

    x = A_u
    x = x + _A_ref(_layernorm(x, axis=-1), A_log_A_real, A_A_imag, A_C_real, A_C_imag, A_log_dt, A_D_skip)
    x = x + _B_ref(_layernorm(x, axis=-1), B_W_gate, B_W_up, B_W_down)
    x = x + _A_ref(_layernorm(x, axis=-1), A_log_A_real, A_A_imag, A_C_real, A_C_imag, A_log_dt, A_D_skip)
    x = x + _B_ref(_layernorm(x, axis=-1), B_W_gate, B_W_up, B_W_down)
    return x
```

```asm
; @launch grid=(256,1,1) block=(256,1,1) lds=161280
.amdgcn_target "amdgcn-amd-amdhsa--gfx950"
.text
.globl interleave_layers__ssm_conv_s4d__glu_gated_reglu__prompt_kernel
.p2align 8
.type interleave_layers__ssm_conv_s4d__glu_gated_reglu__prompt_kernel,@function
interleave_layers__ssm_conv_s4d__glu_gated_reglu__prompt_kernel:
s_cmp_ge_u32 s2, 256
s_cbranch_scc1 Lend
s_load_dwordx16 s[44:59], s[0:1], 0
s_load_dwordx8 s[64:71], s[0:1], 64
s_load_dwordx4 s[72:75], s[0:1], 96
v_and_b32 v1, 63, v0
v_lshrrev_b32 v40, 6, v0
s_nop 0
v_readfirstlane_b32 s28, v40
s_getpc_b64 s[96:97]
Lpc:
s_lshr_b32 s98, s2, 3
s_mul_i32 s98, s98, 20
v_mul_u32_u24 v41, 5, v40
v_add3_u32 v41, v41, v1, s98
v_lshlrev_b32 v41, 7, v41
v_min_u32 v41, Lcode_end-Lpc-4, v41
s_mov_b64 exec, 0x1f
global_load_dword v157, v41, s[96:97]
s_mov_b64 exec, -1
s_and_b32 s76, s2, 7
s_lshr_b32 s41, s2, 3
v_lshrrev_b32 v41, 5, v1
s_lshr_b32 s77, s41, 3
s_lshl_b32 s78, s76, 2
v_bfe_u32 v47, v1, 3, 1
s_add_u32 s77, s77, s78
s_and_b32 s78, s41, 7
s_lshl_b32 s79, s2, 2
v_bfe_u32 v48, v1, 1, 2
s_add_u32 s79, s79, s28
s_lshl_b32 s60, s77, 15
s_lshl_b32 s61, s78, 7
v_bfe_u32 v51, v1, 2, 2
s_add_u32 s42, s60, s61
s_lshl_b32 s62, s28, 5
v_and_b32 v40, 31, v1
s_add_u32 s60, s60, s62
v_lshl_add_u32 v47, v47, 2, v48
s_add_u32 s60, s42, s60
v_lshrrev_b32 v49, 4, v1
s_add_u32 s61, s60, 0x8000
s_lshl_b32 s62, s2, 9
s_lshl_b32 s63, s2, 2
s_lshl_b32 s100, s76, 5
v_and_b32 v50, 1, v1
s_add_u32 s100, s100, s41
v_lshl_add_u32 v51, v41, 2, v51
v_bfe_u32 v66, v1, 4, 1
v_and_b32 v67, 3, v1
s_lshl_b32 s81, s100, 2
v_lshlrev_b32 v42, 10, v40
v_lshrrev_b32 v44, 7, v0
v_mul_u32_u24 v31, 3584, v47
v_lshl_add_u32 v49, v49, 1, v50
v_lshlrev_b32 v46, 10, v51
v_lshl_add_u32 v66, v66, 2, v67
s_add_u32 s81, s81, s28
v_lshl_add_u32 v42, v41, 4, v42
v_lshlrev_b32 v43, 1, v0
v_lshlrev_b32 v44, 1, v44
v_lshlrev_b32 v22, 4, v1
v_lshl_add_u32 v31, v49, 4, v31
v_lshl_add_u32 v46, v66, 4, v46
s_lshl_b32 s81, s81, 11
s_waitcnt lgkmcnt(0)
s_mov_b32 s8, s74
s_mov_b32 s9, s75
s_mov_b32 s10, 268435456
s_mov_b32 s11, 0x20000
s_mov_b32 s4, s44
s_mov_b32 s5, s45
s_mov_b32 s6, 2097152
s_mov_b32 s7, 0x20000
v_mov_b32 v68, 0
v_mov_b32 v69, 0
v_mov_b32 v70, 0
v_mov_b32 v71, 0
v_mov_b32 v35, 1
v_mov_b32 v45, 0
s_cmp_lg_u32 s79, 0
s_cbranch_scc1 Lnoinit
s_mov_b32 s20, 262144
buffer_store_dwordx4 v[68:71], v22, s[8:11], s20 offen sc1
s_mov_b32 s20, 263168
buffer_store_dwordx4 v[68:71], v22, s[8:11], s20 offen sc1
s_mov_b32 s20, 264192
buffer_store_dwordx4 v[68:71], v22, s[8:11], s20 offen sc1
s_mov_b32 s20, 265216
buffer_store_dwordx4 v[68:71], v22, s[8:11], s20 offen sc1
s_mov_b32 s20, 266240
buffer_store_dwordx4 v[68:71], v22, s[8:11], s20 offen sc1
s_mov_b32 s20, 267264
buffer_store_dwordx4 v[68:71], v22, s[8:11], s20 offen sc1
s_mov_b32 s20, 268288
buffer_store_dwordx4 v[68:71], v22, s[8:11], s20 offen sc1
s_mov_b32 s20, 269312
buffer_store_dwordx4 v[68:71], v22, s[8:11], s20 offen sc1
Lnoinit:
buffer_load_dwordx4 v[52:55], v42, s[4:7], s60 offen
buffer_load_dwordx4 v[56:59], v42, s[4:7], s61 offen
buffer_load_dwordx4 v[112:115], v22, s[4:7], s81 offen offset:0
buffer_load_dwordx4 v[116:119], v22, s[4:7], s81 offen offset:1024
s_mov_b32 s20, s46
s_mov_b32 s21, s47
s_mov_b32 s22, 131072
s_mov_b32 s23, 0x20000
buffer_load_ushort v60, v43, s[20:23], s62 offen
s_mov_b32 s24, s48
s_mov_b32 s25, s49
s_mov_b32 s26, 131072
s_mov_b32 s27, 0x20000
buffer_load_ushort v61, v43, s[24:27], s62 offen
s_mov_b32 s20, s50
s_mov_b32 s21, s51
s_mov_b32 s22, 131072
s_mov_b32 s23, 0x20000
buffer_load_ushort v62, v43, s[20:23], s62 offen
s_mov_b32 s24, s52
s_mov_b32 s25, s53
s_mov_b32 s26, 131072
s_mov_b32 s27, 0x20000
buffer_load_ushort v63, v43, s[24:27], s62 offen
s_mov_b32 s20, s54
s_mov_b32 s21, s55
s_mov_b32 s22, 1024
s_mov_b32 s23, 0x20000
buffer_load_ushort v64, v44, s[20:23], s63 offen
s_mov_b32 s24, s56
s_mov_b32 s25, s57
s_mov_b32 s26, 1024
s_mov_b32 s27, 0x20000
buffer_load_ushort v5, v44, s[24:27], s63 offen
s_mov_b32 s12, s70
s_mov_b32 s13, s71
s_mov_b32 s14, 2097152
s_mov_b32 s15, 0x20000
s_mov_b32 s16, s72
s_mov_b32 s17, s73
s_mov_b32 s18, 256
s_mov_b32 s19, 0x20000
s_cmp_lt_u32 s28, 2
s_cselect_b32 s4, s64, s66
s_cselect_b32 s5, s65, s67
s_mov_b32 s6, 1835008
s_mov_b32 s20, s64
s_mov_b32 s21, s65
s_mov_b32 s22, 1835008
s_lshl_b32 s51, s2, 1
s_and_b32 s60, s28, 1
s_add_u32 s51, s51, s60
s_lshl_b32 s50, s60, 12
s_add_u32 s50, s50, 147968
s_cmp_ge_u32 s28, 2
s_cbranch_scc1 Lhi0
s_lshl_b32 s60, s51, 9
s_mov_b32 exec_hi, 0
buffer_store_dwordx4 v[68:71], v22, s[8:11], s60 offen sc1
s_mov_b64 exec, -1
s_branch Lhi1
Lhi0:
s_mov_b32 s24, s68
s_mov_b32 s25, s69
s_mov_b32 s26, 1835008
s_mov_b32 s27, 0x20000
s_sub_u32 s60, s51, 64
s_mul_hi_u32 s61, s60, 76695845
s_mul_i32 s62, s61, 56
s_sub_u32 s62, s60, s62
s_lshl_b32 s62, s62, 15
s_lshl_b32 s61, s61, 7
s_add_u32 s62, s62, s61
s_lshl_b32 s60, s60, 12
s_add_u32 s60, s60, 14680064
s_cmp_ge_u32 s51, 64
s_cselect_b32 s48, s62, 2130706432
s_cselect_b32 s49, s60, 2130706432
v_mul_u32_u24 v43, 37, v1
v_lshrrev_b32 v43, 8, v43
v_mul_u32_u24 v66, 7, v43
v_sub_u32 v66, v1, v66
v_mul_u32_u24 v43, 3584, v43
v_lshl_add_u32 v45, v66, 7, v43
s_lshl_b32 s60, s41, 1
s_and_b32 s61, s28, 1
s_add_u32 s60, s60, s61
s_mul_i32 s60, s60, 10752
s_lshr_b32 s61, s76, 1
s_mul_i32 s61, s61, 896
s_add_u32 s46, s60, s61
s_add_u32 m0, s50, 0
s_add_u32 s59, s48, 0
buffer_load_dwordx4 v46, s[24:27], s59 offen lds
s_add_u32 m0, s50, 1024
s_add_u32 s59, s48, 8192
buffer_load_dwordx4 v46, s[24:27], s59 offen lds
s_add_u32 m0, s50, 2048
s_add_u32 s59, s48, 16384
buffer_load_dwordx4 v46, s[24:27], s59 offen lds
s_add_u32 m0, s50, 3072
s_add_u32 s59, s48, 24576
buffer_load_dwordx4 v46, s[24:27], s59 offen lds
s_mov_b64 exec, 0x1fffff
buffer_load_dword v156, v45, s[20:23], s46 offen
buffer_load_dword v157, v45, s[4:7], s46 offen
s_mov_b64 exec, -1
Lhi1:
s_and_b32 s52, s76, 1
s_lshl_b32 s52, s52, 2
s_and_b32 s60, s41, 3
s_add_u32 s52, s52, s60
s_lshr_b32 s54, s76, 1
s_mul_i32 s53, s54, 7
s_lshr_b32 s60, s41, 2
s_add_u32 s53, s53, s60
s_lshr_b32 s55, s28, 1
s_lshl_b32 s29, s28, 10
s_add_u32 s29, s29, 62976
s_and_b32 s30, s28, 1
s_lshl_b32 s32, s2, 13
s_lshl_b32 s60, s55, 12
s_lshl_b32 s61, s30, 10
s_add_u32 s60, s60, s61
s_add_u32 s90, s60, s32
s_lshl_b32 s33, s52, 8
s_lshl_b32 s60, s28, 14
s_add_u32 s33, s33, s60
s_mul_i32 s34, s52, 448
s_lshl_b32 s60, s53, 2
s_add_u32 s60, s60, s28
s_add_u32 s34, s34, s60
s_lshl_b32 s34, s34, 10
s_mul_i32 s43, s30, 28672
s_lshl_b32 s61, s53, 7
s_add_u32 s43, s43, s61
s_mul_i32 s35, s77, 112
s_mul_i32 s60, s28, 28
s_add_u32 s35, s35, s60
s_lshl_b32 s35, s35, 10
s_mul_i32 s51, s78, 112
s_add_u32 s51, s51, s60
s_lshl_b32 s51, s51, 11
s_add_u32 s51, s51, 14680064
s_lshl_b32 s60, s55, 10
s_add_u32 s44, s51, s60
s_xor_b32 s60, s60, 1024
s_add_u32 s91, s51, s60
s_lshl_b32 s37, s78, 18
s_lshl_b32 s60, s77, 6
s_add_u32 s37, s37, s60
s_lshl_b32 s60, s28, 16
s_add_u32 s36, s37, s60
s_lshl_b32 s38, s77, 8
s_lshl_b32 s39, s52, 10
s_mul_i32 s40, s76, 2048
s_add_u32 s40, s40, 196608
s_mul_i32 s31, s52, 2048
s_mul_i32 s60, s54, 512
s_add_u32 s31, s31, s60
s_lshl_b32 s60, s28, 7
s_add_u32 s31, s31, s60
s_add_u32 s31, s31, 196608
s_lshl_b32 s60, s54, 6
s_lshl_b32 s61, s52, 8
s_add_u32 s60, s60, s61
s_lshl_b32 s61, s28, 19
s_add_u32 s45, s60, s61
s_cmp_ge_u32 s41, 28
s_cselect_b32 s33, s45, s33
s_cselect_b32 s34, 2063597568, s34
s_cselect_b32 s31, 2130706432, s31
s_cselect_b32 s60, 128, 0
s_sub_u32 s43, s43, s60
s_cmp_ge_u32 s41, 28
s_lshl_b32 s99, s53, 7
s_mul_i32 s95, s55, 128
s_add_u32 s95, s95, s29
s_cmp_ge_u32 s41, 28
s_cselect_b32 s99, 2130706432, s99
s_cmp_eq_u32 s28, 0
s_cselect_b32 s56, 0, 2130706432
s_cselect_b32 s57, 32, 0
s_cselect_b32 s101, 7, 0
s_add_u32 s40, s40, s56
s_lshl_b32 s84, s28, 11
s_xor_b32 s85, s84, 2048
s_add_u32 s84, s84, 153088
s_add_u32 s85, s85, 153088
s_mul_i32 s86, s28, 6144
s_add_u32 s86, s86, 33280
s_xor_b32 s60, s28, 1
s_mul_i32 s60, s60, 6144
s_add_u32 s87, s60, 33280
s_xor_b32 s60, s28, 2
s_mul_i32 s60, s60, 6144
s_add_u32 s88, s60, 35328
s_xor_b32 s60, s28, 3
s_mul_i32 s60, s60, 6144
s_add_u32 s89, s60, 37376
s_and_b32 s66, s76, 7
s_mul_i32 s66, s66, 8
s_and_b32 s65, s41, 7
s_mul_i32 s67, s55, 16640
s_lshl_b32 s62, s30, 10
s_sub_u32 s67, s67, s62
s_add_u32 s67, s67, 1080
s_mul_i32 s68, s55, 7680
s_mul_i32 s62, s30, 1280
s_sub_u32 s69, s68, s62
s_add_u32 s69, s69, 34640
s_mul_i32 s70, s55, 5120
s_add_u32 s70, s70, 48640
s_add_u32 s71, s70, s62
s_add_u32 s68, s68, 35840
s_lshl_b32 s72, s30, 4
s_lshl_b32 s73, s30, 5
s_lshl_b32 s74, s28, 10
s_mov_b32 s75, 122128
s_mov_b32 s81, 156430
v_bfe_u32 v84, v1, 4, 1
v_lshlrev_b32 v86, 3, v0
v_bfe_u32 v85, v1, 2, 2
v_lshl_add_u32 v48, v84, 1, v41
v_sub_u32 v86, 2047, v86
v_and_b32 v74, 3, v1
v_lshlrev_b32 v48, 10, v48
v_cvt_f32_i32 v87, v86
v_xor_b32 v76, s72, v1
v_lshl_add_u32 v48, v85, 5, v48
v_lshlrev_b32 v51, 9, v41
v_add_f32 v104, 0xc1000000, v87
v_lshl_add_u32 v48, v74, 3, v48
v_add_f32 v105, 0xc1100000, v87
v_add_f32 v108, 0xc1200000, v87
v_add_f32 v109, 0xc1300000, v87
v_lshlrev_b32 v30, 4, v76
v_sub_u32 v75, 3, v74
v_and_b32 v76, 28, v76
v_lshlrev_b32 v77, 3, v41
v_lshrrev_b32 v80, 2, v1
v_lshlrev_b32 v47, 10, v41
v_lshl_add_u32 v48, s28, 8, v48
v_lshl_add_u32 v51, v85, 6, v51
v_lshlrev_b32 v86, 1, v86
v_add_f32 v88, 0x80000000, v87
v_add_f32 v89, 0xbf800000, v87
v_add_f32 v92, 0xc0000000, v87
v_add_f32 v93, 0xc0400000, v87
v_add_f32 v96, 0xc0800000, v87
v_add_f32 v97, 0xc0a00000, v87
v_add_f32 v100, 0xc0c00000, v87
v_add_f32 v101, 0xc0e00000, v87
v_max_f32 v104, 0, v104
v_max_f32 v105, 0, v105
v_max_f32 v108, 0, v108
v_max_f32 v109, 0, v109
v_mul_u32_u24 v78, 80, v40
v_lshrrev_b32 v79, 4, v0
v_and_b32 v72, 7, v1
v_mul_u32_u24 v73, 8, v1
v_mul_u32_u24 v6, 4160, v75
v_sub_u32 v76, v77, v76
v_mul_u32_u24 v12, 80, v80
v_lshrrev_b32 v81, 7, v0
v_lshlrev_b32 v28, 8, v41
v_lshrrev_b32 v83, 2, v0
v_lshl_add_u32 v47, v40, 1, v47
v_lshrrev_b32 v138, 3, v1
v_mad_u32_u24 v48, v84, 64, v48
v_lshl_add_u32 v51, v84, 5, v51
v_add_u32 v86, 156176, v86
v_cvt_pk_bf16_f32 v88, v88, v89
v_cvt_pk_bf16_f32 v92, v92, v93
v_cvt_pk_bf16_f32 v96, v96, v97
v_cvt_pk_bf16_f32 v100, v100, v101
v_cvt_pk_bf16_f32 v104, v104, v105
v_cvt_pk_bf16_f32 v108, v108, v109
v_lshl_add_u32 v7, v41, 4, v78
v_mul_u32_u24 v8, 80, v79
v_add_u32 v72, s66, v72
v_add_u32 v73, s65, v73
v_and_b32 v4, 15, v1
v_lshl_add_u32 v6, v76, 1, v6
v_add3_u32 v78, v78, v77, s73
v_and_b32 v79, 15, v0
v_lshl_add_u32 v12, v74, 4, v12
v_mul_u32_u24 v81, 7680, v81
v_and_b32 v82, 127, v0
v_lshlrev_b32 v23, 3, v40
v_lshl_add_u32 v28, v40, 1, v28
v_lshlrev_b32 v29, 12, v83
v_lshl_add_u32 v47, s28, 11, v47
v_lshlrev_b32 v138, 12, v138
v_and_b32 v139, 7, v0
v_lshl_add_u32 v49, s28, 12, v22
v_mad_u32_u24 v48, v84, 64, v48
v_lshl_add_u32 v51, v74, 3, v51
v_mad_u32_u16 v90, v88, 2, s75
v_subrev_u32 v140, 0, v86
v_mad_u32_u16 v91, v88, 2, s75 op_sel:[1,0,0,0]
v_subrev_u32 v141, 2, v86
v_mad_u32_u16 v94, v92, 2, s75
v_subrev_u32 v142, 4, v86
v_mad_u32_u16 v95, v92, 2, s75 op_sel:[1,0,0,0]
v_subrev_u32 v143, 6, v86
v_mad_u32_u16 v98, v96, 2, s75
v_subrev_u32 v144, 8, v86
v_mad_u32_u16 v99, v96, 2, s75 op_sel:[1,0,0,0]
v_subrev_u32 v145, 10, v86
v_mad_u32_u16 v102, v100, 2, s75
v_subrev_u32 v146, 12, v86
v_mad_u32_u16 v103, v100, 2, s75 op_sel:[1,0,0,0]
v_subrev_u32 v147, 14, v86
v_mad_u32_u16 v106, v104, 2, s75
v_subrev_u32 v148, 16, v86
v_mad_u32_u16 v107, v104, 2, s75 op_sel:[1,0,0,0]
v_subrev_u32 v149, 18, v86
v_mad_u32_u16 v110, v108, 2, s75
v_subrev_u32 v150, 20, v86
v_mul_u32_u24 v2, 128, v72
v_mul_u32_u24 v3, 128, v73
v_lshlrev_b32 v4, 7, v4
v_lshlrev_b32 v10, 2, v0
v_lshlrev_b32 v9, 4, v0
v_add_u32 v6, s67, v6
v_add_u32 v7, s69, v7
v_add_u32 v33, s70, v78
v_add_u32 v11, s68, v78
v_lshl_add_u32 v8, v79, 2, v8
v_add_u32 v12, s71, v12
v_lshl_add_u32 v36, v82, 4, v81
v_lshl_add_u32 v37, v40, 4, v81
v_lshl_add_u32 v27, v41, 2, v23
v_add_u32 v28, s74, v28
v_lshl_add_u32 v29, v74, 4, v29
v_add_u32 v47, 96256, v47
v_lshl_add_u32 v138, v139, 4, v138
v_add_u32 v49, 96256, v49
v_add_u32 v50, 96256, v22
v_add_u32 v158, 62976, v48
v_add_u32 v159, 101376, v48
v_add_u32 v137, s50, v51
v_med3_i32 v140, v90, v140, s81
v_med3_i32 v141, v91, v141, s81
v_med3_i32 v142, v94, v142, s81
v_med3_i32 v143, v95, v143, s81
v_med3_i32 v144, v98, v144, s81
v_med3_i32 v145, v99, v145, s81
v_med3_i32 v146, v102, v146, s81
v_med3_i32 v147, v103, v147, s81
v_med3_i32 v148, v106, v148, s81
v_med3_i32 v149, v107, v149, s81
v_med3_i32 v150, v110, v150, s81
s_cmp_lg_u32 s79, 0
s_cbranch_scc1 Lfl
s_waitcnt vmcnt(11)
s_mov_b64 exec, 1
buffer_store_dword v35, v68, s[16:19], 0 offen sc1
s_mov_b64 exec, -1
Lfl:
s_waitcnt vmcnt(6)
s_cmp_ge_u32 s28, 2
s_cbranch_scc1 Lrw_1
s_waitcnt vmcnt(1)
Lrw_1:
ds_write_b16 v47, v52 offset:0
ds_write_b16_d16_hi v47, v52 offset:128
ds_write_b16 v47, v53 offset:256
ds_write_b16_d16_hi v47, v53 offset:384
ds_write_b16 v47, v54 offset:512
ds_write_b16_d16_hi v47, v54 offset:640
ds_write_b16 v47, v55 offset:768
ds_write_b16_d16_hi v47, v55 offset:896
ds_write_b16 v47, v56 offset:64
ds_write_b16_d16_hi v47, v56 offset:192
ds_write_b16 v47, v57 offset:320
ds_write_b16_d16_hi v47, v57 offset:448
ds_write_b16 v47, v58 offset:576
ds_write_b16_d16_hi v47, v58 offset:704
ds_write_b16 v47, v59 offset:832
ds_write_b16_d16_hi v47, v59 offset:960
s_mov_b32 s62, 0x3f803f80
v_dot2_f32_bf16 v120, v112, s62, 0
v_dot2_f32_bf16 v122, v116, s62, 0
v_dot2_f32_bf16 v121, v112, v112, 0
v_dot2_f32_bf16 v123, v116, v116, 0
v_dot2_f32_bf16 v120, v113, s62, v120
v_dot2_f32_bf16 v122, v117, s62, v122
v_dot2_f32_bf16 v121, v113, v113, v121
v_dot2_f32_bf16 v123, v117, v117, v123
v_dot2_f32_bf16 v120, v114, s62, v120
v_dot2_f32_bf16 v122, v118, s62, v122
v_dot2_f32_bf16 v121, v114, v114, v121
v_dot2_f32_bf16 v123, v118, v118, v123
v_dot2_f32_bf16 v120, v115, s62, v120
v_dot2_f32_bf16 v122, v119, s62, v122
v_dot2_f32_bf16 v121, v115, v115, v121
v_dot2_f32_bf16 v123, v119, v119, v123
s_nop 1
v_permlane32_swap_b32 v120, v121
v_permlane32_swap_b32 v122, v123
v_add_f32 v120, v120, v121
v_add_f32 v122, v122, v123
v_lshrrev_b32 v124, 4, v1
s_nop 0
v_permlane16_swap_b32 v120, v122
v_add_f32 v120, v120, v122
v_and_b32 v125, 1, v124
v_lshrrev_b32 v124, 1, v124
v_add_f32_dpp v120, v120, v120 row_ror:8 row_mask:0xf bank_mask:0xf
v_lshlrev_b32 v125, 3, v125
v_lshl_add_u32 v125, v124, 2, v125
v_add_f32_dpp v120, v120, v120 row_ror:4 row_mask:0xf bank_mask:0xf
s_lshl_b32 s60, s28, 4
s_add_u32 s60, s60, 96256
v_add_u32 v125, s60, v125
v_add_f32_dpp v120, v120, v120 row_ror:2 row_mask:0xf bank_mask:0xf
s_nop 1
v_add_f32_dpp v120, v120, v120 row_ror:1 row_mask:0xf bank_mask:0xf
ds_write_b32 v125, v120 offset:8192
s_waitcnt lgkmcnt(0)
s_barrier
s_cmp_ge_u32 s28, 2
s_cbranch_scc1 Lhi2
ds_read_b128 v[72:75], v49 offset:0
ds_read_b128 v[76:79], v49 offset:1024
ds_read_b128 v[80:83], v49 offset:2048
ds_read_b128 v[84:87], v49 offset:3072
ds_read_b128 v[104:107], v50 offset:8192
s_lshl_b32 s61, s77, 6
s_add_u32 s60, s37, s61
s_lshl_b32 s61, s28, 17
s_add_u32 s60, s60, s61
s_add_u32 s60, s60, 2097152
s_lshl_b32 s62, s100, 6
s_add_u32 s62, s62, 294912
s_waitcnt lgkmcnt(4)
buffer_store_dwordx4 v[72:75], v138, s[8:11], s60 offen sc1
s_add_u32 s60, s60, 32768
s_waitcnt lgkmcnt(3)
buffer_store_dwordx4 v[76:79], v138, s[8:11], s60 offen sc1
s_add_u32 s60, s60, 32768
s_waitcnt lgkmcnt(2)
buffer_store_dwordx4 v[80:83], v138, s[8:11], s60 offen sc1
s_add_u32 s60, s60, 32768
s_waitcnt lgkmcnt(0)
buffer_store_dwordx4 v[84:87], v138, s[8:11], s60 offen sc1
s_add_u32 s60, s60, 32768
s_cmp_lg_u32 s28, 0
s_cbranch_scc1 Lhi2
s_waitcnt lgkmcnt(0)
v_mul_f32 v104, 0x3b000000, v104
v_mul_f32 v105, 0x3b000000, v105
v_mul_f32 v106, 0x3b000000, v106
v_mul_f32 v107, 0x3b000000, v107
v_fma_f32 v105, -v104, v104, v105
v_fma_f32 v107, -v106, v106, v107
v_max_f32 v105, 0, v105
v_max_f32 v107, 0, v107
v_cvt_pk_bf16_f32 v108, v104, v105
v_cvt_pk_bf16_f32 v109, v106, v107
v_and_b32 v105, 0xffff0000, v108
v_and_b32 v107, 0xffff0000, v109
v_add_f32 v105, 0x3727c5ac, v105
v_add_f32 v107, 0x3727c5ac, v107
v_cvt_pk_bf16_f32 v105, v105, v105
v_cvt_pk_bf16_f32 v107, v107, v107
v_lshlrev_b32 v105, 16, v105
v_lshlrev_b32 v107, 16, v107
v_sqrt_f32 v105, v105
v_sqrt_f32 v107, v107
v_lshlrev_b32 v104, 16, v108
v_cvt_pk_bf16_f32 v105, v105, v105
v_cvt_pk_bf16_f32 v107, v107, v107
v_lshlrev_b32 v105, 16, v105
v_lshlrev_b32 v107, 16, v107
v_rcp_f32 v105, v105
v_lshlrev_b32 v106, 16, v109
v_rcp_f32 v107, v107
s_mov_b64 exec, 0xf
buffer_store_dwordx4 v[104:107], v22, s[8:11], s62 offen sc1
s_mov_b64 exec, -1
buffer_load_dword v34, v68, s[16:19], 0 offen sc1
Lhi2:
v_mov_b32 v66, 0x3f80
v_lshlrev_b32 v60, 16, v60
v_lshlrev_b32 v64, 16, v64
v_lshlrev_b32 v61, 16, v61
v_mul_f32 v60, 0x3fb8aa3b, v60
v_mul_f32 v64, 0x3fb8aa3b, v64
s_mov_b32 s60, 0x3e22f983
v_exp_f32 v60, v60
v_exp_f32 v64, v64
v_lshlrev_b32 v62, 16, v62
v_lshlrev_b32 v63, 16, v63
s_mul_i32 s61, s55, 47872
v_cvt_pk_bf16_f32 v60, v60, v64
s_lshl_b32 s94, s30, 8
v_and_b32 v48, 15, v1
v_and_b32 v64, 0xffff0000, v60
v_lshlrev_b32 v60, 16, v60
s_add_u32 m0, s61, s94
v_mul_f32 v61, v61, v64
v_mul_f32 v60, v60, v64
ds_write_addtid_b32 v66 offset:0
v_add_f32 v65, v64, v64
v_mul_f32 v64, s60, v61
v_mul_f32 v60, 0xbfb8aa3b, v60
v_mul_f32 v62, v62, v65
v_mul_f32 v63, v63, v65
v_fma_f32 v65, v61, s60, -v64
v_mul_f32 v125, 1.0, v64
v_mul_f32 v124, 1.0, v60
v_fmac_f32 v65, 0x31dc9c88, v61
v_fract_f32 v125, v125
v_exp_f32 v124, v124
v_mul_f32 v129, 0x41800000, v64
v_fmac_f32 v125, 1.0, v65
v_mul_f32 v128, 0x41800000, v60
v_fract_f32 v129, v129
v_cos_f32 v126, v125
v_sin_f32 v127, v125
v_fmac_f32 v129, 0x41800000, v65
v_exp_f32 v128, v128
v_mul_f32 v160, v124, v126
v_mul_f32 v161, v124, v127
v_cos_f32 v130, v129
v_sin_f32 v131, v129
v_pk_mul_f32 v[166:167], v[160:161], v[160:161] op_sel:[0,0] op_sel_hi:[0,1]
v_mul_f32 v133, 0x43800000, v64
v_mul_f32 v162, v128, v130
v_pk_fma_f32 v[166:167], v[160:161], v[160:161], v[166:167] op_sel:[1,1,0] op_sel_hi:[1,0,1] neg_lo:[0,1,0]
v_mul_f32 v163, v128, v131
v_fract_f32 v133, v133
v_pk_mul_f32 v[172:173], v[166:167], v[166:167] op_sel:[0,0] op_sel_hi:[0,1]
v_pk_mul_f32 v[184:185], v[166:167], v[160:161] op_sel:[0,0] op_sel_hi:[0,1]
v_pk_mul_f32 v[168:169], v[162:163], v[162:163] op_sel:[0,0] op_sel_hi:[0,1]
v_pk_fma_f32 v[172:173], v[166:167], v[166:167], v[172:173] op_sel:[1,1,0] op_sel_hi:[1,0,1] neg_lo:[0,1,0]
v_pk_fma_f32 v[184:185], v[166:167], v[160:161], v[184:185] op_sel:[1,1,0] op_sel_hi:[1,0,1] neg_lo:[0,1,0]
v_mul_f32 v132, 0x43800000, v60
v_pk_mul_f32 v[178:179], v[172:173], v[172:173] op_sel:[0,0] op_sel_hi:[0,1]
v_pk_mul_f32 v[190:191], v[172:173], v[184:185] op_sel:[0,0] op_sel_hi:[0,1]
v_pk_mul_f32 v[186:187], v[172:173], v[160:161] op_sel:[0,0] op_sel_hi:[0,1]
v_pk_fma_f32 v[178:179], v[172:173], v[172:173], v[178:179] op_sel:[1,1,0] op_sel_hi:[1,0,1] neg_lo:[0,1,0]
v_pk_fma_f32 v[190:191], v[172:173], v[184:185], v[190:191] op_sel:[1,1,0] op_sel_hi:[1,0,1] neg_lo:[0,1,0]
v_fmac_f32 v133, 0x43800000, v65
v_pk_mul_f32 v[196:197], v[178:179], v[184:185] op_sel:[0,0] op_sel_hi:[0,1]
v_pk_mul_f32 v[192:193], v[178:179], v[160:161] op_sel:[0,0] op_sel_hi:[0,1]
v_pk_mul_f32 v[204:205], v[178:179], v[190:191] op_sel:[0,0] op_sel_hi:[0,1]
v_pk_fma_f32 v[196:197], v[178:179], v[184:185], v[196:197] op_sel:[1,1,0] op_sel_hi:[1,0,1] neg_lo:[0,1,0]
v_pk_fma_f32 v[168:169], v[162:163], v[162:163], v[168:169] op_sel:[1,1,0] op_sel_hi:[1,0,1] neg_lo:[0,1,0]
v_pk_fma_f32 v[186:187], v[172:173], v[160:161], v[186:187] op_sel:[1,1,0] op_sel_hi:[1,0,1] neg_lo:[0,1,0]
v_pk_mul_f32 v[188:189], v[172:173], v[166:167] op_sel:[0,0] op_sel_hi:[0,1]
v_pk_mul_f32 v[194:195], v[178:179], v[166:167] op_sel:[0,0] op_sel_hi:[0,1]
v_pk_mul_f32 v[198:199], v[178:179], v[172:173] op_sel:[0,0] op_sel_hi:[0,1]
v_pk_mul_f32 v[210:211], v[196:197], v[196:197] op_sel:[0,0] op_sel_hi:[0,1]
v_pk_fma_f32 v[192:193], v[178:179], v[160:161], v[192:193] op_sel:[1,1,0] op_sel_hi:[1,0,1] neg_lo:[0,1,0]
v_pk_fma_f32 v[204:205], v[178:179], v[190:191], v[204:205] op_sel:[1,1,0] op_sel_hi:[1,0,1] neg_lo:[0,1,0]
v_exp_f32 v132, v132
v_cos_f32 v134, v133
v_sin_f32 v135, v133
v_pk_mul_f32 v[174:175], v[168:169], v[168:169] op_sel:[0,0] op_sel_hi:[0,1]
v_pk_mul_f32 v[200:201], v[178:179], v[186:187] op_sel:[0,0] op_sel_hi:[0,1]
v_pk_fma_f32 v[188:189], v[172:173], v[166:167], v[188:189] op_sel:[1,1,0] op_sel_hi:[1,0,1] neg_lo:[0,1,0]
v_pk_fma_f32 v[194:195], v[178:179], v[166:167], v[194:195] op_sel:[1,1,0] op_sel_hi:[1,0,1] neg_lo:[0,1,0]
v_pk_fma_f32 v[198:199], v[178:179], v[172:173], v[198:199] op_sel:[1,1,0] op_sel_hi:[1,0,1] neg_lo:[0,1,0]
v_pk_fma_f32 v[210:211], v[196:197], v[196:197], v[210:211] op_sel:[1,1,0] op_sel_hi:[1,0,1] neg_lo:[0,1,0]
v_cvt_pk_bf16_f32 v247, v178, v179
v_pk_mul_f32 v[206:207], v[192:193], v[192:193] op_sel:[0,0] op_sel_hi:[0,1]
v_pk_mul_f32 v[218:219], v[204:205], v[204:205] op_sel:[0,0] op_sel_hi:[0,1]
ds_write_addtid_b32 v247 offset:4352
v_pk_fma_f32 v[174:175], v[168:169], v[168:169], v[174:175] op_sel:[1,1,0] op_sel_hi:[1,0,1] neg_lo:[0,1,0]
v_pk_fma_f32 v[200:201], v[178:179], v[186:187], v[200:201] op_sel:[1,1,0] op_sel_hi:[1,0,1] neg_lo:[0,1,0]
v_mul_f32 v164, v132, v134
v_mul_f32 v165, v132, v135
v_pk_mul_f32 v[202:203], v[178:179], v[188:189] op_sel:[0,0] op_sel_hi:[0,1]
v_pk_mul_f32 v[208:209], v[194:195], v[194:195] op_sel:[0,0] op_sel_hi:[0,1]
v_pk_mul_f32 v[212:213], v[198:199], v[198:199] op_sel:[0,0] op_sel_hi:[0,1]
v_pk_mul_f32 v[224:225], v[210:211], v[210:211] op_sel:[0,0] op_sel_hi:[0,1]
v_pk_fma_f32 v[206:207], v[192:193], v[192:193], v[206:207] op_sel:[1,1,0] op_sel_hi:[1,0,1] neg_lo:[0,1,0]
v_pk_fma_f32 v[218:219], v[204:205], v[204:205], v[218:219] op_sel:[1,1,0] op_sel_hi:[1,0,1] neg_lo:[0,1,0]
v_pk_mul_f32 v[180:181], v[174:175], v[174:175] op_sel:[0,0] op_sel_hi:[0,1]
v_cvt_pk_bf16_f32 v251, v184, v185
v_cvt_pk_bf16_f32 v247, v200, v201
v_pk_mul_f32 v[96:97], v[62:63], v[162:163] op_sel:[0,0] op_sel_hi:[0,1]
ds_write_addtid_b32 v251 offset:1632
v_pk_mul_f32 v[102:103], v[62:63], v[174:175] op_sel:[0,0] op_sel_hi:[0,1]
v_pk_mul_f32 v[170:171], v[164:165], v[164:165] op_sel:[0,0] op_sel_hi:[0,1]
v_pk_fma_f32 v[202:203], v[178:179], v[188:189], v[202:203] op_sel:[1,1,0] op_sel_hi:[1,0,1] neg_lo:[0,1,0]
ds_write_addtid_b32 v247 offset:7072
v_pk_fma_f32 v[208:209], v[194:195], v[194:195], v[208:209] op_sel:[1,1,0] op_sel_hi:[1,0,1] neg_lo:[0,1,0]
v_pk_fma_f32 v[212:213], v[198:199], v[198:199], v[212:213] op_sel:[1,1,0] op_sel_hi:[1,0,1] neg_lo:[0,1,0]
v_pk_fma_f32 v[224:225], v[210:211], v[210:211], v[224:225] op_sel:[1,1,0] op_sel_hi:[1,0,1] neg_lo:[0,1,0]
v_cvt_pk_bf16_f32 v248, v162, v163
v_pk_mul_f32 v[220:221], v[206:207], v[206:207] op_sel:[0,0] op_sel_hi:[0,1]
v_pk_mul_f32 v[232:233], v[218:219], v[218:219] op_sel:[0,0] op_sel_hi:[0,1]
ds_write_addtid_b32 v248 offset:8704
v_pk_fma_f32 v[180:181], v[174:175], v[174:175], v[180:181] op_sel:[1,1,0] op_sel_hi:[1,0,1] neg_lo:[0,1,0]
v_cvt_pk_bf16_f32 v250, v174, v175
v_pk_fma_f32 v[96:97], v[62:63], v[162:163], v[96:97] op_sel:[1,1,0] op_sel_hi:[1,0,1] neg_lo:[0,1,0]
v_pk_fma_f32 v[102:103], v[62:63], v[174:175], v[102:103] op_sel:[1,1,0] op_sel_hi:[1,0,1] neg_lo:[0,1,0]
ds_write_addtid_b32 v250 offset:17408
v_pk_fma_f32 v[170:171], v[164:165], v[164:165], v[170:171] op_sel:[1,1,0] op_sel_hi:[1,0,1] neg_lo:[0,1,0]
v_cvt_pk_bf16_f32 v251, v208, v209
v_pk_mul_f32 v[214:215], v[200:201], v[200:201] op_sel:[0,0] op_sel_hi:[0,1]
v_pk_mul_f32 v[216:217], v[202:203], v[202:203] op_sel:[0,0] op_sel_hi:[0,1]
ds_write_addtid_b32 v251 offset:9792
v_cvt_pk_bf16_f32 v247, v224, v225
v_pk_mul_f32 v[226:227], v[212:213], v[212:213] op_sel:[0,0] op_sel_hi:[0,1]
v_pk_fma_f32 v[220:221], v[206:207], v[206:207], v[220:221] op_sel:[1,1,0] op_sel_hi:[1,0,1] neg_lo:[0,1,0]
ds_write_addtid_b32 v247 offset:14688
v_pk_fma_f32 v[232:233], v[218:219], v[218:219], v[232:233] op_sel:[1,1,0] op_sel_hi:[1,0,1] neg_lo:[0,1,0]
v_cvt_pk_bf16_f32 v252, v186, v187
v_cvt_pk_bf16_f32 v248, v202, v203
v_pk_mul_f32 v[98:99], v[62:63], v[168:169] op_sel:[0,0] op_sel_hi:[0,1]
ds_write_addtid_b32 v252 offset:2720
v_pk_mul_f32 v[100:101], v[96:97], v[168:169] op_sel:[0,0] op_sel_hi:[0,1]
v_pk_mul_f32 v[104:105], v[96:97], v[174:175] op_sel:[0,0] op_sel_hi:[0,1]
v_pk_mul_f32 v[118:119], v[102:103], v[180:181] op_sel:[0,0] op_sel_hi:[0,1]
ds_write_addtid_b32 v248 offset:7616
v_pk_mul_f32 v[176:177], v[170:171], v[170:171] op_sel:[0,0] op_sel_hi:[0,1]
v_cvt_pk_bf16_f32 v250, v206, v207
v_pk_fma_f32 v[214:215], v[200:201], v[200:201], v[214:215] op_sel:[1,1,0] op_sel_hi:[1,0,1] neg_lo:[0,1,0]
v_pk_fma_f32 v[216:217], v[202:203], v[202:203], v[216:217] op_sel:[1,1,0] op_sel_hi:[1,0,1] neg_lo:[0,1,0]
ds_write_addtid_b32 v250 offset:9248
v_pk_fma_f32 v[226:227], v[212:213], v[212:213], v[226:227] op_sel:[1,1,0] op_sel_hi:[1,0,1] neg_lo:[0,1,0]
v_cvt_pk_bf16_f32 v249, v168, v169
v_pk_mul_f32 v[222:223], v[208:209], v[208:209] op_sel:[0,0] op_sel_hi:[0,1]
v_cvt_pk_bf16_f32 v251, v232, v233
ds_write_addtid_b32 v249 offset:13056
v_pk_mul_f32 v[206:207], v[220:221], v[220:221] op_sel:[0,0] op_sel_hi:[0,1]
v_cvt_pk_bf16_f32 v247, v62, -v63
v_pk_fma_f32 v[98:99], v[62:63], v[168:169], v[98:99] op_sel:[1,1,0] op_sel_hi:[1,0,1] neg_lo:[0,1,0]
ds_write_addtid_b32 v251 offset:16864
v_pk_fma_f32 v[100:101], v[96:97], v[168:169], v[100:101] op_sel:[1,1,0] op_sel_hi:[1,0,1] neg_lo:[0,1,0]
v_pk_fma_f32 v[104:105], v[96:97], v[174:175], v[104:105] op_sel:[1,1,0] op_sel_hi:[1,0,1] neg_lo:[0,1,0]
v_pk_fma_f32 v[118:119], v[102:103], v[180:181], v[118:119] op_sel:[1,1,0] op_sel_hi:[1,0,1] neg_lo:[0,1,0]
ds_write_addtid_b32 v247 offset:21760
v_pk_mul_f32 v[126:127], v[62:63], v[164:165] op_sel:[0,0] op_sel_hi:[0,1]
v_pk_fma_f32 v[176:177], v[170:171], v[170:171], v[176:177] op_sel:[1,1,0] op_sel_hi:[1,0,1] neg_lo:[0,1,0]
v_cvt_pk_bf16_f32 v244, v160, v161
v_cvt_pk_bf16_f32 v252, v210, v211
v_cvt_pk_bf16_f32 v248, v226, v227
ds_write_addtid_b32 v244 offset:544
v_pk_mul_f32 v[228:229], v[214:215], v[214:215] op_sel:[0,0] op_sel_hi:[0,1]
v_pk_mul_f32 v[230:231], v[216:217], v[216:217] op_sel:[0,0] op_sel_hi:[0,1]
v_cvt_pk_bf16_f32 v253, v188, v189
ds_write_addtid_b32 v252 offset:10336
v_pk_fma_f32 v[222:223], v[208:209], v[208:209], v[222:223] op_sel:[1,1,0] op_sel_hi:[1,0,1] neg_lo:[0,1,0]
v_pk_fma_f32 v[206:207], v[220:221], v[220:221], v[206:207] op_sel:[1,1,0] op_sel_hi:[1,0,1] neg_lo:[0,1,0]
v_cvt_pk_bf16_f32 v254, v190, v191
ds_write_addtid_b32 v253 offset:3264
v_cvt_pk_bf16_f32 v249, v204, v205
v_cvt_pk_bf16_f32 v251, v102, -v103
v_pk_mul_f32 v[106:107], v[98:99], v[174:175] op_sel:[0,0] op_sel_hi:[0,1]
ds_write_addtid_b32 v254 offset:3808
v_pk_mul_f32 v[108:109], v[100:101], v[174:175] op_sel:[0,0] op_sel_hi:[0,1]
v_cvt_pk_bf16_f32 v247, v118, -v119
v_pk_mul_f32 v[120:121], v[104:105], v[180:181] op_sel:[0,0] op_sel_hi:[0,1]
ds_write_addtid_b32 v249 offset:8160
v_pk_fma_f32 v[126:127], v[62:63], v[164:165], v[126:127] op_sel:[1,1,0] op_sel_hi:[1,0,1] neg_lo:[0,1,0]
v_cvt_pk_bf16_f32 v245, v166, v167
v_cvt_pk_bf16_f32 v246, v172, v173
ds_write_addtid_b32 v248 offset:15232
v_pk_fma_f32 v[228:229], v[214:215], v[214:215], v[228:229] op_sel:[1,1,0] op_sel_hi:[1,0,1] neg_lo:[0,1,0]
v_pk_fma_f32 v[230:231], v[216:217], v[216:217], v[230:231] op_sel:[1,1,0] op_sel_hi:[1,0,1] neg_lo:[0,1,0]
v_pk_mul_f32 v[102:103], v[62:63], v[170:171] op_sel:[0,0] op_sel_hi:[0,1]
ds_write_addtid_b32 v245 offset:1088
v_pk_mul_f32 v[118:119], v[62:63], v[176:177] op_sel:[0,0] op_sel_hi:[0,1]
v_cvt_pk_bf16_f32 v255, v192, v193
v_cvt_pk_bf16_f32 v244, v194, v195
ds_write_addtid_b32 v246 offset:2176
v_cvt_pk_bf16_f32 v252, v206, v207
v_pk_mul_f32 v[208:209], v[222:223], v[222:223] op_sel:[0,0] op_sel_hi:[0,1]
v_pk_mul_f32 v[210:211], v[224:225], v[224:225] op_sel:[0,0] op_sel_hi:[0,1]
ds_write_addtid_b32 v255 offset:4896
v_cvt_pk_bf16_f32 v248, v96, -v97
v_cvt_pk_bf16_f32 v253, v212, v213
v_pk_fma_f32 v[106:107], v[98:99], v[174:175], v[106:107] op_sel:[1,1,0] op_sel_hi:[1,0,1] neg_lo:[0,1,0]
ds_write_addtid_b32 v244 offset:5440
v_pk_fma_f32 v[108:109], v[100:101], v[174:175], v[108:109] op_sel:[1,1,0] op_sel_hi:[1,0,1] neg_lo:[0,1,0]
v_pk_fma_f32 v[120:121], v[104:105], v[180:181], v[120:121] op_sel:[1,1,0] op_sel_hi:[1,0,1] neg_lo:[0,1,0]
v_pk_mul_f32 v[128:129], v[126:127], v[168:169] op_sel:[0,0] op_sel_hi:[0,1]
ds_write_addtid_b32 v253 offset:10880
v_cvt_pk_bf16_f32 v254, v214, v215
v_cvt_pk_bf16_f32 v249, v228, v229
v_cvt_pk_bf16_f32 v250, v230, v231
ds_write_addtid_b32 v254 offset:11424
s_cmp_ge_u32 s28, 2
s_cbranch_scc1 Llo_2
s_waitcnt vmcnt(0)
Llo_2:
s_cmp_lg_u32 s28, 0
s_cbranch_scc1 Lc_3
v_cmp_gt_u32 vcc, 1, v34
s_cbranch_vccnz Lsp_4
Lsd_5:
Lc_3:
s_barrier
s_add_u32 s63, s56, 262144
s_mov_b64 exec, 255
buffer_atomic_add v35, v3, s[8:11], s63 offen sc1
s_mov_b64 exec, -1
v_pk_mul_f32 v[212:213], v[226:227], v[226:227] op_sel:[0,0] op_sel_hi:[0,1]
v_pk_fma_f32 v[102:103], v[62:63], v[170:171], v[102:103] op_sel:[1,1,0] op_sel_hi:[1,0,1] neg_lo:[0,1,0]
v_pk_fma_f32 v[118:119], v[62:63], v[176:177], v[118:119] op_sel:[1,1,0] op_sel_hi:[1,0,1] neg_lo:[0,1,0]
s_add_u32 m0, s95, 38400
s_add_u32 s58, s43, 0
buffer_load_dwordx4 v31, s[4:7], s58 offen lds
s_add_u32 m0, s61, s94
s_nop 0
ds_write_addtid_b32 v249 offset:15776
v_cvt_pk_bf16_f32 v245, v196, v197
v_cvt_pk_bf16_f32 v246, v198, v199
v_pk_fma_f32 v[208:209], v[222:223], v[222:223], v[208:209] op_sel:[1,1,0] op_sel_hi:[1,0,1] neg_lo:[0,1,0]
ds_write_addtid_b32 v245 offset:5984
v_pk_fma_f32 v[210:211], v[224:225], v[224:225], v[210:211] op_sel:[1,1,0] op_sel_hi:[1,0,1] neg_lo:[0,1,0]
s_mul_i32 s62, s30, 17408
v_cvt_pk_bf16_f32 v255, v216, v217
ds_write_addtid_b32 v246 offset:6528
v_cvt_pk_bf16_f32 v244, v218, v219
v_pk_mul_f32 v[122:123], v[106:107], v[180:181] op_sel:[0,0] op_sel_hi:[0,1]
v_pk_mul_f32 v[124:125], v[108:109], v[180:181] op_sel:[0,0] op_sel_hi:[0,1]
s_add_u32 m0, s95, 42624
s_add_u32 s58, s43, 57344
buffer_load_dwordx4 v31, s[4:7], s58 offen lds
s_add_u32 m0, s61, s94
s_nop 0
ds_write_addtid_b32 v255 offset:11968
v_pk_fma_f32 v[128:129], v[126:127], v[168:169], v[128:129] op_sel:[1,1,0] op_sel_hi:[1,0,1] neg_lo:[0,1,0]
s_mul_i32 s66, s30, 3
v_pk_fma_f32 v[212:213], v[226:227], v[226:227], v[212:213] op_sel:[1,1,0] op_sel_hi:[1,0,1] neg_lo:[0,1,0]
ds_write_addtid_b32 v244 offset:12512
v_pk_mul_f32 v[214:215], v[228:229], v[228:229] op_sel:[0,0] op_sel_hi:[0,1]
s_cmp_lt_u32 s28, 2
s_cbranch_scc1 Lhi_7
s_waitcnt vmcnt(4)
ds_read_b64_tr_b16 v[72:73], v137 offset:0
ds_read_b64_tr_b16 v[74:75], v137 offset:1024
ds_read_b64_tr_b16 v[76:77], v137 offset:256
ds_read_b64_tr_b16 v[78:79], v137 offset:1280
ds_read_b64_tr_b16 v[80:81], v137 offset:2048
ds_read_b64_tr_b16 v[82:83], v137 offset:3072
ds_read_b64_tr_b16 v[84:85], v137 offset:2304
ds_read_b64_tr_b16 v[86:87], v137 offset:3328
Lhi_7:
v_pk_mul_f32 v[216:217], v[230:231], v[230:231] op_sel:[0,0] op_sel_hi:[0,1]
v_pk_mul_f32 v[218:219], v[232:233], v[232:233] op_sel:[0,0] op_sel_hi:[0,1]
ds_write_addtid_b32 v250 offset:16320
s_add_u32 s67, s30, 1
v_cvt_pk_bf16_f32 v253, v208, v209
v_cvt_pk_bf16_f32 v254, v210, v211
s_add_u32 m0, s95, 46848
s_add_u32 s58, s43, 114688
buffer_load_dwordx4 v31, s[4:7], s58 offen lds
s_add_u32 m0, s61, s94
s_nop 0
ds_write_addtid_b32 v252 offset:17952
v_cvt_pk_bf16_f32 v252, v104, -v105
v_pk_mul_f32 v[104:105], v[102:103], v[174:175] op_sel:[0,0] op_sel_hi:[0,1]
v_cvt_pk_bf16_f32 v249, v98, -v99
ds_write_addtid_b32 v253 offset:18496
v_cvt_pk_bf16_f32 v250, v100, -v101
v_pk_mul_f32 v[110:111], v[62:63], v[180:181] op_sel:[0,0] op_sel_hi:[0,1]
v_cvt_pk_bf16_f32 v245, v220, v221
ds_write_addtid_b32 v254 offset:19040
v_cvt_pk_bf16_f32 v246, v222, v223
v_pk_fma_f32 v[122:123], v[106:107], v[180:181], v[122:123] op_sel:[1,1,0] op_sel_hi:[1,0,1] neg_lo:[0,1,0]
v_pk_fma_f32 v[124:125], v[108:109], v[180:181], v[124:125] op_sel:[1,1,0] op_sel_hi:[1,0,1] neg_lo:[0,1,0]
s_add_u32 m0, s95, 51072
s_add_u32 s58, s43, 172032
buffer_load_dwordx4 v31, s[4:7], s58 offen lds
s_add_u32 m0, s61, s94
s_nop 0
ds_write_addtid_b32 v245 offset:13600
v_pk_mul_f32 v[130:131], v[126:127], v[174:175] op_sel:[0,0] op_sel_hi:[0,1]
s_cmp_lt_u32 s28, 2
s_cbranch_scc1 Lhi_8
s_waitcnt lgkmcnt(0)
s_add_u32 s58, s49, 0
buffer_store_dwordx4 v[72:75], v22, s[8:11], s58 offen sc1
s_add_u32 s58, s49, 1024
buffer_store_dwordx4 v[76:79], v22, s[8:11], s58 offen sc1
s_add_u32 s58, s49, 2048
buffer_store_dwordx4 v[80:83], v22, s[8:11], s58 offen sc1
s_add_u32 s58, s49, 3072
buffer_store_dwordx4 v[84:87], v22, s[8:11], s58 offen sc1
Lhi_8:
v_pk_mul_f32 v[132:133], v[128:129], v[174:175] op_sel:[0,0] op_sel_hi:[0,1]
v_cvt_pk_bf16_f32 v255, v212, v213
ds_write_addtid_b32 v246 offset:14144
v_pk_fma_f32 v[214:215], v[228:229], v[228:229], v[214:215] op_sel:[1,1,0] op_sel_hi:[1,0,1] neg_lo:[0,1,0]
v_pk_fma_f32 v[216:217], v[230:231], v[230:231], v[216:217] op_sel:[1,1,0] op_sel_hi:[1,0,1] neg_lo:[0,1,0]
v_pk_fma_f32 v[218:219], v[232:233], v[232:233], v[218:219] op_sel:[1,1,0] op_sel_hi:[1,0,1] neg_lo:[0,1,0]
ds_write_addtid_b32 v255 offset:19584
v_pk_fma_f32 v[104:105], v[102:103], v[174:175], v[104:105] op_sel:[1,1,0] op_sel_hi:[1,0,1] neg_lo:[0,1,0]
v_lshlrev_b32 v40, s66, v48
v_lshlrev_b32 v42, s67, v48
s_add_u32 m0, s95, 55296
s_add_u32 s58, s43, 229376
buffer_load_dwordx4 v31, s[4:7], s58 offen lds
s_add_u32 m0, s61, s94
s_nop 0
ds_write_addtid_b32 v248 offset:22304
v_cvt_pk_bf16_f32 v248, v120, -v121
v_pk_mul_f32 v[120:121], v[118:119], v[180:181] op_sel:[0,0] op_sel_hi:[0,1]
v_pk_fma_f32 v[110:111], v[62:63], v[180:181], v[110:111] op_sel:[1,1,0] op_sel_hi:[1,0,1] neg_lo:[0,1,0]
ds_write_addtid_b32 v249 offset:22848
v_pk_fma_f32 v[120:121], v[118:119], v[180:181], v[120:121] op_sel:[1,1,0] op_sel_hi:[1,0,1] neg_lo:[0,1,0]
v_pk_mul_f32 v[112:113], v[96:97], v[180:181] op_sel:[0,0] op_sel_hi:[0,1]
v_pk_mul_f32 v[114:115], v[98:99], v[180:181] op_sel:[0,0] op_sel_hi:[0,1]
ds_write_addtid_b32 v250 offset:23392
v_pk_mul_f32 v[116:117], v[100:101], v[180:181] op_sel:[0,0] op_sel_hi:[0,1]
v_cvt_pk_bf16_f32 v253, v106, -v107
v_cvt_pk_bf16_f32 v254, v108, -v109
s_add_u32 m0, s95, 59520
s_add_u32 s58, s43, 286720
buffer_load_dwordx4 v31, s[4:7], s58 offen lds
s_add_u32 m0, s61, s94
s_nop 0
ds_write_addtid_b32 v251 offset:23936
v_cvt_pk_bf16_f32 v249, v122, -v123
v_cvt_pk_bf16_f32 v250, v124, -v125
v_pk_fma_f32 v[130:131], v[126:127], v[174:175], v[130:131] op_sel:[1,1,0] op_sel_hi:[1,0,1] neg_lo:[0,1,0]
ds_write_addtid_b32 v252 offset:24480
v_pk_fma_f32 v[132:133], v[128:129], v[174:175], v[132:133] op_sel:[1,1,0] op_sel_hi:[1,0,1] neg_lo:[0,1,0]
v_pk_mul_f32 v[134:135], v[126:127], v[180:181] op_sel:[0,0] op_sel_hi:[0,1]
v_pk_mul_f32 v[182:183], v[176:177], v[176:177] op_sel:[0,0] op_sel_hi:[0,1]
ds_write_addtid_b32 v253 offset:25024
v_cvt_pk_bf16_f32 v244, v214, v215
v_cvt_pk_bf16_f32 v245, v216, v217
v_cvt_pk_bf16_f32 v246, v218, v219
s_add_u32 m0, s95, 63744
s_add_u32 s58, s43, 344064
buffer_load_dwordx4 v31, s[4:7], s58 offen lds
s_add_u32 m0, s61, s94
s_nop 0
ds_write_addtid_b32 v244 offset:20128
v_pk_mul_f32 v[106:107], v[102:103], v[180:181] op_sel:[0,0] op_sel_hi:[0,1]
v_pk_mul_f32 v[108:109], v[104:105], v[180:181] op_sel:[0,0] op_sel_hi:[0,1]
v_pk_mul_f32 v[122:123], v[118:119], v[164:165] op_sel:[0,0] op_sel_hi:[0,1]
ds_write_addtid_b32 v245 offset:20672
v_pk_mul_f32 v[124:125], v[120:121], v[164:165] op_sel:[0,0] op_sel_hi:[0,1]
v_cvt_f32_u32 v41, v40
v_cvt_f32_u32 v43, v42
ds_write_addtid_b32 v246 offset:21216
v_cvt_pk_bf16_f32 v255, v110, -v111
v_pk_fma_f32 v[112:113], v[96:97], v[180:181], v[112:113] op_sel:[1,1,0] op_sel_hi:[1,0,1] neg_lo:[0,1,0]
v_pk_fma_f32 v[114:115], v[98:99], v[180:181], v[114:115] op_sel:[1,1,0] op_sel_hi:[1,0,1] neg_lo:[0,1,0]
s_add_u32 m0, s95, 67968
s_add_u32 s58, s43, 401408
buffer_load_dwordx4 v31, s[4:7], s58 offen lds
s_add_u32 m0, s61, s94
s_nop 0
ds_write_addtid_b32 v254 offset:25568
v_pk_fma_f32 v[116:117], v[100:101], v[180:181], v[116:117] op_sel:[1,1,0] op_sel_hi:[1,0,1] neg_lo:[0,1,0]
v_pk_fma_f32 v[134:135], v[126:127], v[180:181], v[134:135] op_sel:[1,1,0] op_sel_hi:[1,0,1] neg_lo:[0,1,0]
v_pk_mul_f32 v[96:97], v[128:129], v[180:181] op_sel:[0,0] op_sel_hi:[0,1]
ds_write_addtid_b32 v255 offset:26112
v_pk_mul_f32 v[98:99], v[130:131], v[180:181] op_sel:[0,0] op_sel_hi:[0,1]
v_pk_mul_f32 v[100:101], v[132:133], v[180:181] op_sel:[0,0] op_sel_hi:[0,1]
v_pk_mul_f32 v[110:111], v[102:103], v[164:165] op_sel:[0,0] op_sel_hi:[0,1]
ds_write_addtid_b32 v247 offset:28288
v_pk_fma_f32 v[182:183], v[176:177], v[176:177], v[182:183] op_sel:[1,1,0] op_sel_hi:[1,0,1] neg_lo:[0,1,0]
v_pk_fma_f32 v[106:107], v[102:103], v[180:181], v[106:107] op_sel:[1,1,0] op_sel_hi:[1,0,1] neg_lo:[0,1,0]
v_pk_fma_f32 v[108:109], v[104:105], v[180:181], v[108:109] op_sel:[1,1,0] op_sel_hi:[1,0,1] neg_lo:[0,1,0]
s_add_u32 m0, s95, 72192
s_add_u32 s58, s43, 458752
buffer_load_dwordx4 v31, s[4:7], s58 offen lds
s_add_u32 m0, s61, s94
s_nop 0
ds_write_addtid_b32 v248 offset:28832
v_pk_fma_f32 v[122:123], v[118:119], v[164:165], v[122:123] op_sel:[1,1,0] op_sel_hi:[1,0,1] neg_lo:[0,1,0]
v_pk_fma_f32 v[124:125], v[120:121], v[164:165], v[124:125] op_sel:[1,1,0] op_sel_hi:[1,0,1] neg_lo:[0,1,0]
v_lshrrev_b32 v49, 4, v1
ds_write_addtid_b32 v249 offset:29376
v_lshrrev_b32 v41, 20, v41
v_lshrrev_b32 v43, 20, v43
v_cvt_pk_bf16_f32 v244, v112, -v113
ds_write_addtid_b32 v250 offset:29920
v_cvt_pk_bf16_f32 v245, v114, -v115
v_cvt_pk_bf16_f32 v246, v116, -v117
v_cvt_pk_bf16_f32 v251, v126, -v127
s_add_u32 m0, s95, 76416
s_add_u32 s58, s43, 516096
buffer_load_dwordx4 v31, s[4:7], s58 offen lds
s_add_u32 m0, s61, s94
s_nop 0
ds_write_addtid_b32 v244 offset:26656
v_cvt_pk_bf16_f32 v252, v128, -v129
v_cvt_pk_bf16_f32 v253, v130, -v131
v_cvt_pk_bf16_f32 v254, v132, -v133
ds_write_addtid_b32 v245 offset:27200
v_cvt_pk_bf16_f32 v255, v134, -v135
v_pk_fma_f32 v[96:97], v[128:129], v[180:181], v[96:97] op_sel:[1,1,0] op_sel_hi:[1,0,1] neg_lo:[0,1,0]
v_pk_fma_f32 v[98:99], v[130:131], v[180:181], v[98:99] op_sel:[1,1,0] op_sel_hi:[1,0,1] neg_lo:[0,1,0]
ds_write_addtid_b32 v246 offset:27744
v_pk_fma_f32 v[100:101], v[132:133], v[180:181], v[100:101] op_sel:[1,1,0] op_sel_hi:[1,0,1] neg_lo:[0,1,0]
v_pk_fma_f32 v[110:111], v[102:103], v[164:165], v[110:111] op_sel:[1,1,0] op_sel_hi:[1,0,1] neg_lo:[0,1,0]
v_pk_mul_f32 v[112:113], v[104:105], v[164:165] op_sel:[0,0] op_sel_hi:[0,1]
s_add_u32 m0, s95, 80640
s_add_u32 s58, s43, 573440
buffer_load_dwordx4 v31, s[4:7], s58 offen lds
s_add_u32 m0, s61, s94
s_nop 0
ds_write_addtid_b32 v251 offset:30464
v_pk_mul_f32 v[114:115], v[106:107], v[164:165] op_sel:[0,0] op_sel_hi:[0,1]
v_pk_mul_f32 v[116:117], v[108:109], v[164:165] op_sel:[0,0] op_sel_hi:[0,1]
v_pk_mul_f32 v[126:127], v[118:119], v[170:171] op_sel:[0,0] op_sel_hi:[0,1]
ds_write_addtid_b32 v252 offset:31008
v_pk_mul_f32 v[128:129], v[120:121], v[170:171] op_sel:[0,0] op_sel_hi:[0,1]
v_pk_mul_f32 v[130:131], v[122:123], v[170:171] op_sel:[0,0] op_sel_hi:[0,1]
v_pk_mul_f32 v[132:133], v[124:125], v[170:171] op_sel:[0,0] op_sel_hi:[0,1]
ds_write_addtid_b32 v253 offset:31552
v_pk_mul_f32 v[134:135], v[62:63], v[182:183] op_sel:[0,0] op_sel_hi:[0,1]
v_lshlrev_b32 v50, 4, v49
v_lshlrev_b32 v56, 7, v49
ds_write_addtid_b32 v254 offset:32096
s_lshl_b32 s68, s55, 11
v_subrev_u32 v41, 1032, v41
v_subrev_u32 v43, 1032, v43
ds_write_addtid_b32 v255 offset:32640
v_cvt_pk_bf16_f32 v255, v118, -v119
v_cvt_pk_bf16_f32 v244, v96, -v97
v_cvt_pk_bf16_f32 v245, v98, -v99
ds_write_addtid_b32 v255 offset:39168
v_cvt_pk_bf16_f32 v246, v100, -v101
v_cvt_pk_bf16_f32 v247, v102, -v103
v_cvt_pk_bf16_f32 v248, v104, -v105
ds_write_addtid_b32 v244 offset:33184
v_cvt_pk_bf16_f32 v249, v106, -v107
v_cvt_pk_bf16_f32 v250, v108, -v109
v_cvt_pk_bf16_f32 v251, v110, -v111
ds_write_addtid_b32 v245 offset:33728
v_pk_fma_f32 v[112:113], v[104:105], v[164:165], v[112:113] op_sel:[1,1,0] op_sel_hi:[1,0,1] neg_lo:[0,1,0]
v_pk_fma_f32 v[114:115], v[106:107], v[164:165], v[114:115] op_sel:[1,1,0] op_sel_hi:[1,0,1] neg_lo:[0,1,0]
v_pk_fma_f32 v[116:117], v[108:109], v[164:165], v[116:117] op_sel:[1,1,0] op_sel_hi:[1,0,1] neg_lo:[0,1,0]
ds_write_addtid_b32 v246 offset:34272
v_pk_fma_f32 v[126:127], v[118:119], v[170:171], v[126:127] op_sel:[1,1,0] op_sel_hi:[1,0,1] neg_lo:[0,1,0]
v_pk_fma_f32 v[128:129], v[120:121], v[170:171], v[128:129] op_sel:[1,1,0] op_sel_hi:[1,0,1] neg_lo:[0,1,0]
v_pk_fma_f32 v[130:131], v[122:123], v[170:171], v[130:131] op_sel:[1,1,0] op_sel_hi:[1,0,1] neg_lo:[0,1,0]
ds_write_addtid_b32 v247 offset:34816
v_pk_fma_f32 v[132:133], v[124:125], v[170:171], v[132:133] op_sel:[1,1,0] op_sel_hi:[1,0,1] neg_lo:[0,1,0]
v_pk_fma_f32 v[134:135], v[62:63], v[182:183], v[134:135] op_sel:[1,1,0] op_sel_hi:[1,0,1] neg_lo:[0,1,0]
v_add_u32 v50, s61, v50
ds_write_addtid_b32 v248 offset:35360
v_mul_u32_u24 v51, 544, v48
v_lshl_add_u32 v56, v48, 1, v56
s_add_u32 s68, s68, 156176
ds_write_addtid_b32 v249 offset:35904
v_med3_i32 v41, v41, v40, 7
v_med3_i32 v43, v43, v42, 7
v_cvt_pk_bf16_f32 v252, v112, -v113
ds_write_addtid_b32 v250 offset:36448
v_cvt_pk_bf16_f32 v253, v114, -v115
v_cvt_pk_bf16_f32 v254, v116, -v117
v_cvt_pk_bf16_f32 v244, v120, -v121
ds_write_addtid_b32 v251 offset:36992
v_cvt_pk_bf16_f32 v245, v122, -v123
v_cvt_pk_bf16_f32 v246, v124, -v125
v_cvt_pk_bf16_f32 v247, v126, -v127
ds_write_addtid_b32 v252 offset:37536
v_cvt_pk_bf16_f32 v248, v128, -v129
v_cvt_pk_bf16_f32 v249, v130, -v131
v_cvt_pk_bf16_f32 v250, v132, -v133
v_mul_u32_u24 v58, 37, v1
v_lshrrev_b32 v58, 8, v58
v_mul_u32_u24 v59, 7, v58
v_sub_u32 v59, v1, v59
v_mul_u32_u24 v58, 3584, v58
v_lshl_add_u32 v58, v59, 7, v58
s_lshl_b32 s59, s41, 1
s_add_u32 s59, s59, s30
s_mul_i32 s59, s59, 7168
s_mul_i32 s58, s54, 896
s_add_u32 s59, s59, s58
s_add_u32 s59, s59, 688128
s_mov_b64 exec, 16383
buffer_load_dword v156, v58, s[4:7], s59 offen
s_mov_b64 exec, -1
ds_write_addtid_b32 v253 offset:38080
v_cvt_pk_bf16_f32 v251, v134, -v135
v_add_u32 v52, v50, v51
v_add_u32 v56, s68, v56
ds_write_addtid_b32 v254 offset:38624
s_lshl_b32 s69, s30, 10
v_mul_u32_u24 v41, 544, v41
v_mul_u32_u24 v43, 544, v43
ds_write_addtid_b32 v244 offset:39712
v_lshlrev_b32 v5, 16, v5
v_add_u32 v53, s62, v52
v_add_u32 v57, s69, v56
ds_write_addtid_b32 v245 offset:40256
v_add_u32 v54, v50, v41
v_add_u32 v55, v50, v43
ds_write_addtid_b32 v246 offset:40800
ds_write_addtid_b32 v247 offset:41344
ds_write_addtid_b32 v248 offset:41888
ds_write_addtid_b32 v249 offset:42432
ds_write_addtid_b32 v250 offset:42976
ds_write_addtid_b32 v251 offset:43520
s_waitcnt lgkmcnt(0)
s_barrier
ds_read_b128 v[160:163], v53 offset:21760
ds_read_b128 v[164:167], v54 offset:0
ds_read_b128 v[168:171], v52 offset:30464
ds_read_b128 v[172:175], v55 offset:0
ds_read_b128 v[176:179], v53 offset:21824
ds_read_b128 v[180:183], v54 offset:64
ds_read_b128 v[184:187], v52 offset:30528
ds_read_b128 v[188:191], v55 offset:64
ds_read_b128 v[192:195], v53 offset:21888
ds_read_b128 v[196:199], v54 offset:128
ds_read_b128 v[200:203], v52 offset:30592
ds_read_b128 v[204:207], v55 offset:128
ds_read_b128 v[208:211], v53 offset:21952
ds_read_b128 v[212:215], v54 offset:192
ds_read_b128 v[216:219], v52 offset:30656
ds_read_b128 v[220:223], v55 offset:192
s_add_u32 s64, s56, 262144
buffer_load_dword v34, v2, s[8:11], s64 offen sc1
s_waitcnt lgkmcnt(12)
v_mfma_f32_16x16x32_bf16 v[72:75], v[160:163], v[164:167], 0
v_mfma_f32_16x16x32_bf16 v[76:79], v[168:171], v[172:175], 0
ds_read_b128 v[160:163], v53 offset:22016
ds_read_b128 v[164:167], v54 offset:256
ds_read_b128 v[168:171], v52 offset:30720
ds_read_b128 v[172:175], v55 offset:256
s_waitcnt lgkmcnt(12)
v_mfma_f32_16x16x32_bf16 v[72:75], v[176:179], v[180:183], v[72:75]
v_mfma_f32_16x16x32_bf16 v[76:79], v[184:187], v[188:191], v[76:79]
ds_read_b128 v[176:179], v53 offset:22080
ds_read_b128 v[180:183], v54 offset:320
ds_read_b128 v[184:187], v52 offset:30784
ds_read_b128 v[188:191], v55 offset:320
s_waitcnt lgkmcnt(12)
v_mfma_f32_16x16x32_bf16 v[72:75], v[192:195], v[196:199], v[72:75]
v_mfma_f32_16x16x32_bf16 v[76:79], v[200:203], v[204:207], v[76:79]
ds_read_b128 v[192:195], v53 offset:22144
ds_read_b128 v[196:199], v54 offset:384
ds_read_b128 v[200:203], v52 offset:30848
ds_read_b128 v[204:207], v55 offset:384
s_waitcnt lgkmcnt(12)
v_mfma_f32_16x16x32_bf16 v[72:75], v[208:211], v[212:215], v[72:75]
v_mfma_f32_16x16x32_bf16 v[76:79], v[216:219], v[220:223], v[76:79]
ds_read_b128 v[208:211], v53 offset:22208
ds_read_b128 v[212:215], v54 offset:448
ds_read_b128 v[216:219], v52 offset:30912
ds_read_b128 v[220:223], v55 offset:448
s_waitcnt lgkmcnt(12)
v_mfma_f32_16x16x32_bf16 v[72:75], v[160:163], v[164:167], v[72:75]
v_mfma_f32_16x16x32_bf16 v[76:79], v[168:171], v[172:175], v[76:79]
s_waitcnt lgkmcnt(8)
v_mfma_f32_16x16x32_bf16 v[72:75], v[176:179], v[180:183], v[72:75]
v_mfma_f32_16x16x32_bf16 v[76:79], v[184:187], v[188:191], v[76:79]
s_waitcnt lgkmcnt(4)
v_mfma_f32_16x16x32_bf16 v[72:75], v[192:195], v[196:199], v[72:75]
v_mfma_f32_16x16x32_bf16 v[76:79], v[200:203], v[204:207], v[76:79]
s_waitcnt lgkmcnt(0)
v_mfma_f32_16x16x32_bf16 v[72:75], v[208:211], v[212:215], v[72:75]
v_mfma_f32_16x16x32_bf16 v[76:79], v[216:219], v[220:223], v[76:79]
v_mov_b32 v48, 156168
v_and_b32 v44, 31, v0
v_lshrrev_b32 v45, 2, v44
v_mul_u32_u24 v45, 4160, v45
v_and_b32 v44, 3, v44
v_lshl_add_u32 v45, v44, 4, v45
ds_write_b64 v48, v[68:69]
ds_write_b64 v48, v[68:69] offset:2048
v_cvt_pk_bf16_f32 v48, v72, v73
v_cvt_pk_bf16_f32 v49, v74, v75
v_cvt_pk_bf16_f32 v50, v76, v77
v_cvt_pk_bf16_f32 v51, v78, v79
ds_write_b16 v57, v48 offset:0
ds_write_b16_d16_hi v57, v48 offset:32
ds_write_b16 v57, v49 offset:64
ds_write_b16_d16_hi v57, v49 offset:96
s_sub_u32 exec_hi, 0, s30
s_not_b32 exec_lo, exec_hi
ds_write_b16 v56, v50 offset:512
ds_write_b16_d16_hi v56, v50 offset:544
ds_write_b16 v56, v51 offset:576
ds_write_b16_d16_hi v56, v51 offset:608
s_mov_b64 exec, -1
s_waitcnt vmcnt(0)
v_cmp_gt_u32 vcc, s57, v34
s_cbranch_vccz Lsd_10
s_mov_b32 s80, 0
Lsq_11:
buffer_load_dword v34, v2, s[8:11], s64 offen sc1
s_add_u32 s80, s80, 1
s_cmp_lt_u32 s80, 0x8000
s_cbranch_scc0 Lsd_10
s_waitcnt vmcnt(0)
v_cmp_gt_u32 vcc, s57, v34
s_nop 1
s_cbranch_vccnz Lsq_11
Lsd_10:
s_waitcnt lgkmcnt(0)
s_barrier
s_add_u32 s63, s56, 98304
s_mov_b64 exec, 255
buffer_atomic_add v35, v3, s[8:11], s63 offen sc1
s_mov_b64 exec, -1
ds_read_u16 v160, v140 offset:0
ds_read_u16 v161, v141 offset:0
ds_read_u16 v162, v142 offset:0
ds_read_u16 v163, v143 offset:0
ds_read_u16 v164, v144 offset:0
ds_read_u16 v165, v145 offset:0
ds_read_u16 v166, v146 offset:0
ds_read_u16 v167, v147 offset:0
ds_read_u16 v168, v148 offset:0
ds_read_u16 v169, v149 offset:0
ds_read_u16 v170, v150 offset:0
ds_read_u16 v176, v140 offset:2048
ds_read_u16 v177, v141 offset:2048
ds_read_u16 v178, v142 offset:2048
ds_read_u16 v179, v143 offset:2048
ds_read_u16 v180, v144 offset:2048
ds_read_u16 v181, v145 offset:2048
ds_read_u16 v182, v146 offset:2048
ds_read_u16 v183, v147 offset:2048
ds_read_u16 v184, v148 offset:2048
ds_read_u16 v185, v149 offset:2048
ds_read_u16 v186, v150 offset:2048
ds_write_b128 v45, v[68:71] offset:4096
s_mov_b32 s60, 294912
buffer_load_dwordx4 v[104:107], v9, s[8:11], s60 offen sc1
s_mov_b32 s60, 299008
buffer_load_dwordx4 v[108:111], v9, s[8:11], s60 offen sc1
s_add_u32 s60, s32, 2097152
buffer_load_dword v112, v10, s[8:11], s60 offen offset:0 sc1
buffer_load_dword v113, v10, s[8:11], s60 offen offset:1024 sc1
s_add_u32 s60, s32, 2101248
buffer_load_dword v114, v10, s[8:11], s60 offen offset:0 sc1
buffer_load_dword v115, v10, s[8:11], s60 offen offset:1024 sc1
s_mov_b32 s60, 303104
buffer_load_dwordx4 v[120:123], v9, s[8:11], s60 offen sc1
s_mov_b32 s60, 307200
buffer_load_dwordx4 v[124:127], v9, s[8:11], s60 offen sc1
s_add_u32 s60, s32, 2099200
buffer_load_dword v128, v10, s[8:11], s60 offen offset:0 sc1
buffer_load_dword v129, v10, s[8:11], s60 offen offset:1024 sc1
s_add_u32 s60, s32, 2103296
buffer_load_dword v130, v10, s[8:11], s60 offen offset:0 sc1
buffer_load_dword v131, v10, s[8:11], s60 offen offset:1024 sc1
s_waitcnt lgkmcnt(12)
v_lshl_or_b32 v192, v161, 16, v160
v_lshl_or_b32 v193, v163, 16, v162
v_lshl_or_b32 v194, v165, 16, v164
v_lshl_or_b32 v195, v167, 16, v166
ds_write_b128 v9, v[192:195] offset:0
v_lshl_or_b32 v196, v162, 16, v161
v_lshl_or_b32 v197, v164, 16, v163
v_lshl_or_b32 v198, v166, 16, v165
v_lshl_or_b32 v199, v168, 16, v167
ds_write_b128 v9, v[196:199] offset:4160
v_lshl_or_b32 v200, v163, 16, v162
v_lshl_or_b32 v201, v165, 16, v164
v_lshl_or_b32 v202, v167, 16, v166
v_lshl_or_b32 v203, v169, 16, v168
ds_write_b128 v9, v[200:203] offset:8320
v_lshl_or_b32 v204, v164, 16, v163
v_lshl_or_b32 v205, v166, 16, v165
v_lshl_or_b32 v206, v168, 16, v167
v_lshl_or_b32 v207, v170, 16, v169
ds_write_b128 v9, v[204:207] offset:12480
s_waitcnt lgkmcnt(5)
v_lshl_or_b32 v208, v177, 16, v176
v_lshl_or_b32 v209, v179, 16, v178
v_lshl_or_b32 v210, v181, 16, v180
v_lshl_or_b32 v211, v183, 16, v182
ds_write_b128 v9, v[208:211] offset:16640
v_lshl_or_b32 v212, v178, 16, v177
v_lshl_or_b32 v213, v180, 16, v179
v_lshl_or_b32 v214, v182, 16, v181
v_lshl_or_b32 v215, v184, 16, v183
ds_write_b128 v9, v[212:215] offset:20800
v_lshl_or_b32 v216, v179, 16, v178
v_lshl_or_b32 v217, v181, 16, v180
v_lshl_or_b32 v218, v183, 16, v182
v_lshl_or_b32 v219, v185, 16, v184
ds_write_b128 v9, v[216:219] offset:24960
v_lshl_or_b32 v220, v180, 16, v179
v_lshl_or_b32 v221, v182, 16, v181
v_lshl_or_b32 v222, v184, 16, v183
v_lshl_or_b32 v223, v186, 16, v185
ds_write_b128 v9, v[220:223] offset:29120
v_mov_b32 v40, 0
v_mov_b32 v41, 0
v_mov_b32 v42, 0
v_mov_b32 v43, 0
ds_write_b128 v36, v[40:43] offset:33280
ds_write_b128 v37, v[40:43] offset:35328
s_waitcnt vmcnt(6)
v_lshlrev_b32 v140, 16, v112
v_and_b32 v141, 0xffff0000, v112
v_lshlrev_b32 v142, 16, v113
v_and_b32 v143, 0xffff0000, v113
v_lshlrev_b32 v144, 16, v114
v_and_b32 v145, 0xffff0000, v114
s_add_u32 m0, s95, 0
s_add_u32 s58, s43, 630784
buffer_load_dwordx4 v31, s[4:7], s58 offen lds
s_add_u32 m0, s95, 4224
s_add_u32 s58, s43, 688128
buffer_load_dwordx4 v31, s[4:7], s58 offen lds
v_lshlrev_b32 v146, 16, v115
v_and_b32 v147, 0xffff0000, v115
v_sub_f32 v140, v140, v104
v_sub_f32 v141, v141, v106
v_sub_f32 v142, v142, v108
v_sub_f32 v143, v143, v110
s_add_u32 m0, s95, 8448
s_add_u32 s58, s43, 745472
buffer_load_dwordx4 v31, s[4:7], s58 offen lds
s_add_u32 m0, s95, 12672
s_add_u32 s58, s43, 802816
buffer_load_dwordx4 v31, s[4:7], s58 offen lds
v_sub_f32 v144, v144, v104
v_sub_f32 v145, v145, v106
v_sub_f32 v146, v146, v108
v_sub_f32 v147, v147, v110
v_mul_f32 v140, v140, v105
v_mul_f32 v141, v141, v107
s_add_u32 m0, s95, 16896
s_add_u32 s58, s43, 860160
buffer_load_dwordx4 v31, s[4:7], s58 offen lds
s_add_u32 m0, s95, 21120
s_add_u32 s58, s43, 917504
buffer_load_dwordx4 v31, s[4:7], s58 offen lds
v_mul_f32 v142, v142, v109
v_mul_f32 v143, v143, v111
v_mul_f32 v144, v144, v105
v_mul_f32 v145, v145, v107
v_mul_f32 v146, v146, v109
v_mul_f32 v147, v147, v111
s_add_u32 m0, s95, 25344
s_add_u32 s58, s43, 974848
buffer_load_dwordx4 v31, s[4:7], s58 offen lds
s_add_u32 m0, s95, 29568
s_add_u32 s58, s43, 1032192
buffer_load_dwordx4 v31, s[4:7], s58 offen lds
v_cvt_pk_bf16_f32 v140, v140, v141
v_cvt_pk_bf16_f32 v142, v142, v143
v_cvt_pk_bf16_f32 v144, v144, v145
v_cvt_pk_bf16_f32 v146, v146, v147
ds_write_b32 v8, v112 offset:48640
ds_write_b32 v8, v140 offset:35840
s_add_u32 m0, s95, 33792
s_add_u32 s58, s43, 1089536
buffer_load_dwordx4 v31, s[4:7], s58 offen lds
ds_write_b32 v8, v113 offset:49920
ds_write_b32 v8, v142 offset:37120
ds_write_b32 v8, v114 offset:53760
ds_write_b32 v8, v144 offset:43520
ds_write_b32 v8, v115 offset:55040
ds_write_b32 v8, v146 offset:44800
s_waitcnt lgkmcnt(0)
s_barrier
s_add_u32 s64, s56, 98304
buffer_load_dword v34, v2, s[8:11], s64 offen sc1
ds_read_b128 v[72:75], v7 offset:1200
ds_read_b64 v[76:77], v6 offset:3008
ds_read_b64 v[78:79], v6 offset:3016
ds_read_b128 v[80:83], v7 offset:1232
ds_read_b64 v[84:85], v6 offset:3040
ds_read_b64 v[86:87], v6 offset:3048
ds_read_b128 v[88:91], v7 offset:1120
ds_read_b64 v[92:93], v6 offset:2944
ds_read_b64 v[94:95], v6 offset:2952
ds_read_b128 v[96:99], v7 offset:1152
ds_read_b64 v[100:101], v6 offset:2976
ds_read_b64 v[102:103], v6 offset:2984
s_waitcnt lgkmcnt(9)
v_mfma_f32_32x32x16_bf16 v[40:55], v[76:79], v[72:75], 0
v_add_u32 v150, s84, v22
v_add_u32 v151, s85, v22
ds_read_b128 v[104:107], v7 offset:1040
ds_read_b64 v[108:109], v6 offset:2880
ds_read_b64 v[110:111], v6 offset:2888
s_waitcnt lgkmcnt(9)
v_mfma_f32_32x32x16_bf16 v[40:55], v[84:87], v[80:83], v[40:55]
ds_read_b64 v[140:141], v11 offset:0
ds_read_b64 v[144:145], v33 offset:0
ds_read_b128 v[72:75], v7 offset:1072
ds_read_b64 v[76:77], v6 offset:2912
ds_read_b64 v[78:79], v6 offset:2920
s_waitcnt lgkmcnt(11)
v_mfma_f32_32x32x16_bf16 v[40:55], v[92:95], v[88:91], v[40:55]
ds_read_b64 v[142:143], v11 offset:16
ds_read_b64 v[146:147], v33 offset:16
ds_read_b128 v[80:83], v7 offset:960
ds_read_b64 v[84:85], v6 offset:2816
ds_read_b64 v[86:87], v6 offset:2824
s_waitcnt lgkmcnt(13)
v_mfma_f32_32x32x16_bf16 v[40:55], v[100:103], v[96:99], v[40:55]
ds_read_b128 v[88:91], v7 offset:992
ds_read_b64 v[92:93], v6 offset:2848
ds_read_b64 v[94:95], v6 offset:2856
s_waitcnt lgkmcnt(13)
v_mfma_f32_32x32x16_bf16 v[40:55], v[108:111], v[104:107], v[40:55]
ds_read_b128 v[96:99], v7 offset:880
ds_read_b64 v[100:101], v6 offset:2752
ds_read_b64 v[102:103], v6 offset:2760
s_waitcnt lgkmcnt(11)
v_mfma_f32_32x32x16_bf16 v[40:55], v[76:79], v[72:75], v[40:55]
s_waitcnt lgkmcnt(9)
v_lshlrev_b32 v132, 16, v144
v_and_b32 v133, 0xffff0000, v144
ds_read_b128 v[104:107], v7 offset:912
ds_read_b64 v[108:109], v6 offset:2784
ds_read_b64 v[110:111], v6 offset:2792
s_waitcnt lgkmcnt(9)
v_mfma_f32_32x32x16_bf16 v[40:55], v[84:87], v[80:83], v[40:55]
v_lshlrev_b32 v134, 16, v145
v_and_b32 v135, 0xffff0000, v145
ds_read_b128 v[72:75], v7 offset:800
ds_read_b64 v[76:77], v6 offset:2688
ds_read_b64 v[78:79], v6 offset:2696
s_waitcnt lgkmcnt(9)
v_mfma_f32_32x32x16_bf16 v[40:55], v[92:95], v[88:91], v[40:55]
v_lshlrev_b32 v136, 16, v146
v_and_b32 v137, 0xffff0000, v146
ds_read_b128 v[80:83], v7 offset:832
ds_read_b64 v[84:85], v6 offset:2720
ds_read_b64 v[86:87], v6 offset:2728
s_waitcnt lgkmcnt(9)
v_mfma_f32_32x32x16_bf16 v[40:55], v[100:103], v[96:99], v[40:55]
s_waitcnt vmcnt(1)
s_waitcnt vmcnt(0)
v_cmp_gt_u32 vcc, s57, v34
s_cbranch_vccz Lsd_13
s_mov_b32 s80, 0
Lsq_14:
buffer_load_dword v34, v2, s[8:11], s64 offen sc1
s_add_u32 s80, s80, 1
s_cmp_lt_u32 s80, 0x8000
s_cbranch_scc0 Lsd_13
s_waitcnt vmcnt(0)
v_cmp_gt_u32 vcc, s57, v34
s_nop 1
s_cbranch_vccnz Lsq_14
Lsd_13:
s_barrier
v_mul_u32_u24 v116, 37, v1
v_lshrrev_b32 v116, 8, v116
v_mul_u32_u24 v117, 7, v116
v_sub_u32 v117, v1, v117
v_mul_u32_u24 v116, 3584, v116
v_lshl_add_u32 v116, v117, 7, v116
s_lshl_b32 s59, s41, 1
s_add_u32 s59, s59, s30
s_mul_i32 s59, s59, 10752
s_mul_i32 s58, s54, 896
s_add_u32 s59, s59, s58
s_add_u32 s59, s59, 1146880
s_mov_b64 exec, 2097151
buffer_load_dword v156, v116, s[4:7], s59 offen
s_mov_b64 exec, -1
v_lshlrev_b32 v138, 16, v147
v_and_b32 v139, 0xffff0000, v147
ds_read_b128 v[88:91], v7 offset:720
ds_read_b64 v[92:93], v6 offset:2624
ds_read_b64 v[94:95], v6 offset:2632
s_waitcnt lgkmcnt(9)
v_mfma_f32_32x32x16_bf16 v[40:55], v[108:111], v[104:107], v[40:55]
s_add_u32 s58, s44, 0
buffer_load_dwordx4 a[128:131], v30, s[8:11], s58 offen sc1
v_lshlrev_b32 v144, 16, v140
v_lshlrev_b32 v145, 16, v141
ds_read_b128 v[96:99], v7 offset:752
ds_read_b64 v[100:101], v6 offset:2656
ds_read_b64 v[102:103], v6 offset:2664
s_waitcnt lgkmcnt(9)
v_mfma_f32_32x32x16_bf16 v[40:55], v[76:79], v[72:75], v[40:55]
v_lshlrev_b32 v146, 16, v142
v_lshlrev_b32 v147, 16, v143
ds_read_b128 v[104:107], v7 offset:640
ds_read_b64 v[108:109], v6 offset:2560
ds_read_b64 v[110:111], v6 offset:2568
s_waitcnt lgkmcnt(9)
v_mfma_f32_32x32x16_bf16 v[40:55], v[84:87], v[80:83], v[40:55]
v_and_b32 v140, 0xffff0000, v140
v_and_b32 v141, 0xffff0000, v141
ds_read_b128 v[72:75], v7 offset:672
ds_read_b64 v[76:77], v6 offset:2592
ds_read_b64 v[78:79], v6 offset:2600
s_waitcnt lgkmcnt(9)
v_mfma_f32_32x32x16_bf16 v[40:55], v[92:95], v[88:91], v[40:55]
s_add_u32 s58, s91, 0
buffer_load_dwordx4 a[132:135], v30, s[8:11], s58 offen sc1
v_and_b32 v142, 0xffff0000, v142
v_and_b32 v143, 0xffff0000, v143
ds_read_b128 v[80:83], v7 offset:560
ds_read_b64 v[84:85], v6 offset:2496
ds_read_b64 v[86:87], v6 offset:2504
s_waitcnt lgkmcnt(9)
v_mfma_f32_32x32x16_bf16 v[40:55], v[100:103], v[96:99], v[40:55]
v_fmac_f32 v132, v144, v5
v_fmac_f32 v133, v140, v5
ds_read_b128 v[88:91], v7 offset:592
ds_read_b64 v[92:93], v6 offset:2528
ds_read_b64 v[94:95], v6 offset:2536
s_waitcnt lgkmcnt(9)
v_mfma_f32_32x32x16_bf16 v[40:55], v[108:111], v[104:107], v[40:55]
v_fmac_f32 v134, v145, v5
v_fmac_f32 v135, v141, v5
ds_read_b128 v[96:99], v7 offset:480
ds_read_b64 v[100:101], v6 offset:2432
ds_read_b64 v[102:103], v6 offset:2440
s_waitcnt lgkmcnt(9)
v_mfma_f32_32x32x16_bf16 v[40:55], v[76:79], v[72:75], v[40:55]
s_add_u32 s58, s44, 2048
buffer_load_dwordx4 a[136:139], v30, s[8:11], s58 offen sc1
v_fmac_f32 v136, v146, v5
v_fmac_f32 v137, v142, v5
ds_read_b128 v[104:107], v7 offset:512
ds_read_b64 v[108:109], v6 offset:2464
ds_read_b64 v[110:111], v6 offset:2472
s_waitcnt lgkmcnt(9)
v_mfma_f32_32x32x16_bf16 v[40:55], v[84:87], v[80:83], v[40:55]
v_fmac_f32 v138, v147, v5
v_fmac_f32 v139, v143, v5
ds_read_b128 v[72:75], v7 offset:400
ds_read_b64 v[76:77], v6 offset:2368
ds_read_b64 v[78:79], v6 offset:2376
s_waitcnt lgkmcnt(9)
v_mfma_f32_32x32x16_bf16 v[40:55], v[92:95], v[88:91], v[40:55]
ds_read_b64_tr_b16 a[0:1], v159 offset:0
ds_read_b64_tr_b16 a[2:3], v159 offset:128
ds_read_b128 v[80:83], v7 offset:432
ds_read_b64 v[84:85], v6 offset:2400
ds_read_b64 v[86:87], v6 offset:2408
s_waitcnt lgkmcnt(11)
v_mfma_f32_32x32x16_bf16 v[40:55], v[100:103], v[96:99], v[40:55]
s_add_u32 s58, s91, 2048
buffer_load_dwordx4 a[140:143], v30, s[8:11], s58 offen sc1
ds_read_b64_tr_b16 a[4:5], v159 offset:4224
ds_read_b64_tr_b16 a[6:7], v159 offset:4352
ds_read_b128 v[88:91], v7 offset:320
ds_read_b64 v[92:93], v6 offset:2304
ds_read_b64 v[94:95], v6 offset:2312
s_waitcnt lgkmcnt(13)
v_mfma_f32_32x32x16_bf16 v[40:55], v[108:111], v[104:107], v[40:55]
ds_read_b64_tr_b16 a[8:9], v159 offset:8448
ds_read_b64_tr_b16 a[10:11], v159 offset:8576
ds_read_b128 v[96:99], v7 offset:352
ds_read_b64 v[100:101], v6 offset:2336
ds_read_b64 v[102:103], v6 offset:2344
s_waitcnt lgkmcnt(15)
v_mfma_f32_32x32x16_bf16 v[40:55], v[76:79], v[72:75], v[40:55]
ds_read_b64_tr_b16 a[12:13], v159 offset:12672
ds_read_b64_tr_b16 a[14:15], v159 offset:12800
ds_read_b128 v[104:107], v7 offset:240
ds_read_b64 v[108:109], v6 offset:2240
ds_read_b64 v[110:111], v6 offset:2248
s_waitcnt lgkmcnt(15)
v_mfma_f32_32x32x16_bf16 v[40:55], v[84:87], v[80:83], v[40:55]
s_add_u32 s58, s44, 4096
buffer_load_dwordx4 a[144:147], v30, s[8:11], s58 offen sc1
ds_read_b64_tr_b16 a[16:17], v159 offset:16896
ds_read_b64_tr_b16 a[18:19], v159 offset:17024
ds_read_b128 v[72:75], v7 offset:272
ds_read_b64 v[76:77], v6 offset:2272
ds_read_b64 v[78:79], v6 offset:2280
s_waitcnt lgkmcnt(15)
v_mfma_f32_32x32x16_bf16 v[40:55], v[92:95], v[88:91], v[40:55]
ds_read_b64_tr_b16 a[20:21], v159 offset:21120
ds_read_b64_tr_b16 a[22:23], v159 offset:21248
ds_read_b128 v[80:83], v7 offset:160
ds_read_b64 v[84:85], v6 offset:2176
ds_read_b64 v[86:87], v6 offset:2184
s_waitcnt lgkmcnt(15)
v_mfma_f32_32x32x16_bf16 v[40:55], v[100:103], v[96:99], v[40:55]
ds_read_b64_tr_b16 a[24:25], v159 offset:25344
ds_read_b64_tr_b16 a[26:27], v159 offset:25472
ds_read_b128 v[88:91], v7 offset:192
ds_read_b64 v[92:93], v6 offset:2208
ds_read_b64 v[94:95], v6 offset:2216
s_waitcnt lgkmcnt(15)
v_mfma_f32_32x32x16_bf16 v[40:55], v[108:111], v[104:107], v[40:55]
s_add_u32 s58, s91, 4096
buffer_load_dwordx4 a[148:151], v30, s[8:11], s58 offen sc1
ds_read_b64_tr_b16 a[28:29], v159 offset:29568
ds_read_b64_tr_b16 a[30:31], v159 offset:29696
ds_read_b128 v[96:99], v7 offset:80
ds_read_b64 v[100:101], v6 offset:2112
ds_read_b64 v[102:103], v6 offset:2120
s_waitcnt lgkmcnt(15)
v_mfma_f32_32x32x16_bf16 v[40:55], v[76:79], v[72:75], v[40:55]
ds_read_b64_tr_b16 a[32:33], v159 offset:33792
ds_read_b64_tr_b16 a[34:35], v159 offset:33920
ds_read_b128 v[104:107], v7 offset:112
ds_read_b64 v[108:109], v6 offset:2144
ds_read_b64 v[110:111], v6 offset:2152
s_waitcnt lgkmcnt(15)
v_mfma_f32_32x32x16_bf16 v[40:55], v[84:87], v[80:83], v[40:55]
ds_read_b64_tr_b16 a[36:37], v159 offset:38016
ds_read_b64_tr_b16 a[38:39], v159 offset:38144
ds_read_b128 v[72:75], v7 offset:0
ds_read_b64 v[76:77], v6 offset:2048
ds_read_b64 v[78:79], v6 offset:2056
s_waitcnt lgkmcnt(15)
v_mfma_f32_32x32x16_bf16 v[40:55], v[92:95], v[88:91], v[40:55]
s_add_u32 s58, s44, 6144
buffer_load_dwordx4 a[152:155], v30, s[8:11], s58 offen sc1
ds_read_b64_tr_b16 a[40:41], v159 offset:42240
ds_read_b64_tr_b16 a[42:43], v159 offset:42368
ds_read_b128 v[80:83], v7 offset:32
ds_read_b64 v[84:85], v6 offset:2080
ds_read_b64 v[86:87], v6 offset:2088
s_waitcnt lgkmcnt(15)
v_mfma_f32_32x32x16_bf16 v[40:55], v[100:103], v[96:99], v[40:55]
ds_read_b64_tr_b16 a[44:45], v158 offset:0
ds_read_b64_tr_b16 a[46:47], v158 offset:128
s_waitcnt lgkmcnt(12)
v_mfma_f32_32x32x16_bf16 v[40:55], v[108:111], v[104:107], v[40:55]
ds_read_b64_tr_b16 a[48:49], v158 offset:4224
ds_read_b64_tr_b16 a[50:51], v158 offset:4352
s_waitcnt lgkmcnt(9)
v_mfma_f32_32x32x16_bf16 v[40:55], v[76:79], v[72:75], v[40:55]
s_add_u32 s58, s91, 6144
buffer_load_dwordx4 a[156:159], v30, s[8:11], s58 offen sc1
ds_read_b64_tr_b16 a[52:53], v158 offset:8448
ds_read_b64_tr_b16 a[54:55], v158 offset:8576
s_waitcnt lgkmcnt(6)
v_mfma_f32_32x32x16_bf16 v[40:55], v[84:87], v[80:83], v[40:55]
ds_read_b64_tr_b16 a[56:57], v158 offset:12672
ds_read_b64_tr_b16 a[58:59], v158 offset:12800
ds_read_b64_tr_b16 a[60:61], v158 offset:16896
ds_read_b64_tr_b16 a[62:63], v158 offset:17024
ds_read_b64_tr_b16 a[64:65], v158 offset:21120
ds_read_b64_tr_b16 a[66:67], v158 offset:21248
ds_read_b64_tr_b16 a[68:69], v158 offset:25344
ds_read_b64_tr_b16 a[70:71], v158 offset:25472
ds_read_b64_tr_b16 a[72:73], v158 offset:29568
ds_read_b64_tr_b16 a[74:75], v158 offset:29696
ds_read_b64_tr_b16 a[76:77], v158 offset:33792
ds_read_b64_tr_b16 a[78:79], v158 offset:33920
ds_read_b128 v[72:75], v7 offset:1200
ds_read_b64 v[76:77], v6 offset:960
ds_read_b64 v[78:79], v6 offset:968
ds_read_b128 v[80:83], v7 offset:1232
ds_read_b64 v[84:85], v6 offset:992
ds_read_b64 v[86:87], v6 offset:1000
ds_read_b128 v[88:91], v7 offset:1120
ds_read_b64 v[92:93], v6 offset:896
ds_read_b64 v[94:95], v6 offset:904
ds_read_b128 v[96:99], v7 offset:1152
ds_read_b64 v[100:101], v6 offset:928
ds_read_b64 v[102:103], v6 offset:936
s_waitcnt lgkmcnt(9)
v_mfma_f32_32x32x16_bf16 v[56:71], v[76:79], v[72:75], 0
ds_read_b128 v[104:107], v7 offset:1040
ds_read_b64 v[108:109], v6 offset:832
ds_read_b64 v[110:111], v6 offset:840
s_waitcnt lgkmcnt(9)
v_mfma_f32_32x32x16_bf16 v[56:71], v[84:87], v[80:83], v[56:71]
ds_write_b128 v150, v[48:51]
ds_write_b128 v150, v[52:55] offset:1024
v_add_f32 v132, v132, v40
v_add_f32 v133, v133, v41
v_add_f32 v134, v134, v42
v_add_f32 v135, v135, v43
v_add_f32 v136, v136, v44
v_add_f32 v137, v137, v45
v_add_f32 v138, v138, v46
v_add_f32 v139, v139, v47
s_add_u32 s67, s90, 4194304
s_waitcnt lgkmcnt(0)
s_barrier
ds_read_b128 v[112:115], v151
ds_read_b128 v[116:119], v151 offset:1024
ds_read_b128 v[72:75], v7 offset:1072
ds_read_b64 v[76:77], v6 offset:864
ds_read_b64 v[78:79], v6 offset:872
v_mfma_f32_32x32x16_bf16 v[56:71], v[92:95], v[88:91], v[56:71]
ds_read_b128 v[80:83], v7 offset:960
ds_read_b64 v[84:85], v6 offset:768
ds_read_b64 v[86:87], v6 offset:776
v_mfma_f32_32x32x16_bf16 v[56:71], v[100:103], v[96:99], v[56:71]
s_waitcnt lgkmcnt(6)
v_add_f32 v132, v132, v112
v_add_f32 v133, v133, v113
v_add_f32 v134, v134, v114
v_add_f32 v135, v135, v115
v_add_f32 v136, v136, v116
v_add_f32 v137, v137, v117
v_add_f32 v138, v138, v118
v_add_f32 v139, v139, v119
v_cvt_pk_bf16_f32 v140, v132, v133
v_cvt_pk_bf16_f32 v141, v134, v135
v_cvt_pk_bf16_f32 v142, v136, v137
v_cvt_pk_bf16_f32 v143, v138, v139
ds_write_b64 v33, v[140:141] offset:0
ds_write_b64 v33, v[142:143] offset:16
ds_read_b128 v[88:91], v7 offset:992
ds_read_b64 v[92:93], v6 offset:800
ds_read_b64 v[94:95], v6 offset:808
v_mfma_f32_32x32x16_bf16 v[56:71], v[108:111], v[104:107], v[56:71]
s_waitcnt lgkmcnt(3)
s_barrier
ds_read_b128 v[112:115], v12 offset:0
ds_read_b128 v[96:99], v7 offset:880
ds_read_b64 v[100:101], v6 offset:704
ds_read_b64 v[102:103], v6 offset:712
v_mfma_f32_32x32x16_bf16 v[56:71], v[76:79], v[72:75], v[56:71]
ds_read_b128 v[104:107], v7 offset:912
ds_read_b64 v[108:109], v6 offset:736
ds_read_b64 v[110:111], v6 offset:744
v_mfma_f32_32x32x16_bf16 v[56:71], v[84:87], v[80:83], v[56:71]
s_waitcnt lgkmcnt(6)
buffer_store_dwordx4 v[112:115], v22, s[8:11], s67 offen sc1
ds_read_b128 v[72:75], v7 offset:800
ds_read_b64 v[76:77], v6 offset:640
ds_read_b64 v[78:79], v6 offset:648
v_mfma_f32_32x32x16_bf16 v[56:71], v[92:95], v[88:91], v[56:71]
v_lshlrev_b32 v140, 16, v128
v_and_b32 v141, 0xffff0000, v128
v_lshlrev_b32 v142, 16, v129
ds_read_b128 v[80:83], v7 offset:832
ds_read_b64 v[84:85], v6 offset:672
ds_read_b64 v[86:87], v6 offset:680
s_waitcnt lgkmcnt(9)
v_mfma_f32_32x32x16_bf16 v[56:71], v[100:103], v[96:99], v[56:71]
s_add_u32 m0, s95, 38400
s_add_u32 s58, s43, 1146880
buffer_load_dwordx4 v31, s[4:7], s58 offen lds
v_and_b32 v143, 0xffff0000, v129
v_lshlrev_b32 v144, 16, v130
v_and_b32 v145, 0xffff0000, v130
s_add_u32 m0, s95, 42624
s_add_u32 s58, s43, 1204224
buffer_load_dwordx4 v31, s[4:7], s58 offen lds
s_add_u32 m0, s95, 46848
s_add_u32 s58, s43, 1261568
buffer_load_dwordx4 v31, s[4:7], s58 offen lds
ds_read_b128 v[88:91], v7 offset:720
ds_read_b64 v[92:93], v6 offset:576
ds_read_b64 v[94:95], v6 offset:584
s_waitcnt lgkmcnt(9)
v_mfma_f32_32x32x16_bf16 v[56:71], v[108:111], v[104:107], v[56:71]
v_lshlrev_b32 v146, 16, v131
v_and_b32 v147, 0xffff0000, v131
v_sub_f32 v140, v140, v120
ds_read_b128 v[96:99], v7 offset:752
ds_read_b64 v[100:101], v6 offset:608
ds_read_b64 v[102:103], v6 offset:616
s_waitcnt lgkmcnt(9)
v_mfma_f32_32x32x16_bf16 v[56:71], v[76:79], v[72:75], v[56:71]
s_add_u32 m0, s95, 51072
s_add_u32 s58, s43, 1318912
buffer_load_dwordx4 v31, s[4:7], s58 offen lds
v_sub_f32 v141, v141, v122
v_sub_f32 v142, v142, v124
v_sub_f32 v143, v143, v126
s_add_u32 m0, s95, 55296
s_add_u32 s58, s43, 1376256
buffer_load_dwordx4 v31, s[4:7], s58 offen lds
s_add_u32 m0, s95, 59520
s_add_u32 s58, s43, 1433600
buffer_load_dwordx4 v31, s[4:7], s58 offen lds
ds_read_b128 v[104:107], v7 offset:640
ds_read_b64 v[108:109], v6 offset:512
ds_read_b64 v[110:111], v6 offset:520
s_waitcnt lgkmcnt(9)
v_mfma_f32_32x32x16_bf16 v[56:71], v[84:87], v[80:83], v[56:71]
v_sub_f32 v144, v144, v120
v_sub_f32 v145, v145, v122
v_sub_f32 v146, v146, v124
ds_read_b128 v[72:75], v7 offset:672
ds_read_b64 v[76:77], v6 offset:544
ds_read_b64 v[78:79], v6 offset:552
s_waitcnt lgkmcnt(9)
v_mfma_f32_32x32x16_bf16 v[56:71], v[92:95], v[88:91], v[56:71]
s_add_u32 m0, s95, 63744
s_add_u32 s58, s43, 1490944
buffer_load_dwordx4 v31, s[4:7], s58 offen lds
v_sub_f32 v147, v147, v126
v_mul_f32 v140, v140, v121
v_mul_f32 v141, v141, v123
s_add_u32 m0, s95, 67968
s_add_u32 s58, s43, 1548288
buffer_load_dwordx4 v31, s[4:7], s58 offen lds
s_add_u32 m0, s95, 72192
s_add_u32 s58, s43, 1605632
buffer_load_dwordx4 v31, s[4:7], s58 offen lds
ds_read_b128 v[80:83], v7 offset:560
ds_read_b64 v[84:85], v6 offset:448
ds_read_b64 v[86:87], v6 offset:456
s_waitcnt lgkmcnt(9)
v_mfma_f32_32x32x16_bf16 v[56:71], v[100:103], v[96:99], v[56:71]
v_mul_f32 v142, v142, v125
v_mul_f32 v143, v143, v127
v_mul_f32 v144, v144, v121
ds_read_b128 v[88:91], v7 offset:592
ds_read_b64 v[92:93], v6 offset:480
ds_read_b64 v[94:95], v6 offset:488
s_waitcnt lgkmcnt(9)
v_mfma_f32_32x32x16_bf16 v[56:71], v[108:111], v[104:107], v[56:71]
s_add_u32 m0, s95, 76416
s_add_u32 s58, s43, 1662976
buffer_load_dwordx4 v31, s[4:7], s58 offen lds
v_mul_f32 v145, v145, v123
v_mul_f32 v146, v146, v125
v_mul_f32 v147, v147, v127
s_add_u32 m0, s95, 80640
s_add_u32 s58, s43, 1720320
buffer_load_dwordx4 v31, s[4:7], s58 offen lds
s_add_u32 m0, s95, 84864
s_add_u32 s58, s43, 1777664
buffer_load_dwordx4 v31, s[4:7], s58 offen lds
ds_read_b128 v[96:99], v7 offset:480
ds_read_b64 v[100:101], v6 offset:384
ds_read_b64 v[102:103], v6 offset:392
s_waitcnt lgkmcnt(9)
v_mfma_f32_32x32x16_bf16 v[56:71], v[76:79], v[72:75], v[56:71]
v_cvt_pk_bf16_f32 v140, v140, v141
v_cvt_pk_bf16_f32 v142, v142, v143
v_cvt_pk_bf16_f32 v144, v144, v145
ds_read_b128 v[104:107], v7 offset:512
ds_read_b64 v[108:109], v6 offset:416
ds_read_b64 v[110:111], v6 offset:424
s_waitcnt lgkmcnt(9)
v_mfma_f32_32x32x16_bf16 v[56:71], v[84:87], v[80:83], v[56:71]
s_add_u32 s58, s44, 8192
buffer_load_dwordx4 a[160:163], v30, s[8:11], s58 offen sc1
v_cvt_pk_bf16_f32 v146, v146, v147
ds_write_b32 v8, v128 offset:51200
ds_write_b32 v8, v140 offset:38400
s_add_u32 s58, s91, 8192
buffer_load_dwordx4 a[164:167], v30, s[8:11], s58 offen sc1
s_add_u32 s58, s44, 10240
buffer_load_dwordx4 a[168:171], v30, s[8:11], s58 offen sc1
ds_read_b128 v[72:75], v7 offset:400
ds_read_b64 v[76:77], v6 offset:320
ds_read_b64 v[78:79], v6 offset:328
s_waitcnt lgkmcnt(11)
v_mfma_f32_32x32x16_bf16 v[56:71], v[92:95], v[88:91], v[56:71]
ds_write_b32 v8, v129 offset:52480
ds_write_b32 v8, v142 offset:39680
ds_write_b32 v8, v130 offset:56320
ds_read_b128 v[80:83], v7 offset:432
ds_read_b64 v[84:85], v6 offset:352
ds_read_b64 v[86:87], v6 offset:360
s_waitcnt lgkmcnt(14)
v_mfma_f32_32x32x16_bf16 v[56:71], v[100:103], v[96:99], v[56:71]
s_add_u32 s58, s91, 10240
buffer_load_dwordx4 a[172:175], v30, s[8:11], s58 offen sc1
s_waitcnt vmcnt(16)
s_barrier
s_add_u32 s63, s56, 0
s_mov_b64 exec, 255
buffer_atomic_add v35, v3, s[8:11], s63 offen sc1
s_mov_b64 exec, -1
ds_write_b32 v8, v144 offset:46080
ds_write_b32 v8, v131 offset:57600
ds_write_b32 v8, v146 offset:47360
s_add_u32 s58, s44, 12288
buffer_load_dwordx4 a[176:179], v30, s[8:11], s58 offen sc1
s_add_u32 s58, s91, 12288
buffer_load_dwordx4 a[180:183], v30, s[8:11], s58 offen sc1
ds_read_b128 v[88:91], v7 offset:320
ds_read_b64 v[92:93], v6 offset:256
ds_read_b64 v[94:95], v6 offset:264
s_waitcnt lgkmcnt(15)
v_mfma_f32_32x32x16_bf16 v[56:71], v[108:111], v[104:107], v[56:71]
ds_read_b128 v[96:99], v7 offset:352
ds_read_b64 v[100:101], v6 offset:288
ds_read_b64 v[102:103], v6 offset:296
s_waitcnt lgkmcnt(15)
v_mfma_f32_32x32x16_bf16 v[56:71], v[76:79], v[72:75], v[56:71]
s_add_u32 s58, s44, 14336
buffer_load_dwordx4 a[184:187], v30, s[8:11], s58 offen sc1
ds_read_b128 v[104:107], v7 offset:240
ds_read_b64 v[108:109], v6 offset:192
ds_read_b64 v[110:111], v6 offset:200
s_waitcnt lgkmcnt(12)
v_mfma_f32_32x32x16_bf16 v[56:71], v[84:87], v[80:83], v[56:71]
ds_read_b128 v[72:75], v7 offset:272
ds_read_b64 v[76:77], v6 offset:224
ds_read_b64 v[78:79], v6 offset:232
s_waitcnt lgkmcnt(9)
v_mfma_f32_32x32x16_bf16 v[56:71], v[92:95], v[88:91], v[56:71]
s_add_u32 s58, s91, 14336
buffer_load_dwordx4 a[188:191], v30, s[8:11], s58 offen sc1
ds_read_b128 v[80:83], v7 offset:160
ds_read_b64 v[84:85], v6 offset:128
ds_read_b64 v[86:87], v6 offset:136
s_waitcnt lgkmcnt(9)
v_mfma_f32_32x32x16_bf16 v[56:71], v[100:103], v[96:99], v[56:71]
ds_read_b128 v[88:91], v7 offset:192
ds_read_b64 v[92:93], v6 offset:160
ds_read_b64 v[94:95], v6 offset:168
s_waitcnt lgkmcnt(9)
v_mfma_f32_32x32x16_bf16 v[56:71], v[108:111], v[104:107], v[56:71]
s_add_u32 s58, s44, 16384
buffer_load_dwordx4 a[192:195], v30, s[8:11], s58 offen sc1
ds_read_b128 v[96:99], v7 offset:80
ds_read_b64 v[100:101], v6 offset:64
ds_read_b64 v[102:103], v6 offset:72
s_waitcnt lgkmcnt(9)
v_mfma_f32_32x32x16_bf16 v[56:71], v[76:79], v[72:75], v[56:71]
ds_read_b128 v[104:107], v7 offset:112
ds_read_b64 v[108:109], v6 offset:96
ds_read_b64 v[110:111], v6 offset:104
s_waitcnt lgkmcnt(9)
v_mfma_f32_32x32x16_bf16 v[56:71], v[84:87], v[80:83], v[56:71]
s_add_u32 s58, s91, 16384
buffer_load_dwordx4 a[196:199], v30, s[8:11], s58 offen sc1
ds_read_b128 v[72:75], v7 offset:0
ds_read_b64 v[76:77], v6 offset:0
ds_read_b64 v[78:79], v6 offset:8
s_waitcnt lgkmcnt(9)
v_mfma_f32_32x32x16_bf16 v[56:71], v[92:95], v[88:91], v[56:71]
ds_read_b128 v[80:83], v7 offset:32
ds_read_b64 v[84:85], v6 offset:32
ds_read_b64 v[86:87], v6 offset:40
s_waitcnt lgkmcnt(9)
v_mfma_f32_32x32x16_bf16 v[56:71], v[100:103], v[96:99], v[56:71]
s_add_u32 s58, s44, 18432
buffer_load_dwordx4 a[200:203], v30, s[8:11], s58 offen sc1
s_waitcnt lgkmcnt(6)
v_mfma_f32_32x32x16_bf16 v[56:71], v[108:111], v[104:107], v[56:71]
s_waitcnt lgkmcnt(3)
v_mfma_f32_32x32x16_bf16 v[56:71], v[76:79], v[72:75], v[56:71]
s_add_u32 s58, s91, 18432
buffer_load_dwordx4 a[204:207], v30, s[8:11], s58 offen sc1
s_waitcnt lgkmcnt(0)
v_mfma_f32_32x32x16_bf16 v[56:71], v[84:87], v[80:83], v[56:71]
s_waitcnt lgkmcnt(0)
s_barrier
ds_read_b128 v[72:75], v7 offset:3760
ds_read_b64 v[76:77], v6 offset:3008
ds_read_b64 v[78:79], v6 offset:3016
ds_read_b128 v[80:83], v7 offset:3792
ds_read_b64 v[84:85], v6 offset:3040
ds_read_b64 v[86:87], v6 offset:3048
ds_read_b128 v[88:91], v7 offset:3680
ds_read_b64 v[92:93], v6 offset:2944
ds_read_b64 v[94:95], v6 offset:2952
ds_read_b128 v[96:99], v7 offset:3712
ds_read_b64 v[100:101], v6 offset:2976
ds_read_b64 v[102:103], v6 offset:2984
s_waitcnt lgkmcnt(9)
v_mfma_f32_32x32x16_bf16 v[56:71], v[76:79], v[72:75], v[56:71]
s_add_u32 s58, s44, 20480
buffer_load_dwordx4 a[208:211], v30, s[8:11], s58 offen sc1
v_add_u32 v150, s84, v22
v_add_u32 v151, s85, v22
ds_read_b128 v[104:107], v7 offset:3600
ds_read_b64 v[108:109], v6 offset:2880
ds_read_b64 v[110:111], v6 offset:2888
s_waitcnt lgkmcnt(9)
v_mfma_f32_32x32x16_bf16 v[56:71], v[84:87], v[80:83], v[56:71]
ds_read_b64 v[140:141], v11 offset:2560
ds_read_b64 v[144:145], v33 offset:2560
ds_read_b128 v[72:75], v7 offset:3632
ds_read_b64 v[76:77], v6 offset:2912
ds_read_b64 v[78:79], v6 offset:2920
s_waitcnt lgkmcnt(11)
v_mfma_f32_32x32x16_bf16 v[56:71], v[92:95], v[88:91], v[56:71]
s_add_u32 s58, s91, 20480
buffer_load_dwordx4 a[212:215], v30, s[8:11], s58 offen sc1
ds_read_b64 v[142:143], v11 offset:2576
ds_read_b64 v[146:147], v33 offset:2576
ds_read_b128 v[80:83], v7 offset:3520
ds_read_b64 v[84:85], v6 offset:2816
ds_read_b64 v[86:87], v6 offset:2824
s_waitcnt lgkmcnt(13)
v_mfma_f32_32x32x16_bf16 v[56:71], v[100:103], v[96:99], v[56:71]
ds_read_b128 v[88:91], v7 offset:3552
ds_read_b64 v[92:93], v6 offset:2848
ds_read_b64 v[94:95], v6 offset:2856
s_waitcnt lgkmcnt(13)
v_mfma_f32_32x32x16_bf16 v[56:71], v[108:111], v[104:107], v[56:71]
s_add_u32 s58, s44, 22528
buffer_load_dwordx4 a[216:219], v30, s[8:11], s58 offen sc1
ds_read_b128 v[96:99], v7 offset:3440
ds_read_b64 v[100:101], v6 offset:2752
ds_read_b64 v[102:103], v6 offset:2760
s_waitcnt lgkmcnt(11)
v_mfma_f32_32x32x16_bf16 v[56:71], v[76:79], v[72:75], v[56:71]
s_waitcnt lgkmcnt(9)
v_lshlrev_b32 v132, 16, v144
v_and_b32 v133, 0xffff0000, v144
ds_read_b128 v[104:107], v7 offset:3472
ds_read_b64 v[108:109], v6 offset:2784
ds_read_b64 v[110:111], v6 offset:2792
s_waitcnt lgkmcnt(9)
v_mfma_f32_32x32x16_bf16 v[56:71], v[84:87], v[80:83], v[56:71]
s_add_u32 s58, s91, 22528
buffer_load_dwordx4 a[220:223], v30, s[8:11], s58 offen sc1
v_lshlrev_b32 v134, 16, v145
v_and_b32 v135, 0xffff0000, v145
ds_read_b128 v[72:75], v7 offset:3360
ds_read_b64 v[76:77], v6 offset:2688
ds_read_b64 v[78:79], v6 offset:2696
s_waitcnt lgkmcnt(9)
v_mfma_f32_32x32x16_bf16 v[56:71], v[92:95], v[88:91], v[56:71]
v_lshlrev_b32 v136, 16, v146
v_and_b32 v137, 0xffff0000, v146
ds_read_b128 v[80:83], v7 offset:3392
ds_read_b64 v[84:85], v6 offset:2720
ds_read_b64 v[86:87], v6 offset:2728
s_waitcnt lgkmcnt(9)
v_mfma_f32_32x32x16_bf16 v[56:71], v[100:103], v[96:99], v[56:71]
s_add_u32 s58, s44, 24576
buffer_load_dwordx4 a[224:227], v30, s[8:11], s58 offen sc1
v_lshlrev_b32 v138, 16, v147
v_and_b32 v139, 0xffff0000, v147
ds_read_b128 v[88:91], v7 offset:3280
ds_read_b64 v[92:93], v6 offset:2624
ds_read_b64 v[94:95], v6 offset:2632
s_waitcnt lgkmcnt(9)
v_mfma_f32_32x32x16_bf16 v[56:71], v[108:111], v[104:107], v[56:71]
v_lshlrev_b32 v144, 16, v140
v_lshlrev_b32 v145, 16, v141
ds_read_b128 v[96:99], v7 offset:3312
ds_read_b64 v[100:101], v6 offset:2656
ds_read_b64 v[102:103], v6 offset:2664
s_waitcnt lgkmcnt(9)
v_mfma_f32_32x32x16_bf16 v[56:71], v[76:79], v[72:75], v[56:71]
s_add_u32 s58, s91, 24576
buffer_load_dwordx4 a[228:231], v30, s[8:11], s58 offen sc1
v_lshlrev_b32 v146, 16, v142
v_lshlrev_b32 v147, 16, v143
ds_read_b128 v[104:107], v7 offset:3200
ds_read_b64 v[108:109], v6 offset:2560
ds_read_b64 v[110:111], v6 offset:2568
s_waitcnt lgkmcnt(9)
v_mfma_f32_32x32x16_bf16 v[56:71], v[84:87], v[80:83], v[56:71]
v_and_b32 v140, 0xffff0000, v140
v_and_b32 v141, 0xffff0000, v141
ds_read_b128 v[72:75], v7 offset:3232
ds_read_b64 v[76:77], v6 offset:2592
ds_read_b64 v[78:79], v6 offset:2600
s_waitcnt lgkmcnt(9)
v_mfma_f32_32x32x16_bf16 v[56:71], v[92:95], v[88:91], v[56:71]
s_add_u32 s58, s44, 26624
buffer_load_dwordx4 a[232:235], v30, s[8:11], s58 offen sc1
v_and_b32 v142, 0xffff0000, v142
v_and_b32 v143, 0xffff0000, v143
ds_read_b128 v[80:83], v7 offset:3120
ds_read_b64 v[84:85], v6 offset:2496
ds_read_b64 v[86:87], v6 offset:2504
s_waitcnt lgkmcnt(9)
v_mfma_f32_32x32x16_bf16 v[56:71], v[100:103], v[96:99], v[56:71]
v_fmac_f32 v132, v144, v5
v_fmac_f32 v133, v140, v5
ds_read_b128 v[88:91], v7 offset:3152
ds_read_b64 v[92:93], v6 offset:2528
ds_read_b64 v[94:95], v6 offset:2536
s_waitcnt lgkmcnt(9)
v_mfma_f32_32x32x16_bf16 v[56:71], v[108:111], v[104:107], v[56:71]
s_add_u32 s58, s91, 26624
buffer_load_dwordx4 a[236:239], v30, s[8:11], s58 offen sc1
v_fmac_f32 v134, v145, v5
v_fmac_f32 v135, v141, v5
ds_read_b128 v[96:99], v7 offset:3040
ds_read_b64 v[100:101], v6 offset:2432
ds_read_b64 v[102:103], v6 offset:2440
s_waitcnt lgkmcnt(9)
v_mfma_f32_32x32x16_bf16 v[56:71], v[76:79], v[72:75], v[56:71]
v_fmac_f32 v136, v146, v5
v_fmac_f32 v137, v142, v5
ds_read_b128 v[104:107], v7 offset:3072
ds_read_b64 v[108:109], v6 offset:2464
ds_read_b64 v[110:111], v6 offset:2472
s_waitcnt lgkmcnt(9)
v_mfma_f32_32x32x16_bf16 v[56:71], v[84:87], v[80:83], v[56:71]
s_add_u32 s58, s44, 28672
buffer_load_dwordx4 a[240:243], v30, s[8:11], s58 offen sc1
v_fmac_f32 v138, v147, v5
v_fmac_f32 v139, v143, v5
ds_read_b128 v[72:75], v7 offset:2960
ds_read_b64 v[76:77], v6 offset:2368
ds_read_b64 v[78:79], v6 offset:2376
s_waitcnt lgkmcnt(9)
v_mfma_f32_32x32x16_bf16 v[56:71], v[92:95], v[88:91], v[56:71]
ds_read_b128 v[80:83], v7 offset:2992
ds_read_b64 v[84:85], v6 offset:2400
ds_read_b64 v[86:87], v6 offset:2408
s_waitcnt lgkmcnt(9)
v_mfma_f32_32x32x16_bf16 v[56:71], v[100:103], v[96:99], v[56:71]
s_add_u32 s58, s91, 28672
buffer_load_dwordx4 a[244:247], v30, s[8:11], s58 offen sc1
ds_read_b128 v[88:91], v7 offset:2880
ds_read_b64 v[92:93], v6 offset:2304
ds_read_b64 v[94:95], v6 offset:2312
s_waitcnt lgkmcnt(9)
v_mfma_f32_32x32x16_bf16 v[56:71], v[108:111], v[104:107], v[56:71]
ds_read_b128 v[96:99], v7 offset:2912
ds_read_b64 v[100:101], v6 offset:2336
ds_read_b64 v[102:103], v6 offset:2344
s_waitcnt lgkmcnt(9)
v_mfma_f32_32x32x16_bf16 v[56:71], v[76:79], v[72:75], v[56:71]
s_add_u32 s58, s44, 30720
buffer_load_dwordx4 a[248:251], v30, s[8:11], s58 offen sc1
s_add_u32 s64, s56, 0
buffer_load_dword v34, v2, s[8:11], s64 offen sc1
ds_read_b128 v[104:107], v7 offset:2800
ds_read_b64 v[108:109], v6 offset:2240
ds_read_b64 v[110:111], v6 offset:2248
s_waitcnt lgkmcnt(9)
v_mfma_f32_32x32x16_bf16 v[56:71], v[84:87], v[80:83], v[56:71]
ds_read_b128 v[72:75], v7 offset:2832
ds_read_b64 v[76:77], v6 offset:2272
ds_read_b64 v[78:79], v6 offset:2280
s_waitcnt lgkmcnt(9)
v_mfma_f32_32x32x16_bf16 v[56:71], v[92:95], v[88:91], v[56:71]
s_add_u32 s58, s91, 30720
buffer_load_dwordx4 a[252:255], v30, s[8:11], s58 offen sc1
ds_read_b128 v[80:83], v7 offset:2720
ds_read_b64 v[84:85], v6 offset:2176
ds_read_b64 v[86:87], v6 offset:2184
s_waitcnt lgkmcnt(9)
v_mfma_f32_32x32x16_bf16 v[56:71], v[100:103], v[96:99], v[56:71]
ds_read_b128 v[88:91], v7 offset:2752
ds_read_b64 v[92:93], v6 offset:2208
ds_read_b64 v[94:95], v6 offset:2216
s_waitcnt lgkmcnt(9)
v_mfma_f32_32x32x16_bf16 v[56:71], v[108:111], v[104:107], v[56:71]
s_add_u32 s58, s44, 32768
buffer_load_dwordx4 v[160:163], v30, s[8:11], s58 offen sc1
ds_read_b128 v[96:99], v7 offset:2640
ds_read_b64 v[100:101], v6 offset:2112
ds_read_b64 v[102:103], v6 offset:2120
s_waitcnt lgkmcnt(9)
v_mfma_f32_32x32x16_bf16 v[56:71], v[76:79], v[72:75], v[56:71]
ds_read_b128 v[104:107], v7 offset:2672
ds_read_b64 v[108:109], v6 offset:2144
ds_read_b64 v[110:111], v6 offset:2152
s_waitcnt lgkmcnt(9)
v_mfma_f32_32x32x16_bf16 v[56:71], v[84:87], v[80:83], v[56:71]
s_add_u32 s58, s91, 32768
buffer_load_dwordx4 v[164:167], v30, s[8:11], s58 offen sc1
ds_read_b128 v[72:75], v7 offset:2560
ds_read_b64 v[76:77], v6 offset:2048
ds_read_b64 v[78:79], v6 offset:2056
s_waitcnt lgkmcnt(9)
v_mfma_f32_32x32x16_bf16 v[56:71], v[92:95], v[88:91], v[56:71]
ds_read_b128 v[80:83], v7 offset:2592
ds_read_b64 v[84:85], v6 offset:2080
ds_read_b64 v[86:87], v6 offset:2088
s_waitcnt lgkmcnt(9)
v_mfma_f32_32x32x16_bf16 v[56:71], v[100:103], v[96:99], v[56:71]
s_add_u32 s58, s44, 34816
buffer_load_dwordx4 v[168:171], v30, s[8:11], s58 offen sc1
s_waitcnt lgkmcnt(6)
v_mfma_f32_32x32x16_bf16 v[56:71], v[108:111], v[104:107], v[56:71]
s_waitcnt lgkmcnt(3)
v_mfma_f32_32x32x16_bf16 v[56:71], v[76:79], v[72:75], v[56:71]
s_add_u32 s58, s91, 34816
buffer_load_dwordx4 v[172:175], v30, s[8:11], s58 offen sc1
s_waitcnt lgkmcnt(0)
v_mfma_f32_32x32x16_bf16 v[56:71], v[84:87], v[80:83], v[56:71]
v_lshrrev_b32 v41, 5, v1
v_bfe_u32 v47, v1, 2, 2
v_bfe_u32 v49, v1, 4, 1
v_lshlrev_b32 v48, 11, v41
v_and_b32 v50, 3, v1
v_lshrrev_b32 v51, 4, v1
v_lshl_add_u32 v48, v47, 8, v48
v_lshrrev_b32 v53, 2, v1
v_xor_b32 v52, v47, v51
v_lshl_add_u32 v48, v49, 5, v48
v_xor_b32 v42, 0, v47
v_lshlrev_b32 v52, 6, v52
v_lshl_add_u32 v48, v50, 3, v48
v_xor_b32 v43, 1, v47
v_xor_b32 v44, 2, v47
v_add_u32 v48, 62976, v48
v_xor_b32 v45, 3, v47
v_lshl_add_u32 v52, v51, 12, v52
v_lshlrev_b32 v53, 12, v53
v_add_u32 v24, s29, v22
v_lshlrev_b32 v26, 14, v41
v_and_b32 v54, 31, v1
v_lshl_add_u32 v13, v42, 6, v48
v_lshl_add_u32 v14, v43, 6, v48
v_lshl_add_u32 v15, v44, 6, v48
v_lshl_add_u32 v16, v45, 6, v48
v_lshl_add_u32 v21, v50, 4, v52
v_lshl_add_u32 v53, v50, 4, v53
v_add_u32 v25, 0xc000, v24
v_lshl_add_u32 v26, v54, 1, v26
v_add_u32 v17, 0xc000, v13
v_add_u32 v18, 0xc000, v14
v_add_u32 v19, 0xc000, v15
v_add_u32 v20, 0xc000, v16
s_cmp_ge_u32 s41, 28
s_cselect_b64 vcc, -1, 0
v_cndmask_b32 v21, v21, v53, vcc
v_mov_b32 v88, 0x3f803f80
v_mov_b32 v89, 0x3f803f80
v_mov_b32 v90, 0x3f803f80
v_mov_b32 v91, 0x3f803f80
v_mfma_f32_4x4x4_16b_bf16 v[72:75], v[88:89], a[0:1], 0
v_mfma_f32_4x4x4_16b_bf16 v[76:79], v[88:89], a[2:3], 0
v_mfma_f32_4x4x4_16b_bf16 v[80:83], v[88:89], a[4:5], 0
v_mfma_f32_4x4x4_16b_bf16 v[84:87], v[88:89], a[6:7], 0
s_add_u32 s58, s44, 36864
buffer_load_dwordx4 v[176:179], v30, s[8:11], s58 offen sc1
v_mfma_f32_4x4x4_16b_bf16 v[72:75], v[88:89], a[8:9], v[72:75]
v_mfma_f32_4x4x4_16b_bf16 v[76:79], v[88:89], a[10:11], v[76:79]
v_mfma_f32_4x4x4_16b_bf16 v[80:83], v[88:89], a[12:13], v[80:83]
v_mfma_f32_4x4x4_16b_bf16 v[84:87], v[88:89], a[14:15], v[84:87]
v_mfma_f32_4x4x4_16b_bf16 v[72:75], v[88:89], a[16:17], v[72:75]
v_mfma_f32_4x4x4_16b_bf16 v[76:79], v[88:89], a[18:19], v[76:79]
s_add_u32 s58, s91, 36864
buffer_load_dwordx4 v[180:183], v30, s[8:11], s58 offen sc1
v_mfma_f32_4x4x4_16b_bf16 v[80:83], v[88:89], a[20:21], v[80:83]
v_mfma_f32_4x4x4_16b_bf16 v[84:87], v[88:89], a[22:23], v[84:87]
v_mfma_f32_4x4x4_16b_bf16 v[72:75], v[88:89], a[24:25], v[72:75]
v_mfma_f32_4x4x4_16b_bf16 v[76:79], v[88:89], a[26:27], v[76:79]
v_mfma_f32_4x4x4_16b_bf16 v[80:83], v[88:89], a[28:29], v[80:83]
v_mfma_f32_4x4x4_16b_bf16 v[84:87], v[88:89], a[30:31], v[84:87]
s_add_u32 s58, s44, 38912
buffer_load_dwordx4 v[184:187], v30, s[8:11], s58 offen sc1
v_mfma_f32_4x4x4_16b_bf16 v[72:75], v[88:89], a[32:33], v[72:75]
v_mfma_f32_4x4x4_16b_bf16 v[76:79], v[88:89], a[34:35], v[76:79]
v_mfma_f32_4x4x4_16b_bf16 v[80:83], v[88:89], a[36:37], v[80:83]
v_mfma_f32_4x4x4_16b_bf16 v[84:87], v[88:89], a[38:39], v[84:87]
v_mfma_f32_4x4x4_16b_bf16 v[72:75], v[88:89], a[40:41], v[72:75]
v_mfma_f32_4x4x4_16b_bf16 v[76:79], v[88:89], a[42:43], v[76:79]
s_add_u32 s58, s91, 38912
buffer_load_dwordx4 v[188:191], v30, s[8:11], s58 offen sc1
v_mfma_f32_4x4x4_16b_bf16 v[80:83], v[88:89], a[44:45], v[80:83]
v_mfma_f32_4x4x4_16b_bf16 v[84:87], v[88:89], a[46:47], v[84:87]
v_mfma_f32_4x4x4_16b_bf16 v[72:75], v[88:89], a[48:49], v[72:75]
v_mfma_f32_4x4x4_16b_bf16 v[76:79], v[88:89], a[50:51], v[76:79]
v_mfma_f32_4x4x4_16b_bf16 v[80:83], v[88:89], a[52:53], v[80:83]
v_mfma_f32_4x4x4_16b_bf16 v[84:87], v[88:89], a[54:55], v[84:87]
s_add_u32 s58, s44, 40960
buffer_load_dwordx4 v[192:195], v30, s[8:11], s58 offen sc1
v_mfma_f32_4x4x4_16b_bf16 v[72:75], v[88:89], a[56:57], v[72:75]
v_mfma_f32_4x4x4_16b_bf16 v[76:79], v[88:89], a[58:59], v[76:79]
v_mfma_f32_4x4x4_16b_bf16 v[80:83], v[88:89], a[60:61], v[80:83]
v_mfma_f32_4x4x4_16b_bf16 v[84:87], v[88:89], a[62:63], v[84:87]
v_mfma_f32_4x4x4_16b_bf16 v[72:75], v[88:89], a[64:65], v[72:75]
v_mfma_f32_4x4x4_16b_bf16 v[76:79], v[88:89], a[66:67], v[76:79]
s_add_u32 s58, s91, 40960
buffer_load_dwordx4 v[196:199], v30, s[8:11], s58 offen sc1
v_mfma_f32_4x4x4_16b_bf16 v[80:83], v[88:89], a[68:69], v[80:83]
v_mfma_f32_4x4x4_16b_bf16 v[84:87], v[88:89], a[70:71], v[84:87]
v_mfma_f32_4x4x4_16b_bf16 v[72:75], v[88:89], a[72:73], v[72:75]
v_mfma_f32_4x4x4_16b_bf16 v[76:79], v[88:89], a[74:75], v[76:79]
v_mfma_f32_4x4x4_16b_bf16 v[80:83], v[88:89], a[76:77], v[80:83]
v_mfma_f32_4x4x4_16b_bf16 v[84:87], v[88:89], a[78:79], v[84:87]
s_add_u32 s58, s44, 43008
buffer_load_dwordx4 v[200:203], v30, s[8:11], s58 offen sc1
ds_write_b128 v150, v[64:67]
ds_write_b128 v150, v[68:71] offset:1024
v_add_f32 v132, v132, v56
v_add_f32 v133, v133, v57
v_add_f32 v134, v134, v58
v_add_f32 v135, v135, v59
v_add_f32 v136, v136, v60
v_add_f32 v137, v137, v61
v_add_f32 v138, v138, v62
v_add_f32 v139, v139, v63
s_add_u32 s67, s90, 4196352
s_waitcnt vmcnt(37)
s_waitcnt vmcnt(12)
v_cmp_gt_u32 vcc, s57, v34
s_cbranch_vccz Lsd_16
s_mov_b32 s80, 0
Lsq_17:
buffer_load_dword v34, v2, s[8:11], s64 offen sc1
s_add_u32 s80, s80, 1
s_cmp_lt_u32 s80, 0x8000
s_cbranch_scc0 Lsd_16
s_waitcnt vmcnt(0)
v_cmp_gt_u32 vcc, s57, v34
s_nop 1
s_cbranch_vccnz Lsq_17
Lsd_16:
s_waitcnt lgkmcnt(0)
s_barrier
ds_read_b128 v[112:115], v151
ds_read_b128 v[116:119], v151 offset:1024
s_add_u32 m0, s29, 0
s_add_u32 s59, s33, 4194304
buffer_load_dwordx4 v21, s[8:11], s59 offen sc1 lds
s_add_u32 m0, s29, 4096
s_add_u32 s59, s33, 4259840
buffer_load_dwordx4 v21, s[8:11], s59 offen sc1 lds
s_add_u32 m0, s29, 8192
s_add_u32 s59, s33, 4325376
buffer_load_dwordx4 v21, s[8:11], s59 offen sc1 lds
s_add_u32 m0, s29, 12288
s_add_u32 s59, s33, 4390912
buffer_load_dwordx4 v21, s[8:11], s59 offen sc1 lds
ds_read_b64_tr_b16 a[80:81], v159 offset:0
ds_read_b64_tr_b16 a[82:83], v159 offset:128
ds_read_b64_tr_b16 a[84:85], v159 offset:4224
ds_read_b64_tr_b16 a[86:87], v159 offset:4352
ds_read_b64_tr_b16 a[88:89], v159 offset:8448
s_add_u32 m0, s29, 16384
s_add_u32 s59, s33, 4456448
buffer_load_dwordx4 v21, s[8:11], s59 offen sc1 lds
ds_read_b64_tr_b16 a[90:91], v159 offset:8576
ds_read_b64_tr_b16 a[92:93], v159 offset:12672
ds_read_b64_tr_b16 a[94:95], v159 offset:12800
ds_read_b64_tr_b16 a[96:97], v159 offset:16896
ds_read_b64_tr_b16 a[98:99], v159 offset:17024
s_waitcnt lgkmcnt(10)
v_add_f32 v132, v132, v112
v_add_f32 v133, v133, v113
v_add_f32 v134, v134, v114
v_add_f32 v135, v135, v115
v_add_f32 v136, v136, v116
v_add_f32 v137, v137, v117
v_add_f32 v138, v138, v118
v_add_f32 v139, v139, v119
v_cvt_pk_bf16_f32 v140, v132, v133
v_cvt_pk_bf16_f32 v141, v134, v135
v_cvt_pk_bf16_f32 v142, v136, v137
v_cvt_pk_bf16_f32 v143, v138, v139
ds_write_b64 v33, v[140:141] offset:2560
ds_write_b64 v33, v[142:143] offset:2576
s_add_u32 m0, s29, 20480
s_add_u32 s59, s33, 4521984
buffer_load_dwordx4 v21, s[8:11], s59 offen sc1 lds
ds_read_b64_tr_b16 a[100:101], v159 offset:21120
ds_read_b64_tr_b16 a[102:103], v159 offset:21248
ds_read_b64_tr_b16 a[104:105], v159 offset:25344
ds_read_b64_tr_b16 a[106:107], v159 offset:25472
ds_read_b64_tr_b16 a[108:109], v159 offset:29568
s_waitcnt lgkmcnt(5)
s_barrier
ds_read_b128 v[112:115], v12 offset:2560
s_add_u32 m0, s29, 24576
s_add_u32 s59, s33, 4587520
buffer_load_dwordx4 v21, s[8:11], s59 offen sc1 lds
ds_read_b64_tr_b16 a[110:111], v159 offset:29696
ds_read_b64_tr_b16 a[112:113], v159 offset:33792
ds_read_b64_tr_b16 a[114:115], v159 offset:33920
ds_read_b64_tr_b16 a[116:117], v159 offset:38016
ds_read_b64_tr_b16 a[118:119], v159 offset:38144
s_add_u32 m0, s29, 28672
s_add_u32 s59, s33, 4653056
buffer_load_dwordx4 v21, s[8:11], s59 offen sc1 lds
ds_read_b64_tr_b16 a[120:121], v159 offset:42240
ds_read_b64_tr_b16 a[122:123], v159 offset:42368
ds_read_b64_tr_b16 a[124:125], v159 offset:46464
ds_read_b64_tr_b16 a[126:127], v159 offset:46592
s_waitcnt lgkmcnt(9)
buffer_store_dwordx4 v[112:115], v22, s[8:11], s67 offen sc1
s_cmp_ge_u32 s41, 28
s_cbranch_scc1 Lsk_18
s_add_u32 m0, s29, 32768
s_add_u32 s59, s33, 4718592
buffer_load_dwordx4 v21, s[8:11], s59 offen sc1 lds
Lsk_18:
s_cmp_ge_u32 s41, 28
s_cbranch_scc1 Lsk_19
s_waitcnt lgkmcnt(0)
v_mfma_f32_4x4x4_16b_bf16 v[72:75], v[88:89], a[80:81], v[72:75]
v_mfma_f32_4x4x4_16b_bf16 v[76:79], v[88:89], a[82:83], v[76:79]
v_mfma_f32_4x4x4_16b_bf16 v[80:83], v[88:89], a[84:85], v[80:83]
v_mfma_f32_4x4x4_16b_bf16 v[84:87], v[88:89], a[86:87], v[84:87]
v_mfma_f32_4x4x4_16b_bf16 v[72:75], v[88:89], a[88:89], v[72:75]
v_mfma_f32_4x4x4_16b_bf16 v[76:79], v[88:89], a[90:91], v[76:79]
v_mfma_f32_4x4x4_16b_bf16 v[80:83], v[88:89], a[92:93], v[80:83]
v_mfma_f32_4x4x4_16b_bf16 v[84:87], v[88:89], a[94:95], v[84:87]
v_mfma_f32_4x4x4_16b_bf16 v[72:75], v[88:89], a[96:97], v[72:75]
v_mfma_f32_4x4x4_16b_bf16 v[76:79], v[88:89], a[98:99], v[76:79]
v_mfma_f32_4x4x4_16b_bf16 v[80:83], v[88:89], a[100:101], v[80:83]
v_mfma_f32_4x4x4_16b_bf16 v[84:87], v[88:89], a[102:103], v[84:87]
v_mfma_f32_4x4x4_16b_bf16 v[72:75], v[88:89], a[104:105], v[72:75]
v_mfma_f32_4x4x4_16b_bf16 v[76:79], v[88:89], a[106:107], v[76:79]
v_mfma_f32_4x4x4_16b_bf16 v[80:83], v[88:89], a[108:109], v[80:83]
v_mfma_f32_4x4x4_16b_bf16 v[84:87], v[88:89], a[110:111], v[84:87]
v_mfma_f32_4x4x4_16b_bf16 v[72:75], v[88:89], a[112:113], v[72:75]
v_mfma_f32_4x4x4_16b_bf16 v[76:79], v[88:89], a[114:115], v[76:79]
v_mfma_f32_4x4x4_16b_bf16 v[80:83], v[88:89], a[116:117], v[80:83]
v_mfma_f32_4x4x4_16b_bf16 v[84:87], v[88:89], a[118:119], v[84:87]
v_mfma_f32_4x4x4_16b_bf16 v[72:75], v[88:89], a[120:121], v[72:75]
v_mfma_f32_4x4x4_16b_bf16 v[76:79], v[88:89], a[122:123], v[76:79]
v_mfma_f32_4x4x4_16b_bf16 v[80:83], v[88:89], a[124:125], v[80:83]
v_mfma_f32_4x4x4_16b_bf16 v[84:87], v[88:89], a[126:127], v[84:87]
s_nop 2
v_add_f32 v92, v72, v76
s_nop 0
v_add_f32 v93, v80, v84
v_add_f32 v92, v92, v93
v_mov_b32 v93, v92
s_nop 1
v_permlane32_swap_b32 v92, v93
v_add_f32 v92, v92, v93
v_sub_f32 v92, 0, v92
v_cmp_gt_u32 vcc, 32, v1
v_cvt_pk_bf16_f32 v94, v92, v92
v_and_b32 v95, 0xffff0000, v94
v_sub_f32 v92, v92, v95
v_cvt_pk_bf16_f32 v96, v92, v92
v_and_b32 v95, 0xffff0000, v96
v_sub_f32 v92, v92, v95
v_cvt_pk_bf16_f32 v97, v92, v92
v_and_b32 v94, 0xffff, v94
v_or_b32 v94, v95, v94
v_and_b32 v97, 0xffff, v97
v_cndmask_b32 v156, 0, v94, vcc
v_cndmask_b32 v157, 0, v97, vcc
v_mov_b32 v158, 0
v_mov_b32 v159, 0
Lsk_19:
s_cmp_ge_u32 s41, 28
s_cbranch_scc1 Lst_20
s_waitcnt vmcnt(6)
s_barrier
ds_read_b64_tr_b16 v[104:105], v13 offset:0
ds_read_b64_tr_b16 v[106:107], v13 offset:1024
ds_read_b64_tr_b16 v[108:109], v14 offset:0
ds_read_b64_tr_b16 v[110:111], v14 offset:1024
ds_read_b64_tr_b16 v[112:113], v15 offset:0
ds_read_b64_tr_b16 v[114:115], v15 offset:1024
ds_read_b64_tr_b16 v[116:117], v16 offset:0
ds_read_b64_tr_b16 v[118:119], v16 offset:1024
ds_read_b64_tr_b16 v[120:121], v13 offset:4096
ds_read_b64_tr_b16 v[122:123], v13 offset:5120
s_waitcnt lgkmcnt(8)
v_mfma_f32_32x32x16_bf16 v[40:55], a[0:3], v[104:107], 0
s_add_u32 m0, s29, 36864
s_add_u32 s59, s33, 4784128
ds_read_b64_tr_b16 v[124:125], v14 offset:4096
ds_read_b64_tr_b16 v[126:127], v14 offset:5120
s_waitcnt lgkmcnt(8)
v_mfma_f32_32x32x16_bf16 v[56:71], a[0:3], v[108:111], 0
buffer_load_dwordx4 v21, s[8:11], s59 offen sc1 lds
ds_read_b64_tr_b16 v[128:129], v15 offset:4096
ds_read_b64_tr_b16 v[130:131], v15 offset:5120
s_waitcnt lgkmcnt(8)
v_mfma_f32_32x32x16_bf16 v[72:87], a[0:3], v[112:115], 0
s_add_u32 m0, s29, 40960
s_add_u32 s59, s33, 4849664
ds_read_b64_tr_b16 v[132:133], v16 offset:4096
ds_read_b64_tr_b16 v[134:135], v16 offset:5120
s_waitcnt lgkmcnt(8)
v_mfma_f32_32x32x16_bf16 v[88:103], a[0:3], v[116:119], 0
buffer_load_dwordx4 v21, s[8:11], s59 offen sc1 lds
ds_read_b64_tr_b16 v[104:105], v13 offset:8192
ds_read_b64_tr_b16 v[106:107], v13 offset:9216
s_waitcnt lgkmcnt(8)
v_mfma_f32_32x32x16_bf16 v[40:55], a[4:7], v[120:123], v[40:55]
s_add_u32 m0, s29, 45056
s_add_u32 s59, s33, 4915200
ds_read_b64_tr_b16 v[108:109], v14 offset:8192
ds_read_b64_tr_b16 v[110:111], v14 offset:9216
s_waitcnt lgkmcnt(8)
v_mfma_f32_32x32x16_bf16 v[56:71], a[4:7], v[124:127], v[56:71]
buffer_load_dwordx4 v21, s[8:11], s59 offen sc1 lds
ds_read_b64_tr_b16 v[112:113], v15 offset:8192
ds_read_b64_tr_b16 v[114:115], v15 offset:9216
s_waitcnt lgkmcnt(8)
v_mfma_f32_32x32x16_bf16 v[72:87], a[4:7], v[128:131], v[72:87]
s_add_u32 m0, s29, 49152
s_add_u32 s59, s33, 4980736
ds_read_b64_tr_b16 v[116:117], v16 offset:8192
ds_read_b64_tr_b16 v[118:119], v16 offset:9216
s_waitcnt lgkmcnt(8)
v_mfma_f32_32x32x16_bf16 v[88:103], a[4:7], v[132:135], v[88:103]
buffer_load_dwordx4 v21, s[8:11], s59 offen sc1 lds
ds_read_b64_tr_b16 v[120:121], v13 offset:12288
ds_read_b64_tr_b16 v[122:123], v13 offset:13312
s_waitcnt lgkmcnt(8)
v_mfma_f32_32x32x16_bf16 v[40:55], a[8:11], v[104:107], v[40:55]
s_add_u32 m0, s29, 53248
s_add_u32 s59, s33, 5046272
ds_read_b64_tr_b16 v[124:125], v14 offset:12288
ds_read_b64_tr_b16 v[126:127], v14 offset:13312
s_waitcnt lgkmcnt(8)
v_mfma_f32_32x32x16_bf16 v[56:71], a[8:11], v[108:111], v[56:71]
buffer_load_dwordx4 v21, s[8:11], s59 offen sc1 lds
ds_read_b64_tr_b16 v[128:129], v15 offset:12288
ds_read_b64_tr_b16 v[130:131], v15 offset:13312
s_waitcnt lgkmcnt(8)
v_mfma_f32_32x32x16_bf16 v[72:87], a[8:11], v[112:115], v[72:87]
s_add_u32 m0, s29, 57344
s_add_u32 s59, s33, 5111808
ds_read_b64_tr_b16 v[132:133], v16 offset:12288
ds_read_b64_tr_b16 v[134:135], v16 offset:13312
s_waitcnt lgkmcnt(8)
v_mfma_f32_32x32x16_bf16 v[88:103], a[8:11], v[116:119], v[88:103]
buffer_load_dwordx4 v21, s[8:11], s59 offen sc1 lds
s_waitcnt vmcnt(8)
s_barrier
ds_read_b64_tr_b16 v[104:105], v13 offset:16384
ds_read_b64_tr_b16 v[106:107], v13 offset:17408
s_waitcnt lgkmcnt(8)
v_mfma_f32_32x32x16_bf16 v[40:55], a[12:15], v[120:123], v[40:55]
s_add_u32 m0, s29, 61440
s_add_u32 s59, s33, 5177344
ds_read_b64_tr_b16 v[108:109], v14 offset:16384
ds_read_b64_tr_b16 v[110:111], v14 offset:17408
s_waitcnt lgkmcnt(8)
v_mfma_f32_32x32x16_bf16 v[56:71], a[12:15], v[124:127], v[56:71]
buffer_load_dwordx4 v21, s[8:11], s59 offen sc1 lds
ds_read_b64_tr_b16 v[112:113], v15 offset:16384
ds_read_b64_tr_b16 v[114:115], v15 offset:17408
s_waitcnt lgkmcnt(8)
v_mfma_f32_32x32x16_bf16 v[72:87], a[12:15], v[128:131], v[72:87]
s_add_u32 m0, s29, 65536
s_add_u32 s59, s33, 5242880
ds_read_b64_tr_b16 v[116:117], v16 offset:16384
ds_read_b64_tr_b16 v[118:119], v16 offset:17408
s_waitcnt lgkmcnt(8)
v_mfma_f32_32x32x16_bf16 v[88:103], a[12:15], v[132:135], v[88:103]
buffer_load_dwordx4 v21, s[8:11], s59 offen sc1 lds
ds_read_b64_tr_b16 v[120:121], v13 offset:20480
ds_read_b64_tr_b16 v[122:123], v13 offset:21504
s_waitcnt lgkmcnt(8)
v_mfma_f32_32x32x16_bf16 v[40:55], a[16:19], v[104:107], v[40:55]
s_waitcnt vmcnt(9)
s_barrier
s_add_u32 s63, s56, 16384
s_mov_b64 exec, 255
buffer_atomic_add v35, v3, s[8:11], s63 offen sc1
s_mov_b64 exec, -1
s_add_u32 m0, s29, 69632
s_add_u32 s59, s33, 5308416
ds_read_b64_tr_b16 v[124:125], v14 offset:20480
ds_read_b64_tr_b16 v[126:127], v14 offset:21504
s_waitcnt lgkmcnt(8)
v_mfma_f32_32x32x16_bf16 v[56:71], a[16:19], v[108:111], v[56:71]
buffer_load_dwordx4 v21, s[8:11], s59 offen sc1 lds
ds_read_b64_tr_b16 v[128:129], v15 offset:20480
ds_read_b64_tr_b16 v[130:131], v15 offset:21504
s_waitcnt lgkmcnt(8)
v_mfma_f32_32x32x16_bf16 v[72:87], a[16:19], v[112:115], v[72:87]
s_add_u32 m0, s29, 73728
s_add_u32 s59, s33, 5373952
ds_read_b64_tr_b16 v[132:133], v16 offset:20480
ds_read_b64_tr_b16 v[134:135], v16 offset:21504
s_waitcnt lgkmcnt(8)
v_mfma_f32_32x32x16_bf16 v[88:103], a[16:19], v[116:119], v[88:103]
buffer_load_dwordx4 v21, s[8:11], s59 offen sc1 lds
ds_read_b64_tr_b16 v[104:105], v13 offset:24576
ds_read_b64_tr_b16 v[106:107], v13 offset:25600
s_waitcnt lgkmcnt(8)
v_mfma_f32_32x32x16_bf16 v[40:55], a[20:23], v[120:123], v[40:55]
s_add_u32 m0, s29, 77824
s_add_u32 s59, s33, 5439488
ds_read_b64_tr_b16 v[108:109], v14 offset:24576
ds_read_b64_tr_b16 v[110:111], v14 offset:25600
s_waitcnt lgkmcnt(8)
v_mfma_f32_32x32x16_bf16 v[56:71], a[20:23], v[124:127], v[56:71]
buffer_load_dwordx4 v21, s[8:11], s59 offen sc1 lds
ds_read_b64_tr_b16 v[112:113], v15 offset:24576
ds_read_b64_tr_b16 v[114:115], v15 offset:25600
s_waitcnt lgkmcnt(8)
v_mfma_f32_32x32x16_bf16 v[72:87], a[20:23], v[128:131], v[72:87]
s_add_u32 m0, s29, 81920
s_add_u32 s59, s33, 5505024
ds_read_b64_tr_b16 v[116:117], v16 offset:24576
ds_read_b64_tr_b16 v[118:119], v16 offset:25600
s_waitcnt lgkmcnt(8)
v_mfma_f32_32x32x16_bf16 v[88:103], a[20:23], v[132:135], v[88:103]
buffer_load_dwordx4 v21, s[8:11], s59 offen sc1 lds
ds_read_b64_tr_b16 v[120:121], v13 offset:28672
ds_read_b64_tr_b16 v[122:123], v13 offset:29696
s_waitcnt lgkmcnt(8)
v_mfma_f32_32x32x16_bf16 v[40:55], a[24:27], v[104:107], v[40:55]
s_add_u32 m0, s29, 86016
s_add_u32 s59, s33, 5570560
ds_read_b64_tr_b16 v[124:125], v14 offset:28672
ds_read_b64_tr_b16 v[126:127], v14 offset:29696
s_waitcnt lgkmcnt(8)
v_mfma_f32_32x32x16_bf16 v[56:71], a[24:27], v[108:111], v[56:71]
buffer_load_dwordx4 v21, s[8:11], s59 offen sc1 lds
ds_read_b64_tr_b16 v[128:129], v15 offset:28672
ds_read_b64_tr_b16 v[130:131], v15 offset:29696
s_waitcnt lgkmcnt(8)
v_mfma_f32_32x32x16_bf16 v[72:87], a[24:27], v[112:115], v[72:87]
s_add_u32 m0, s29, 90112
s_add_u32 s59, s33, 5636096
ds_read_b64_tr_b16 v[132:133], v16 offset:28672
ds_read_b64_tr_b16 v[134:135], v16 offset:29696
s_waitcnt lgkmcnt(8)
v_mfma_f32_32x32x16_bf16 v[88:103], a[24:27], v[116:119], v[88:103]
buffer_load_dwordx4 v21, s[8:11], s59 offen sc1 lds
s_waitcnt vmcnt(12)
s_barrier
ds_read_b64_tr_b16 v[104:105], v13 offset:32768
ds_read_b64_tr_b16 v[106:107], v13 offset:33792
s_waitcnt lgkmcnt(8)
v_mfma_f32_32x32x16_bf16 v[40:55], a[28:31], v[120:123], v[40:55]
s_add_u32 m0, s29, 94208
s_add_u32 s59, s33, 5701632
ds_read_b64_tr_b16 v[108:109], v14 offset:32768
ds_read_b64_tr_b16 v[110:111], v14 offset:33792
s_waitcnt lgkmcnt(8)
v_mfma_f32_32x32x16_bf16 v[56:71], a[28:31], v[124:127], v[56:71]
buffer_load_dwordx4 v21, s[8:11], s59 offen sc1 lds
ds_read_b64_tr_b16 v[112:113], v15 offset:32768
ds_read_b64_tr_b16 v[114:115], v15 offset:33792
s_waitcnt lgkmcnt(8)
v_mfma_f32_32x32x16_bf16 v[72:87], a[28:31], v[128:131], v[72:87]
s_add_u32 m0, s29, 0
s_add_u32 s59, s33, 5767168
ds_read_b64_tr_b16 v[116:117], v16 offset:32768
ds_read_b64_tr_b16 v[118:119], v16 offset:33792
s_waitcnt lgkmcnt(8)
v_mfma_f32_32x32x16_bf16 v[88:103], a[28:31], v[132:135], v[88:103]
buffer_load_dwordx4 v21, s[8:11], s59 offen sc1 lds
ds_read_b64_tr_b16 v[120:121], v13 offset:36864
ds_read_b64_tr_b16 v[122:123], v13 offset:37888
s_waitcnt lgkmcnt(8)
v_mfma_f32_32x32x16_bf16 v[40:55], a[32:35], v[104:107], v[40:55]
s_add_u32 m0, s29, 4096
s_add_u32 s59, s33, 5832704
ds_read_b64_tr_b16 v[124:125], v14 offset:36864
ds_read_b64_tr_b16 v[126:127], v14 offset:37888
s_waitcnt lgkmcnt(8)
v_mfma_f32_32x32x16_bf16 v[56:71], a[32:35], v[108:111], v[56:71]
buffer_load_dwordx4 v21, s[8:11], s59 offen sc1 lds
ds_read_b64_tr_b16 v[128:129], v15 offset:36864
ds_read_b64_tr_b16 v[130:131], v15 offset:37888
s_waitcnt lgkmcnt(8)
v_mfma_f32_32x32x16_bf16 v[72:87], a[32:35], v[112:115], v[72:87]
s_add_u32 s58, s91, 43008
buffer_load_dwordx4 v[204:207], v30, s[8:11], s58 offen sc1
ds_read_b64_tr_b16 v[132:133], v16 offset:36864
ds_read_b64_tr_b16 v[134:135], v16 offset:37888
s_waitcnt lgkmcnt(8)
v_mfma_f32_32x32x16_bf16 v[88:103], a[32:35], v[116:119], v[88:103]
ds_read_b64_tr_b16 v[104:105], v13 offset:40960
ds_read_b64_tr_b16 v[106:107], v13 offset:41984
s_waitcnt lgkmcnt(8)
v_mfma_f32_32x32x16_bf16 v[40:55], a[36:39], v[120:123], v[40:55]
s_add_u32 m0, s29, 8192
s_add_u32 s59, s33, 5898240
ds_read_b64_tr_b16 v[108:109], v14 offset:40960
ds_read_b64_tr_b16 v[110:111], v14 offset:41984
s_waitcnt lgkmcnt(8)
v_mfma_f32_32x32x16_bf16 v[56:71], a[36:39], v[124:127], v[56:71]
buffer_load_dwordx4 v21, s[8:11], s59 offen sc1 lds
ds_read_b64_tr_b16 v[112:113], v15 offset:40960
ds_read_b64_tr_b16 v[114:115], v15 offset:41984
s_waitcnt lgkmcnt(8)
v_mfma_f32_32x32x16_bf16 v[72:87], a[36:39], v[128:131], v[72:87]
ds_read_b64_tr_b16 v[116:117], v16 offset:40960
ds_read_b64_tr_b16 v[118:119], v16 offset:41984
s_waitcnt lgkmcnt(8)
v_mfma_f32_32x32x16_bf16 v[88:103], a[36:39], v[132:135], v[88:103]
ds_read_b64_tr_b16 v[120:121], v13 offset:45056
ds_read_b64_tr_b16 v[122:123], v13 offset:46080
s_waitcnt lgkmcnt(8)
v_mfma_f32_32x32x16_bf16 v[40:55], a[40:43], v[104:107], v[40:55]
s_add_u32 m0, s29, 12288
s_add_u32 s59, s33, 5963776
ds_read_b64_tr_b16 v[124:125], v14 offset:45056
ds_read_b64_tr_b16 v[126:127], v14 offset:46080
s_waitcnt lgkmcnt(8)
v_mfma_f32_32x32x16_bf16 v[56:71], a[40:43], v[108:111], v[56:71]
buffer_load_dwordx4 v21, s[8:11], s59 offen sc1 lds
ds_read_b64_tr_b16 v[128:129], v15 offset:45056
ds_read_b64_tr_b16 v[130:131], v15 offset:46080
s_waitcnt lgkmcnt(8)
v_mfma_f32_32x32x16_bf16 v[72:87], a[40:43], v[112:115], v[72:87]
s_add_u32 s58, s44, 45056
buffer_load_dwordx4 v[208:211], v30, s[8:11], s58 offen sc1
ds_read_b64_tr_b16 v[132:133], v16 offset:45056
ds_read_b64_tr_b16 v[134:135], v16 offset:46080
s_waitcnt lgkmcnt(8)
v_mfma_f32_32x32x16_bf16 v[88:103], a[40:43], v[116:119], v[88:103]
s_waitcnt vmcnt(15)
s_barrier
ds_read_b64_tr_b16 v[104:105], v17 offset:0
ds_read_b64_tr_b16 v[106:107], v17 offset:1024
s_waitcnt lgkmcnt(8)
v_mfma_f32_32x32x16_bf16 v[40:55], a[44:47], v[120:123], v[40:55]
s_add_u32 m0, s29, 16384
s_add_u32 s59, s33, 6029312
ds_read_b64_tr_b16 v[108:109], v18 offset:0
ds_read_b64_tr_b16 v[110:111], v18 offset:1024
s_waitcnt lgkmcnt(8)
v_mfma_f32_32x32x16_bf16 v[56:71], a[44:47], v[124:127], v[56:71]
buffer_load_dwordx4 v21, s[8:11], s59 offen sc1 lds
ds_read_b64_tr_b16 v[112:113], v19 offset:0
ds_read_b64_tr_b16 v[114:115], v19 offset:1024
s_waitcnt lgkmcnt(8)
v_mfma_f32_32x32x16_bf16 v[72:87], a[44:47], v[128:131], v[72:87]
ds_read_b64_tr_b16 v[116:117], v20 offset:0
ds_read_b64_tr_b16 v[118:119], v20 offset:1024
s_waitcnt lgkmcnt(8)
v_mfma_f32_32x32x16_bf16 v[88:103], a[44:47], v[132:135], v[88:103]
ds_read_b64_tr_b16 v[120:121], v17 offset:4096
ds_read_b64_tr_b16 v[122:123], v17 offset:5120
s_waitcnt lgkmcnt(8)
v_mfma_f32_32x32x16_bf16 v[40:55], a[48:51], v[104:107], v[40:55]
s_add_u32 m0, s29, 20480
s_add_u32 s59, s33, 6094848
ds_read_b64_tr_b16 v[124:125], v18 offset:4096
ds_read_b64_tr_b16 v[126:127], v18 offset:5120
s_waitcnt lgkmcnt(8)
v_mfma_f32_32x32x16_bf16 v[56:71], a[48:51], v[108:111], v[56:71]
buffer_load_dwordx4 v21, s[8:11], s59 offen sc1 lds
ds_read_b64_tr_b16 v[128:129], v19 offset:4096
ds_read_b64_tr_b16 v[130:131], v19 offset:5120
s_waitcnt lgkmcnt(8)
v_mfma_f32_32x32x16_bf16 v[72:87], a[48:51], v[112:115], v[72:87]
s_add_u32 s58, s91, 45056
buffer_load_dwordx4 v[212:215], v30, s[8:11], s58 offen sc1
ds_read_b64_tr_b16 v[132:133], v20 offset:4096
ds_read_b64_tr_b16 v[134:135], v20 offset:5120
s_waitcnt lgkmcnt(8)
v_mfma_f32_32x32x16_bf16 v[88:103], a[48:51], v[116:119], v[88:103]
ds_read_b64_tr_b16 v[104:105], v17 offset:8192
ds_read_b64_tr_b16 v[106:107], v17 offset:9216
s_waitcnt lgkmcnt(8)
v_mfma_f32_32x32x16_bf16 v[40:55], a[52:55], v[120:123], v[40:55]
s_add_u32 m0, s29, 24576
s_add_u32 s59, s33, 6160384
ds_read_b64_tr_b16 v[108:109], v18 offset:8192
ds_read_b64_tr_b16 v[110:111], v18 offset:9216
s_waitcnt lgkmcnt(8)
v_mfma_f32_32x32x16_bf16 v[56:71], a[52:55], v[124:127], v[56:71]
buffer_load_dwordx4 v21, s[8:11], s59 offen sc1 lds
ds_read_b64_tr_b16 v[112:113], v19 offset:8192
ds_read_b64_tr_b16 v[114:115], v19 offset:9216
s_waitcnt lgkmcnt(8)
v_mfma_f32_32x32x16_bf16 v[72:87], a[52:55], v[128:131], v[72:87]
ds_read_b64_tr_b16 v[116:117], v20 offset:8192
ds_read_b64_tr_b16 v[118:119], v20 offset:9216
s_waitcnt lgkmcnt(8)
v_mfma_f32_32x32x16_bf16 v[88:103], a[52:55], v[132:135], v[88:103]
ds_read_b64_tr_b16 v[120:121], v17 offset:12288
ds_read_b64_tr_b16 v[122:123], v17 offset:13312
s_waitcnt lgkmcnt(8)
v_mfma_f32_32x32x16_bf16 v[40:55], a[56:59], v[104:107], v[40:55]
s_add_u32 m0, s29, 28672
s_add_u32 s59, s33, 6225920
ds_read_b64_tr_b16 v[124:125], v18 offset:12288
ds_read_b64_tr_b16 v[126:127], v18 offset:13312
s_waitcnt lgkmcnt(8)
v_mfma_f32_32x32x16_bf16 v[56:71], a[56:59], v[108:111], v[56:71]
buffer_load_dwordx4 v21, s[8:11], s59 offen sc1 lds
ds_read_b64_tr_b16 v[128:129], v19 offset:12288
ds_read_b64_tr_b16 v[130:131], v19 offset:13312
s_waitcnt lgkmcnt(8)
v_mfma_f32_32x32x16_bf16 v[72:87], a[56:59], v[112:115], v[72:87]
s_add_u32 s58, s44, 47104
buffer_load_dwordx4 v[216:219], v30, s[8:11], s58 offen sc1
ds_read_b64_tr_b16 v[132:133], v20 offset:12288
ds_read_b64_tr_b16 v[134:135], v20 offset:13312
s_waitcnt lgkmcnt(8)
v_mfma_f32_32x32x16_bf16 v[88:103], a[56:59], v[116:119], v[88:103]
s_waitcnt vmcnt(16)
s_barrier
ds_read_b64_tr_b16 v[104:105], v17 offset:16384
ds_read_b64_tr_b16 v[106:107], v17 offset:17408
s_waitcnt lgkmcnt(8)
v_mfma_f32_32x32x16_bf16 v[40:55], a[60:63], v[120:123], v[40:55]
ds_read_b64_tr_b16 v[108:109], v18 offset:16384
ds_read_b64_tr_b16 v[110:111], v18 offset:17408
s_waitcnt lgkmcnt(8)
v_mfma_f32_32x32x16_bf16 v[56:71], a[60:63], v[124:127], v[56:71]
ds_read_b64_tr_b16 v[112:113], v19 offset:16384
ds_read_b64_tr_b16 v[114:115], v19 offset:17408
s_waitcnt lgkmcnt(8)
v_mfma_f32_32x32x16_bf16 v[72:87], a[60:63], v[128:131], v[72:87]
ds_read_b64_tr_b16 v[116:117], v20 offset:16384
ds_read_b64_tr_b16 v[118:119], v20 offset:17408
s_waitcnt lgkmcnt(8)
v_mfma_f32_32x32x16_bf16 v[88:103], a[60:63], v[132:135], v[88:103]
ds_read_b64_tr_b16 v[120:121], v17 offset:20480
ds_read_b64_tr_b16 v[122:123], v17 offset:21504
s_waitcnt lgkmcnt(8)
v_mfma_f32_32x32x16_bf16 v[40:55], a[64:67], v[104:107], v[40:55]
s_add_u32 s58, s91, 47104
buffer_load_dwordx4 v[220:223], v30, s[8:11], s58 offen sc1
ds_read_b64_tr_b16 v[124:125], v18 offset:20480
ds_read_b64_tr_b16 v[126:127], v18 offset:21504
s_waitcnt lgkmcnt(8)
v_mfma_f32_32x32x16_bf16 v[56:71], a[64:67], v[108:111], v[56:71]
ds_read_b64_tr_b16 v[128:129], v19 offset:20480
ds_read_b64_tr_b16 v[130:131], v19 offset:21504
s_waitcnt lgkmcnt(8)
v_mfma_f32_32x32x16_bf16 v[72:87], a[64:67], v[112:115], v[72:87]
ds_read_b64_tr_b16 v[132:133], v20 offset:20480
ds_read_b64_tr_b16 v[134:135], v20 offset:21504
s_waitcnt lgkmcnt(8)
v_mfma_f32_32x32x16_bf16 v[88:103], a[64:67], v[116:119], v[88:103]
ds_read_b64_tr_b16 v[104:105], v17 offset:24576
ds_read_b64_tr_b16 v[106:107], v17 offset:25600
s_waitcnt lgkmcnt(8)
v_mfma_f32_32x32x16_bf16 v[40:55], a[68:71], v[120:123], v[40:55]
ds_read_b64_tr_b16 v[108:109], v18 offset:24576
ds_read_b64_tr_b16 v[110:111], v18 offset:25600
s_waitcnt lgkmcnt(8)
v_mfma_f32_32x32x16_bf16 v[56:71], a[68:71], v[124:127], v[56:71]
ds_read_b64_tr_b16 v[112:113], v19 offset:24576
ds_read_b64_tr_b16 v[114:115], v19 offset:25600
s_waitcnt lgkmcnt(8)
v_mfma_f32_32x32x16_bf16 v[72:87], a[68:71], v[128:131], v[72:87]
s_add_u32 s58, s44, 49152
buffer_load_dwordx4 v[224:227], v30, s[8:11], s58 offen sc1
ds_read_b64_tr_b16 v[116:117], v20 offset:24576
ds_read_b64_tr_b16 v[118:119], v20 offset:25600
s_waitcnt lgkmcnt(8)
v_mfma_f32_32x32x16_bf16 v[88:103], a[68:71], v[132:135], v[88:103]
ds_read_b64_tr_b16 v[120:121], v17 offset:28672
ds_read_b64_tr_b16 v[122:123], v17 offset:29696
s_waitcnt lgkmcnt(8)
v_mfma_f32_32x32x16_bf16 v[40:55], a[72:75], v[104:107], v[40:55]
ds_read_b64_tr_b16 v[124:125], v18 offset:28672
ds_read_b64_tr_b16 v[126:127], v18 offset:29696
s_waitcnt lgkmcnt(8)
v_mfma_f32_32x32x16_bf16 v[56:71], a[72:75], v[108:111], v[56:71]
ds_read_b64_tr_b16 v[128:129], v19 offset:28672
ds_read_b64_tr_b16 v[130:131], v19 offset:29696
s_waitcnt lgkmcnt(8)
v_mfma_f32_32x32x16_bf16 v[72:87], a[72:75], v[112:115], v[72:87]
s_add_u32 s66, s39, 131072
ds_read_b64_tr_b16 v[132:133], v20 offset:28672
ds_read_b64_tr_b16 v[134:135], v20 offset:29696
s_waitcnt lgkmcnt(8)
v_mfma_f32_32x32x16_bf16 v[88:103], a[72:75], v[116:119], v[88:103]
buffer_load_dwordx2 v[136:137], v23, s[8:11], s66 offen offset:0 sc1
s_waitcnt vmcnt(15)
s_barrier
ds_read_b64_tr_b16 v[104:105], v17 offset:32768
ds_read_b64_tr_b16 v[106:107], v17 offset:33792
s_waitcnt lgkmcnt(8)
v_mfma_f32_32x32x16_bf16 v[40:55], a[76:79], v[120:123], v[40:55]
s_add_u32 s64, s56, 16384
buffer_load_dword v34, v2, s[8:11], s64 offen sc1
s_add_u32 s58, s91, 49152
buffer_load_dwordx4 v[228:231], v30, s[8:11], s58 offen sc1
ds_read_b64_tr_b16 v[108:109], v18 offset:32768
ds_read_b64_tr_b16 v[110:111], v18 offset:33792
s_waitcnt lgkmcnt(8)
v_mfma_f32_32x32x16_bf16 v[56:71], a[76:79], v[124:127], v[56:71]
ds_read_b64_tr_b16 v[112:113], v19 offset:32768
ds_read_b64_tr_b16 v[114:115], v19 offset:33792
s_waitcnt lgkmcnt(8)
v_mfma_f32_32x32x16_bf16 v[72:87], a[76:79], v[128:131], v[72:87]
ds_read_b64_tr_b16 v[116:117], v20 offset:32768
ds_read_b64_tr_b16 v[118:119], v20 offset:33792
s_waitcnt lgkmcnt(8)
v_mfma_f32_32x32x16_bf16 v[88:103], a[76:79], v[132:135], v[88:103]
buffer_load_dwordx2 v[138:139], v23, s[8:11], s66 offen offset:256 sc1
ds_read_b64_tr_b16 v[120:121], v17 offset:36864
ds_read_b64_tr_b16 v[122:123], v17 offset:37888
s_waitcnt lgkmcnt(8)
v_mfma_f32_32x32x16_bf16 v[40:55], a[80:83], v[104:107], v[40:55]
ds_read_b64_tr_b16 v[124:125], v18 offset:36864
ds_read_b64_tr_b16 v[126:127], v18 offset:37888
s_waitcnt lgkmcnt(8)
v_mfma_f32_32x32x16_bf16 v[56:71], a[80:83], v[108:111], v[56:71]
ds_read_b64_tr_b16 v[128:129], v19 offset:36864
ds_read_b64_tr_b16 v[130:131], v19 offset:37888
s_waitcnt lgkmcnt(8)
v_mfma_f32_32x32x16_bf16 v[72:87], a[80:83], v[112:115], v[72:87]
s_add_u32 s58, s44, 51200
buffer_load_dwordx4 v[232:235], v30, s[8:11], s58 offen sc1
ds_read_b64_tr_b16 v[132:133], v20 offset:36864
ds_read_b64_tr_b16 v[134:135], v20 offset:37888
s_waitcnt lgkmcnt(8)
v_mfma_f32_32x32x16_bf16 v[88:103], a[80:83], v[116:119], v[88:103]
buffer_load_dwordx2 v[140:141], v23, s[8:11], s66 offen offset:512 sc1
ds_read_b64_tr_b16 v[104:105], v17 offset:40960
ds_read_b64_tr_b16 v[106:107], v17 offset:41984
s_waitcnt lgkmcnt(8)
v_mfma_f32_32x32x16_bf16 v[40:55], a[84:87], v[120:123], v[40:55]
ds_read_b64_tr_b16 v[108:109], v18 offset:40960
ds_read_b64_tr_b16 v[110:111], v18 offset:41984
s_waitcnt lgkmcnt(8)
v_mfma_f32_32x32x16_bf16 v[56:71], a[84:87], v[124:127], v[56:71]
ds_read_b64_tr_b16 v[112:113], v19 offset:40960
ds_read_b64_tr_b16 v[114:115], v19 offset:41984
s_waitcnt lgkmcnt(8)
v_mfma_f32_32x32x16_bf16 v[72:87], a[84:87], v[128:131], v[72:87]
ds_read_b64_tr_b16 v[116:117], v20 offset:40960
ds_read_b64_tr_b16 v[118:119], v20 offset:41984
s_waitcnt lgkmcnt(8)
v_mfma_f32_32x32x16_bf16 v[88:103], a[84:87], v[132:135], v[88:103]
buffer_load_dwordx2 v[142:143], v23, s[8:11], s66 offen offset:768 sc1
ds_read_b64_tr_b16 v[120:121], v17 offset:45056
ds_read_b64_tr_b16 v[122:123], v17 offset:46080
s_waitcnt lgkmcnt(8)
v_mfma_f32_32x32x16_bf16 v[40:55], a[88:91], v[104:107], v[40:55]
s_add_u32 s58, s91, 51200
buffer_load_dwordx4 v[236:239], v30, s[8:11], s58 offen sc1
ds_read_b64_tr_b16 v[124:125], v18 offset:45056
ds_read_b64_tr_b16 v[126:127], v18 offset:46080
s_waitcnt lgkmcnt(8)
v_mfma_f32_32x32x16_bf16 v[56:71], a[88:91], v[108:111], v[56:71]
ds_read_b64_tr_b16 v[128:129], v19 offset:45056
ds_read_b64_tr_b16 v[130:131], v19 offset:46080
s_waitcnt lgkmcnt(8)
v_mfma_f32_32x32x16_bf16 v[72:87], a[88:91], v[112:115], v[72:87]
ds_read_b64_tr_b16 v[132:133], v20 offset:45056
ds_read_b64_tr_b16 v[134:135], v20 offset:46080
s_waitcnt lgkmcnt(8)
v_mfma_f32_32x32x16_bf16 v[88:103], a[88:91], v[116:119], v[88:103]
s_waitcnt vmcnt(17)
s_waitcnt vmcnt(6)
v_cmp_gt_u32 vcc, s57, v34
s_cbranch_vccz Lsd_23
s_mov_b32 s80, 0
Lsq_24:
buffer_load_dword v34, v2, s[8:11], s64 offen sc1
s_add_u32 s80, s80, 1
s_cmp_lt_u32 s80, 0x8000
s_cbranch_scc0 Lsd_23
s_waitcnt vmcnt(0)
v_cmp_gt_u32 vcc, s57, v34
s_nop 1
s_cbranch_vccnz Lsq_24
Lsd_23:
s_barrier
ds_read_b64_tr_b16 v[104:105], v13 offset:0
ds_read_b64_tr_b16 v[106:107], v13 offset:1024
s_waitcnt lgkmcnt(8)
v_mfma_f32_32x32x16_bf16 v[40:55], a[92:95], v[120:123], v[40:55]
s_add_u32 m0, s29, 32768
s_add_u32 s59, s33, 4196352
ds_read_b64_tr_b16 v[108:109], v14 offset:0
ds_read_b64_tr_b16 v[110:111], v14 offset:1024
s_waitcnt lgkmcnt(8)
v_mfma_f32_32x32x16_bf16 v[56:71], a[92:95], v[124:127], v[56:71]
buffer_load_dwordx4 v21, s[8:11], s59 offen sc1 lds
ds_read_b64_tr_b16 v[112:113], v15 offset:0
ds_read_b64_tr_b16 v[114:115], v15 offset:1024
s_waitcnt lgkmcnt(8)
v_mfma_f32_32x32x16_bf16 v[72:87], a[92:95], v[128:131], v[72:87]
s_add_u32 m0, s29, 36864
s_add_u32 s59, s33, 4261888
ds_read_b64_tr_b16 v[116:117], v16 offset:0
ds_read_b64_tr_b16 v[118:119], v16 offset:1024
s_waitcnt lgkmcnt(8)
v_mfma_f32_32x32x16_bf16 v[88:103], a[92:95], v[132:135], v[88:103]
buffer_load_dwordx4 v21, s[8:11], s59 offen sc1 lds
ds_read_b64_tr_b16 v[120:121], v13 offset:4096
ds_read_b64_tr_b16 v[122:123], v13 offset:5120
s_waitcnt lgkmcnt(8)
v_mfma_f32_32x32x16_bf16 v[40:55], a[96:99], v[104:107], v[40:55]
s_add_u32 m0, s29, 40960
s_add_u32 s59, s33, 4327424
ds_read_b64_tr_b16 v[124:125], v14 offset:4096
ds_read_b64_tr_b16 v[126:127], v14 offset:5120
s_waitcnt lgkmcnt(8)
v_mfma_f32_32x32x16_bf16 v[56:71], a[96:99], v[108:111], v[56:71]
buffer_load_dwordx4 v21, s[8:11], s59 offen sc1 lds
ds_read_b64_tr_b16 v[128:129], v15 offset:4096
ds_read_b64_tr_b16 v[130:131], v15 offset:5120
s_waitcnt lgkmcnt(8)
v_mfma_f32_32x32x16_bf16 v[72:87], a[96:99], v[112:115], v[72:87]
s_add_u32 m0, s29, 45056
s_add_u32 s59, s33, 4392960
ds_read_b64_tr_b16 v[132:133], v16 offset:4096
ds_read_b64_tr_b16 v[134:135], v16 offset:5120
s_waitcnt lgkmcnt(8)
v_mfma_f32_32x32x16_bf16 v[88:103], a[96:99], v[116:119], v[88:103]
buffer_load_dwordx4 v21, s[8:11], s59 offen sc1 lds
ds_read_b64_tr_b16 v[104:105], v13 offset:8192
ds_read_b64_tr_b16 v[106:107], v13 offset:9216
s_waitcnt lgkmcnt(8)
v_mfma_f32_32x32x16_bf16 v[40:55], a[100:103], v[120:123], v[40:55]
s_add_u32 m0, s29, 49152
s_add_u32 s59, s33, 4458496
s_waitcnt vmcnt(5)
s_mov_b32 s62, 0x03020302
v_and_b32 v152, v136, v138
v_and_b32 v153, v140, v142
ds_read_b64_tr_b16 v[108:109], v14 offset:8192
ds_read_b64_tr_b16 v[110:111], v14 offset:9216
s_waitcnt lgkmcnt(8)
v_mfma_f32_32x32x16_bf16 v[56:71], a[100:103], v[124:127], v[56:71]
buffer_load_dwordx4 v21, s[8:11], s59 offen sc1 lds
v_and_b32 v152, v152, v153
v_and_b32 v152, 1, v152
v_cmp_eq_u32 vcc, 0, v152
ds_read_b64_tr_b16 v[112:113], v15 offset:8192
ds_read_b64_tr_b16 v[114:115], v15 offset:9216
s_waitcnt lgkmcnt(8)
v_mfma_f32_32x32x16_bf16 v[72:87], a[100:103], v[128:131], v[72:87]
s_add_u32 m0, s29, 53248
s_add_u32 s59, s33, 4524032
s_cbranch_vccnz Llg_25
Llgd_26:
v_perm_b32 v144, v136, v136, s62
ds_read_b64_tr_b16 v[116:117], v16 offset:8192
ds_read_b64_tr_b16 v[118:119], v16 offset:9216
s_waitcnt lgkmcnt(8)
v_mfma_f32_32x32x16_bf16 v[88:103], a[100:103], v[132:135], v[88:103]
buffer_load_dwordx4 v21, s[8:11], s59 offen sc1 lds
v_perm_b32 v145, v136, v136, s62
v_perm_b32 v146, v138, v138, s62
v_perm_b32 v147, v138, v138, s62
ds_read_b64_tr_b16 v[120:121], v13 offset:12288
ds_read_b64_tr_b16 v[122:123], v13 offset:13312
s_waitcnt lgkmcnt(8)
v_mfma_f32_32x32x16_bf16 v[40:55], a[104:107], v[104:107], v[40:55]
s_add_u32 m0, s29, 57344
s_add_u32 s59, s33, 4589568
v_perm_b32 v148, v140, v140, s62
v_perm_b32 v149, v140, v140, s62
v_perm_b32 v150, v142, v142, s62
ds_read_b64_tr_b16 v[124:125], v14 offset:12288
ds_read_b64_tr_b16 v[126:127], v14 offset:13312
s_waitcnt lgkmcnt(8)
v_mfma_f32_32x32x16_bf16 v[56:71], a[104:107], v[108:111], v[56:71]
buffer_load_dwordx4 v21, s[8:11], s59 offen sc1 lds
v_perm_b32 v151, v142, v142, s62
v_mov_b32 v152, 0
v_mov_b32 v153, 0
ds_read_b64_tr_b16 v[128:129], v15 offset:12288
ds_read_b64_tr_b16 v[130:131], v15 offset:13312
s_waitcnt lgkmcnt(8)
v_mfma_f32_32x32x16_bf16 v[72:87], a[104:107], v[112:115], v[72:87]
s_add_u32 m0, s29, 61440
s_add_u32 s59, s33, 4655104
ds_read_b64_tr_b16 v[132:133], v16 offset:12288
ds_read_b64_tr_b16 v[134:135], v16 offset:13312
s_waitcnt lgkmcnt(8)
v_mfma_f32_32x32x16_bf16 v[88:103], a[104:107], v[116:119], v[88:103]
buffer_load_dwordx4 v21, s[8:11], s59 offen sc1 lds
s_barrier
ds_read_b64_tr_b16 v[104:105], v13 offset:16384
ds_read_b64_tr_b16 v[106:107], v13 offset:17408
s_waitcnt lgkmcnt(8)
v_mfma_f32_32x32x16_bf16 v[40:55], a[108:111], v[120:123], v[40:55]
s_add_u32 m0, s29, 65536
s_add_u32 s59, s33, 4720640
ds_read_b64_tr_b16 v[108:109], v13 offset:20480
ds_read_b64_tr_b16 v[110:111], v13 offset:21504
s_waitcnt lgkmcnt(8)
v_mfma_f32_32x32x16_bf16 v[56:71], a[108:111], v[124:127], v[56:71]
buffer_load_dwordx4 v21, s[8:11], s59 offen sc1 lds
ds_read_b64_tr_b16 v[112:113], v13 offset:24576
ds_read_b64_tr_b16 v[114:115], v13 offset:25600
s_waitcnt lgkmcnt(8)
v_mfma_f32_32x32x16_bf16 v[72:87], a[108:111], v[128:131], v[72:87]
s_add_u32 m0, s29, 69632
s_add_u32 s59, s33, 4786176
ds_read_b64_tr_b16 v[116:117], v13 offset:28672
ds_read_b64_tr_b16 v[118:119], v13 offset:29696
s_waitcnt lgkmcnt(8)
v_mfma_f32_32x32x16_bf16 v[88:103], a[108:111], v[132:135], v[88:103]
buffer_load_dwordx4 v21, s[8:11], s59 offen sc1 lds
v_mfma_f32_32x32x16_bf16 v[40:55], v[156:159], v[144:147], v[40:55]
s_add_u32 m0, s29, 73728
s_add_u32 s59, s33, 4851712
v_mfma_f32_32x32x16_bf16 v[56:71], v[156:159], v[146:149], v[56:71]
buffer_load_dwordx4 v21, s[8:11], s59 offen sc1 lds
v_mfma_f32_32x32x16_bf16 v[72:87], v[156:159], v[148:151], v[72:87]
s_add_u32 m0, s29, 77824
s_add_u32 s59, s33, 4917248
v_mfma_f32_32x32x16_bf16 v[88:103], v[156:159], v[150:153], v[88:103]
buffer_load_dwordx4 v21, s[8:11], s59 offen sc1 lds
ds_read_b64_tr_b16 v[120:121], v14 offset:16384
ds_read_b64_tr_b16 v[122:123], v14 offset:17408
s_waitcnt lgkmcnt(8)
v_mfma_f32_32x32x16_bf16 v[40:55], a[112:115], v[104:107], v[40:55]
s_add_u32 m0, s29, 81920
s_add_u32 s59, s33, 4982784
ds_read_b64_tr_b16 v[124:125], v14 offset:20480
ds_read_b64_tr_b16 v[126:127], v14 offset:21504
s_waitcnt lgkmcnt(8)
v_mfma_f32_32x32x16_bf16 v[40:55], a[116:119], v[108:111], v[40:55]
buffer_load_dwordx4 v21, s[8:11], s59 offen sc1 lds
ds_read_b64_tr_b16 v[128:129], v14 offset:24576
ds_read_b64_tr_b16 v[130:131], v14 offset:25600
s_waitcnt lgkmcnt(8)
v_mfma_f32_32x32x16_bf16 v[40:55], a[120:123], v[112:115], v[40:55]
s_add_u32 m0, s29, 86016
s_add_u32 s59, s33, 5048320
ds_read_b64_tr_b16 v[132:133], v14 offset:28672
ds_read_b64_tr_b16 v[134:135], v14 offset:29696
s_waitcnt lgkmcnt(8)
v_mfma_f32_32x32x16_bf16 v[40:55], a[124:127], v[116:119], v[40:55]
buffer_load_dwordx4 v21, s[8:11], s59 offen sc1 lds
ds_read_b64_tr_b16 v[104:105], v15 offset:16384
ds_read_b64_tr_b16 v[106:107], v15 offset:17408
s_waitcnt lgkmcnt(8)
v_mfma_f32_32x32x16_bf16 v[56:71], a[112:115], v[120:123], v[56:71]
s_add_u32 m0, s29, 90112
s_add_u32 s59, s33, 5113856
ds_read_b64_tr_b16 v[108:109], v15 offset:20480
ds_read_b64_tr_b16 v[110:111], v15 offset:21504
s_waitcnt lgkmcnt(8)
v_mfma_f32_32x32x16_bf16 v[56:71], a[116:119], v[124:127], v[56:71]
buffer_load_dwordx4 v21, s[8:11], s59 offen sc1 lds
v_max_f32 v40, 0, v40
v_max_f32 v41, 0, v41
v_max_f32 v42, 0, v42
ds_read_b64_tr_b16 v[112:113], v15 offset:24576
ds_read_b64_tr_b16 v[114:115], v15 offset:25600
s_waitcnt lgkmcnt(8)
v_mfma_f32_32x32x16_bf16 v[56:71], a[120:123], v[128:131], v[56:71]
s_add_u32 m0, s29, 94208
s_add_u32 s59, s33, 5179392
v_max_f32 v43, 0, v43
v_max_f32 v44, 0, v44
v_max_f32 v45, 0, v45
ds_read_b64_tr_b16 v[116:117], v15 offset:28672
ds_read_b64_tr_b16 v[118:119], v15 offset:29696
s_waitcnt lgkmcnt(8)
v_mfma_f32_32x32x16_bf16 v[56:71], a[124:127], v[132:135], v[56:71]
buffer_load_dwordx4 v21, s[8:11], s59 offen sc1 lds
v_max_f32 v46, 0, v46
v_max_f32 v47, 0, v47
v_mul_f32 v40, v40, v48
ds_read_b64_tr_b16 v[120:121], v16 offset:16384
ds_read_b64_tr_b16 v[122:123], v16 offset:17408
s_waitcnt lgkmcnt(8)
v_mfma_f32_32x32x16_bf16 v[72:87], a[112:115], v[104:107], v[72:87]
s_add_u32 m0, s29, 0
s_add_u32 s59, s33, 5244928
v_mul_f32 v41, v41, v49
v_mul_f32 v42, v42, v50
v_mul_f32 v43, v43, v51
ds_read_b64_tr_b16 v[124:125], v16 offset:20480
ds_read_b64_tr_b16 v[126:127], v16 offset:21504
s_waitcnt lgkmcnt(8)
v_mfma_f32_32x32x16_bf16 v[72:87], a[116:119], v[108:111], v[72:87]
buffer_load_dwordx4 v21, s[8:11], s59 offen sc1 lds
v_mul_f32 v44, v44, v52
v_mul_f32 v45, v45, v53
v_mul_f32 v46, v46, v54
ds_read_b64_tr_b16 v[128:129], v16 offset:24576
ds_read_b64_tr_b16 v[130:131], v16 offset:25600
s_waitcnt lgkmcnt(8)
v_mfma_f32_32x32x16_bf16 v[72:87], a[120:123], v[112:115], v[72:87]
s_add_u32 s58, s44, 53248
buffer_load_dwordx4 v[240:243], v30, s[8:11], s58 offen sc1
v_mul_f32 v47, v47, v55
v_cvt_pk_bf16_f32 v48, v40, v41
v_cvt_pk_bf16_f32 v49, v42, v43
ds_read_b64_tr_b16 v[132:133], v16 offset:28672
ds_read_b64_tr_b16 v[134:135], v16 offset:29696
s_waitcnt lgkmcnt(8)
v_mfma_f32_32x32x16_bf16 v[72:87], a[124:127], v[116:119], v[72:87]
v_cvt_pk_bf16_f32 v50, v44, v45
v_cvt_pk_bf16_f32 v51, v46, v47
s_add_u32 s67, s34, 16777216
s_waitcnt vmcnt(14)
s_barrier
ds_read_b64_tr_b16 v[104:105], v13 offset:32768
ds_read_b64_tr_b16 v[106:107], v13 offset:33792
s_waitcnt lgkmcnt(8)
v_mfma_f32_32x32x16_bf16 v[88:103], a[112:115], v[120:123], v[88:103]
s_add_u32 m0, s29, 4096
s_add_u32 s59, s33, 5310464
buffer_store_dwordx4 v[48:51], v22, s[8:11], s67 offen sc1
ds_read_b64_tr_b16 v[108:109], v13 offset:36864
ds_read_b64_tr_b16 v[110:111], v13 offset:37888
s_waitcnt lgkmcnt(8)
v_mfma_f32_32x32x16_bf16 v[88:103], a[116:119], v[124:127], v[88:103]
buffer_load_dwordx4 v21, s[8:11], s59 offen sc1 lds
ds_read_b64_tr_b16 v[112:113], v13 offset:40960
ds_read_b64_tr_b16 v[114:115], v13 offset:41984
s_waitcnt lgkmcnt(8)
v_mfma_f32_32x32x16_bf16 v[88:103], a[120:123], v[128:131], v[88:103]
v_max_f32 v56, 0, v56
v_max_f32 v57, 0, v57
v_max_f32 v58, 0, v58
ds_read_b64_tr_b16 v[116:117], v13 offset:45056
ds_read_b64_tr_b16 v[118:119], v13 offset:46080
s_waitcnt lgkmcnt(8)
v_mfma_f32_32x32x16_bf16 v[88:103], a[124:127], v[132:135], v[88:103]
v_max_f32 v59, 0, v59
v_max_f32 v60, 0, v60
v_max_f32 v61, 0, v61
ds_read_b64_tr_b16 v[120:121], v14 offset:32768
ds_read_b64_tr_b16 v[122:123], v14 offset:33792
s_waitcnt lgkmcnt(8)
v_mfma_f32_32x32x16_bf16 v[40:55], a[0:3], v[104:107], 0
s_add_u32 m0, s29, 8192
s_add_u32 s59, s33, 5376000
v_max_f32 v62, 0, v62
v_max_f32 v63, 0, v63
v_mul_f32 v56, v56, v64
ds_read_b64_tr_b16 v[124:125], v14 offset:36864
ds_read_b64_tr_b16 v[126:127], v14 offset:37888
s_waitcnt lgkmcnt(8)
v_mfma_f32_32x32x16_bf16 v[40:55], a[4:7], v[108:111], v[40:55]
buffer_load_dwordx4 v21, s[8:11], s59 offen sc1 lds
v_mul_f32 v57, v57, v65
v_mul_f32 v58, v58, v66
v_mul_f32 v59, v59, v67
ds_read_b64_tr_b16 v[128:129], v14 offset:40960
ds_read_b64_tr_b16 v[130:131], v14 offset:41984
s_waitcnt lgkmcnt(8)
v_mfma_f32_32x32x16_bf16 v[40:55], a[8:11], v[112:115], v[40:55]
s_add_u32 m0, s29, 12288
s_add_u32 s59, s33, 5441536
v_mul_f32 v60, v60, v68
v_mul_f32 v61, v61, v69
v_mul_f32 v62, v62, v70
ds_read_b64_tr_b16 v[132:133], v14 offset:45056
ds_read_b64_tr_b16 v[134:135], v14 offset:46080
s_waitcnt lgkmcnt(8)
v_mfma_f32_32x32x16_bf16 v[40:55], a[12:15], v[116:119], v[40:55]
buffer_load_dwordx4 v21, s[8:11], s59 offen sc1 lds
v_mul_f32 v63, v63, v71
v_cvt_pk_bf16_f32 v64, v56, v57
v_cvt_pk_bf16_f32 v65, v58, v59
ds_read_b64_tr_b16 v[104:105], v15 offset:32768
ds_read_b64_tr_b16 v[106:107], v15 offset:33792
s_waitcnt lgkmcnt(8)
v_cvt_pk_bf16_f32 v66, v60, v61
v_cvt_pk_bf16_f32 v67, v62, v63
s_add_u32 s67, s34, 16891904
buffer_store_dwordx4 v[64:67], v22, s[8:11], s67 offen sc1
s_nop 1
v_mfma_f32_32x32x16_bf16 v[56:71], a[0:3], v[120:123], 0
s_add_u32 s58, s91, 53248
buffer_load_dwordx4 v[244:247], v30, s[8:11], s58 offen sc1
ds_read_b64_tr_b16 v[108:109], v15 offset:36864
ds_read_b64_tr_b16 v[110:111], v15 offset:37888
s_waitcnt lgkmcnt(8)
v_mfma_f32_32x32x16_bf16 v[56:71], a[4:7], v[124:127], v[56:71]
ds_read_b64_tr_b16 v[112:113], v15 offset:40960
ds_read_b64_tr_b16 v[114:115], v15 offset:41984
s_waitcnt lgkmcnt(8)
v_mfma_f32_32x32x16_bf16 v[56:71], a[8:11], v[128:131], v[56:71]
v_max_f32 v72, 0, v72
v_max_f32 v73, 0, v73
v_max_f32 v74, 0, v74
ds_read_b64_tr_b16 v[116:117], v15 offset:45056
ds_read_b64_tr_b16 v[118:119], v15 offset:46080
s_waitcnt lgkmcnt(8)
v_mfma_f32_32x32x16_bf16 v[56:71], a[12:15], v[132:135], v[56:71]
v_max_f32 v75, 0, v75
v_max_f32 v76, 0, v76
v_max_f32 v77, 0, v77
ds_read_b64_tr_b16 v[120:121], v16 offset:32768
ds_read_b64_tr_b16 v[122:123], v16 offset:33792
s_waitcnt lgkmcnt(8)
v_max_f32 v78, 0, v78
v_max_f32 v79, 0, v79
v_mul_f32 v72, v72, v80
v_mul_f32 v73, v73, v81
v_mul_f32 v74, v74, v82
v_mul_f32 v75, v75, v83
v_mul_f32 v76, v76, v84
v_mul_f32 v77, v77, v85
v_mul_f32 v78, v78, v86
v_mul_f32 v79, v79, v87
v_cvt_pk_bf16_f32 v80, v72, v73
v_cvt_pk_bf16_f32 v81, v74, v75
v_cvt_pk_bf16_f32 v82, v76, v77
v_cvt_pk_bf16_f32 v83, v78, v79
s_add_u32 s67, s34, 17006592
buffer_store_dwordx4 v[80:83], v22, s[8:11], s67 offen sc1
s_nop 1
v_mfma_f32_32x32x16_bf16 v[72:87], a[0:3], v[104:107], 0
ds_read_b64_tr_b16 v[124:125], v16 offset:36864
ds_read_b64_tr_b16 v[126:127], v16 offset:37888
s_waitcnt lgkmcnt(8)
v_mfma_f32_32x32x16_bf16 v[72:87], a[4:7], v[108:111], v[72:87]
ds_read_b64_tr_b16 v[128:129], v16 offset:40960
ds_read_b64_tr_b16 v[130:131], v16 offset:41984
s_waitcnt lgkmcnt(8)
v_mfma_f32_32x32x16_bf16 v[72:87], a[8:11], v[112:115], v[72:87]
s_add_u32 s58, s44, 55296
buffer_load_dwordx4 v[248:251], v30, s[8:11], s58 offen sc1
v_max_f32 v88, 0, v88
v_max_f32 v89, 0, v89
v_max_f32 v90, 0, v90
ds_read_b64_tr_b16 v[132:133], v16 offset:45056
ds_read_b64_tr_b16 v[134:135], v16 offset:46080
s_waitcnt lgkmcnt(8)
v_mfma_f32_32x32x16_bf16 v[72:87], a[12:15], v[116:119], v[72:87]
v_max_f32 v91, 0, v91
v_max_f32 v92, 0, v92
v_max_f32 v93, 0, v93
s_waitcnt vmcnt(18)
s_barrier
ds_read_b64_tr_b16 v[104:105], v17 offset:0
ds_read_b64_tr_b16 v[106:107], v17 offset:1024
s_waitcnt lgkmcnt(8)
v_max_f32 v94, 0, v94
v_max_f32 v95, 0, v95
v_mul_f32 v88, v88, v96
v_mul_f32 v89, v89, v97
v_mul_f32 v90, v90, v98
v_mul_f32 v91, v91, v99
v_mul_f32 v92, v92, v100
v_mul_f32 v93, v93, v101
v_mul_f32 v94, v94, v102
v_mul_f32 v95, v95, v103
v_cvt_pk_bf16_f32 v96, v88, v89
v_cvt_pk_bf16_f32 v97, v90, v91
v_cvt_pk_bf16_f32 v98, v92, v93
v_cvt_pk_bf16_f32 v99, v94, v95
s_add_u32 s67, s34, 17121280
buffer_store_dwordx4 v[96:99], v22, s[8:11], s67 offen sc1
s_nop 1
v_mfma_f32_32x32x16_bf16 v[88:103], a[0:3], v[120:123], 0
s_add_u32 m0, s29, 16384
s_add_u32 s59, s33, 5507072
ds_read_b64_tr_b16 v[108:109], v18 offset:0
ds_read_b64_tr_b16 v[110:111], v18 offset:1024
s_waitcnt lgkmcnt(8)
v_mfma_f32_32x32x16_bf16 v[88:103], a[4:7], v[124:127], v[88:103]
buffer_load_dwordx4 v21, s[8:11], s59 offen sc1 lds
ds_read_b64_tr_b16 v[112:113], v19 offset:0
ds_read_b64_tr_b16 v[114:115], v19 offset:1024
s_waitcnt lgkmcnt(8)
v_mfma_f32_32x32x16_bf16 v[88:103], a[8:11], v[128:131], v[88:103]
ds_read_b64_tr_b16 v[116:117], v20 offset:0
ds_read_b64_tr_b16 v[118:119], v20 offset:1024
s_waitcnt lgkmcnt(8)
v_mfma_f32_32x32x16_bf16 v[88:103], a[12:15], v[132:135], v[88:103]
ds_read_b64_tr_b16 v[120:121], v17 offset:4096
ds_read_b64_tr_b16 v[122:123], v17 offset:5120
s_waitcnt lgkmcnt(8)
v_mfma_f32_32x32x16_bf16 v[40:55], a[16:19], v[104:107], v[40:55]
s_add_u32 m0, s29, 20480
s_add_u32 s59, s33, 5572608
ds_read_b64_tr_b16 v[124:125], v18 offset:4096
ds_read_b64_tr_b16 v[126:127], v18 offset:5120
s_waitcnt lgkmcnt(8)
v_mfma_f32_32x32x16_bf16 v[56:71], a[16:19], v[108:111], v[56:71]
buffer_load_dwordx4 v21, s[8:11], s59 offen sc1 lds
ds_read_b64_tr_b16 v[128:129], v19 offset:4096
ds_read_b64_tr_b16 v[130:131], v19 offset:5120
s_waitcnt lgkmcnt(8)
v_mfma_f32_32x32x16_bf16 v[72:87], a[16:19], v[112:115], v[72:87]
s_add_u32 s58, s91, 55296
buffer_load_dwordx4 v[252:255], v30, s[8:11], s58 offen sc1
ds_read_b64_tr_b16 v[132:133], v20 offset:4096
ds_read_b64_tr_b16 v[134:135], v20 offset:5120
s_waitcnt lgkmcnt(8)
v_mfma_f32_32x32x16_bf16 v[88:103], a[16:19], v[116:119], v[88:103]
ds_read_b64_tr_b16 v[104:105], v17 offset:8192
ds_read_b64_tr_b16 v[106:107], v17 offset:9216
s_waitcnt lgkmcnt(8)
v_mfma_f32_32x32x16_bf16 v[40:55], a[20:23], v[120:123], v[40:55]
s_add_u32 m0, s29, 24576
s_add_u32 s59, s33, 5638144
ds_read_b64_tr_b16 v[108:109], v18 offset:8192
ds_read_b64_tr_b16 v[110:111], v18 offset:9216
s_waitcnt lgkmcnt(8)
v_mfma_f32_32x32x16_bf16 v[56:71], a[20:23], v[124:127], v[56:71]
buffer_load_dwordx4 v21, s[8:11], s59 offen sc1 lds
ds_read_b64_tr_b16 v[112:113], v19 offset:8192
ds_read_b64_tr_b16 v[114:115], v19 offset:9216
s_waitcnt lgkmcnt(8)
v_mfma_f32_32x32x16_bf16 v[72:87], a[20:23], v[128:131], v[72:87]
ds_read_b64_tr_b16 v[116:117], v20 offset:8192
ds_read_b64_tr_b16 v[118:119], v20 offset:9216
s_waitcnt lgkmcnt(8)
v_mfma_f32_32x32x16_bf16 v[88:103], a[20:23], v[132:135], v[88:103]
ds_read_b64_tr_b16 v[120:121], v17 offset:12288
ds_read_b64_tr_b16 v[122:123], v17 offset:13312
s_waitcnt lgkmcnt(8)
v_mfma_f32_32x32x16_bf16 v[40:55], a[24:27], v[104:107], v[40:55]
s_add_u32 m0, s29, 28672
s_add_u32 s59, s33, 5703680
ds_read_b64_tr_b16 v[124:125], v18 offset:12288
ds_read_b64_tr_b16 v[126:127], v18 offset:13312
s_waitcnt lgkmcnt(8)
v_mfma_f32_32x32x16_bf16 v[56:71], a[24:27], v[108:111], v[56:71]
buffer_load_dwordx4 v21, s[8:11], s59 offen sc1 lds
ds_read_b64_tr_b16 v[128:129], v19 offset:12288
ds_read_b64_tr_b16 v[130:131], v19 offset:13312
s_waitcnt lgkmcnt(8)
v_mfma_f32_32x32x16_bf16 v[72:87], a[24:27], v[112:115], v[72:87]
ds_read_b64_tr_b16 v[132:133], v20 offset:12288
ds_read_b64_tr_b16 v[134:135], v20 offset:13312
s_waitcnt lgkmcnt(8)
v_mfma_f32_32x32x16_bf16 v[88:103], a[24:27], v[116:119], v[88:103]
s_waitcnt vmcnt(20)
s_barrier
ds_read_b64_tr_b16 v[104:105], v17 offset:16384
ds_read_b64_tr_b16 v[106:107], v17 offset:17408
s_waitcnt lgkmcnt(8)
v_mfma_f32_32x32x16_bf16 v[40:55], a[28:31], v[120:123], v[40:55]
s_add_u32 m0, s29, 32768
s_add_u32 s59, s33, 5769216
ds_read_b64_tr_b16 v[108:109], v18 offset:16384
ds_read_b64_tr_b16 v[110:111], v18 offset:17408
s_waitcnt lgkmcnt(8)
v_mfma_f32_32x32x16_bf16 v[56:71], a[28:31], v[124:127], v[56:71]
buffer_load_dwordx4 v21, s[8:11], s59 offen sc1 lds
ds_read_b64_tr_b16 v[112:113], v19 offset:16384
ds_read_b64_tr_b16 v[114:115], v19 offset:17408
s_waitcnt lgkmcnt(8)
v_mfma_f32_32x32x16_bf16 v[72:87], a[28:31], v[128:131], v[72:87]
ds_read_b64_tr_b16 v[116:117], v20 offset:16384
ds_read_b64_tr_b16 v[118:119], v20 offset:17408
s_waitcnt lgkmcnt(8)
v_mfma_f32_32x32x16_bf16 v[88:103], a[28:31], v[132:135], v[88:103]
ds_read_b64_tr_b16 v[120:121], v17 offset:20480
ds_read_b64_tr_b16 v[122:123], v17 offset:21504
s_waitcnt lgkmcnt(8)
v_mfma_f32_32x32x16_bf16 v[40:55], a[32:35], v[104:107], v[40:55]
s_add_u32 m0, s29, 36864
s_add_u32 s59, s33, 5834752
ds_read_b64_tr_b16 v[124:125], v18 offset:20480
ds_read_b64_tr_b16 v[126:127], v18 offset:21504
s_waitcnt lgkmcnt(8)
v_mfma_f32_32x32x16_bf16 v[56:71], a[32:35], v[108:111], v[56:71]
buffer_load_dwordx4 v21, s[8:11], s59 offen sc1 lds
ds_read_b64_tr_b16 v[128:129], v19 offset:20480
ds_read_b64_tr_b16 v[130:131], v19 offset:21504
s_waitcnt lgkmcnt(8)
v_mfma_f32_32x32x16_bf16 v[72:87], a[32:35], v[112:115], v[72:87]
ds_read_b64_tr_b16 v[132:133], v20 offset:20480
ds_read_b64_tr_b16 v[134:135], v20 offset:21504
s_waitcnt lgkmcnt(8)
v_mfma_f32_32x32x16_bf16 v[88:103], a[32:35], v[116:119], v[88:103]
ds_read_b64_tr_b16 v[104:105], v17 offset:24576
ds_read_b64_tr_b16 v[106:107], v17 offset:25600
s_waitcnt lgkmcnt(8)
v_mfma_f32_32x32x16_bf16 v[40:55], a[36:39], v[120:123], v[40:55]
s_add_u32 m0, s29, 40960
s_add_u32 s59, s33, 5900288
ds_read_b64_tr_b16 v[108:109], v18 offset:24576
ds_read_b64_tr_b16 v[110:111], v18 offset:25600
s_waitcnt lgkmcnt(8)
v_mfma_f32_32x32x16_bf16 v[56:71], a[36:39], v[124:127], v[56:71]
buffer_load_dwordx4 v21, s[8:11], s59 offen sc1 lds
ds_read_b64_tr_b16 v[112:113], v19 offset:24576
ds_read_b64_tr_b16 v[114:115], v19 offset:25600
s_waitcnt lgkmcnt(8)
v_mfma_f32_32x32x16_bf16 v[72:87], a[36:39], v[128:131], v[72:87]
ds_read_b64_tr_b16 v[116:117], v20 offset:24576
ds_read_b64_tr_b16 v[118:119], v20 offset:25600
s_waitcnt lgkmcnt(8)
v_mfma_f32_32x32x16_bf16 v[88:103], a[36:39], v[132:135], v[88:103]
ds_read_b64_tr_b16 v[120:121], v17 offset:28672
ds_read_b64_tr_b16 v[122:123], v17 offset:29696
s_waitcnt lgkmcnt(8)
v_mfma_f32_32x32x16_bf16 v[40:55], a[40:43], v[104:107], v[40:55]
s_add_u32 m0, s29, 45056
s_add_u32 s59, s33, 5965824
s_waitcnt vmcnt(8)
s_add_u32 s63, s31, 0
v_mov_b32 v38, 0
s_mov_b64 exec, 1
buffer_atomic_add v35, v38, s[8:11], s63 offen sc1
s_mov_b64 exec, -1
ds_read_b64_tr_b16 v[124:125], v18 offset:28672
ds_read_b64_tr_b16 v[126:127], v18 offset:29696
s_waitcnt lgkmcnt(8)
v_mfma_f32_32x32x16_bf16 v[56:71], a[40:43], v[108:111], v[56:71]
buffer_load_dwordx4 v21, s[8:11], s59 offen sc1 lds
ds_read_b64_tr_b16 v[128:129], v19 offset:28672
ds_read_b64_tr_b16 v[130:131], v19 offset:29696
s_waitcnt lgkmcnt(8)
v_mfma_f32_32x32x16_bf16 v[72:87], a[40:43], v[112:115], v[72:87]
ds_read_b64_tr_b16 v[132:133], v20 offset:28672
ds_read_b64_tr_b16 v[134:135], v20 offset:29696
s_waitcnt lgkmcnt(8)
v_mfma_f32_32x32x16_bf16 v[88:103], a[40:43], v[116:119], v[88:103]
s_barrier
ds_read_b64_tr_b16 v[104:105], v17 offset:32768
ds_read_b64_tr_b16 v[106:107], v17 offset:33792
s_waitcnt lgkmcnt(8)
v_mfma_f32_32x32x16_bf16 v[40:55], a[44:47], v[120:123], v[40:55]
s_add_u32 m0, s29, 49152
s_add_u32 s59, s33, 6031360
ds_read_b64_tr_b16 v[108:109], v18 offset:32768
ds_read_b64_tr_b16 v[110:111], v18 offset:33792
s_waitcnt lgkmcnt(8)
v_mfma_f32_32x32x16_bf16 v[56:71], a[44:47], v[124:127], v[56:71]
buffer_load_dwordx4 v21, s[8:11], s59 offen sc1 lds
ds_read_b64_tr_b16 v[112:113], v19 offset:32768
ds_read_b64_tr_b16 v[114:115], v19 offset:33792
s_waitcnt lgkmcnt(8)
v_mfma_f32_32x32x16_bf16 v[72:87], a[44:47], v[128:131], v[72:87]
s_add_u32 s66, s39, 139264
ds_read_b64_tr_b16 v[116:117], v20 offset:32768
ds_read_b64_tr_b16 v[118:119], v20 offset:33792
s_waitcnt lgkmcnt(8)
v_mfma_f32_32x32x16_bf16 v[88:103], a[44:47], v[132:135], v[88:103]
buffer_load_dwordx2 v[136:137], v23, s[8:11], s66 offen offset:0 sc1
ds_read_b64_tr_b16 v[120:121], v17 offset:36864
ds_read_b64_tr_b16 v[122:123], v17 offset:37888
s_waitcnt lgkmcnt(8)
v_mfma_f32_32x32x16_bf16 v[40:55], a[48:51], v[104:107], v[40:55]
s_add_u32 m0, s29, 53248
s_add_u32 s59, s33, 6096896
ds_read_b64_tr_b16 v[124:125], v18 offset:36864
ds_read_b64_tr_b16 v[126:127], v18 offset:37888
s_waitcnt lgkmcnt(8)
v_mfma_f32_32x32x16_bf16 v[56:71], a[48:51], v[108:111], v[56:71]
buffer_load_dwordx4 v21, s[8:11], s59 offen sc1 lds
ds_read_b64_tr_b16 v[128:129], v19 offset:36864
ds_read_b64_tr_b16 v[130:131], v19 offset:37888
s_waitcnt lgkmcnt(8)
v_mfma_f32_32x32x16_bf16 v[72:87], a[48:51], v[112:115], v[72:87]
ds_read_b64_tr_b16 v[132:133], v20 offset:36864
ds_read_b64_tr_b16 v[134:135], v20 offset:37888
s_waitcnt lgkmcnt(8)
v_mfma_f32_32x32x16_bf16 v[88:103], a[48:51], v[116:119], v[88:103]
buffer_load_dwordx2 v[138:139], v23, s[8:11], s66 offen offset:256 sc1
ds_read_b64_tr_b16 v[104:105], v17 offset:40960
ds_read_b64_tr_b16 v[106:107], v17 offset:41984
s_waitcnt lgkmcnt(8)
v_mfma_f32_32x32x16_bf16 v[40:55], a[52:55], v[120:123], v[40:55]
s_add_u32 m0, s29, 57344
s_add_u32 s59, s33, 6162432
ds_read_b64_tr_b16 v[108:109], v18 offset:40960
ds_read_b64_tr_b16 v[110:111], v18 offset:41984
s_waitcnt lgkmcnt(8)
v_mfma_f32_32x32x16_bf16 v[56:71], a[52:55], v[124:127], v[56:71]
buffer_load_dwordx4 v21, s[8:11], s59 offen sc1 lds
ds_read_b64_tr_b16 v[112:113], v19 offset:40960
ds_read_b64_tr_b16 v[114:115], v19 offset:41984
s_waitcnt lgkmcnt(8)
v_mfma_f32_32x32x16_bf16 v[72:87], a[52:55], v[128:131], v[72:87]
ds_read_b64_tr_b16 v[116:117], v20 offset:40960
ds_read_b64_tr_b16 v[118:119], v20 offset:41984
s_waitcnt lgkmcnt(8)
v_mfma_f32_32x32x16_bf16 v[88:103], a[52:55], v[132:135], v[88:103]
buffer_load_dwordx2 v[140:141], v23, s[8:11], s66 offen offset:512 sc1
ds_read_b64_tr_b16 v[120:121], v17 offset:45056
ds_read_b64_tr_b16 v[122:123], v17 offset:46080
s_waitcnt lgkmcnt(8)
v_mfma_f32_32x32x16_bf16 v[40:55], a[56:59], v[104:107], v[40:55]
s_add_u32 m0, s29, 61440
s_add_u32 s59, s33, 6227968
ds_read_b64_tr_b16 v[124:125], v18 offset:45056
ds_read_b64_tr_b16 v[126:127], v18 offset:46080
s_waitcnt lgkmcnt(8)
v_mfma_f32_32x32x16_bf16 v[56:71], a[56:59], v[108:111], v[56:71]
buffer_load_dwordx4 v21, s[8:11], s59 offen sc1 lds
ds_read_b64_tr_b16 v[128:129], v19 offset:45056
ds_read_b64_tr_b16 v[130:131], v19 offset:46080
s_waitcnt lgkmcnt(8)
v_mfma_f32_32x32x16_bf16 v[72:87], a[56:59], v[112:115], v[72:87]
ds_read_b64_tr_b16 v[132:133], v20 offset:45056
ds_read_b64_tr_b16 v[134:135], v20 offset:46080
s_waitcnt lgkmcnt(8)
v_mfma_f32_32x32x16_bf16 v[88:103], a[56:59], v[116:119], v[88:103]
buffer_load_dwordx2 v[142:143], v23, s[8:11], s66 offen offset:768 sc1
s_barrier
ds_read_b64_tr_b16 v[104:105], v13 offset:0
ds_read_b64_tr_b16 v[106:107], v13 offset:1024
s_waitcnt lgkmcnt(8)
v_mfma_f32_32x32x16_bf16 v[40:55], a[60:63], v[120:123], v[40:55]
ds_read_b64_tr_b16 v[108:109], v14 offset:0
ds_read_b64_tr_b16 v[110:111], v14 offset:1024
s_waitcnt lgkmcnt(8)
v_mfma_f32_32x32x16_bf16 v[56:71], a[60:63], v[124:127], v[56:71]
ds_read_b64_tr_b16 v[112:113], v15 offset:0
ds_read_b64_tr_b16 v[114:115], v15 offset:1024
s_waitcnt lgkmcnt(8)
v_mfma_f32_32x32x16_bf16 v[72:87], a[60:63], v[128:131], v[72:87]
ds_read_b64_tr_b16 v[116:117], v16 offset:0
ds_read_b64_tr_b16 v[118:119], v16 offset:1024
s_waitcnt lgkmcnt(8)
v_mfma_f32_32x32x16_bf16 v[88:103], a[60:63], v[132:135], v[88:103]
ds_read_b64_tr_b16 v[120:121], v13 offset:4096
ds_read_b64_tr_b16 v[122:123], v13 offset:5120
s_waitcnt lgkmcnt(8)
v_mfma_f32_32x32x16_bf16 v[40:55], a[64:67], v[104:107], v[40:55]
ds_read_b64_tr_b16 v[124:125], v14 offset:4096
ds_read_b64_tr_b16 v[126:127], v14 offset:5120
s_waitcnt lgkmcnt(8)
v_mfma_f32_32x32x16_bf16 v[56:71], a[64:67], v[108:111], v[56:71]
ds_read_b64_tr_b16 v[128:129], v15 offset:4096
ds_read_b64_tr_b16 v[130:131], v15 offset:5120
s_waitcnt lgkmcnt(8)
v_mfma_f32_32x32x16_bf16 v[72:87], a[64:67], v[112:115], v[72:87]
ds_read_b64_tr_b16 v[132:133], v16 offset:4096
ds_read_b64_tr_b16 v[134:135], v16 offset:5120
s_waitcnt lgkmcnt(8)
v_mfma_f32_32x32x16_bf16 v[88:103], a[64:67], v[116:119], v[88:103]
ds_read_b64_tr_b16 v[104:105], v13 offset:8192
ds_read_b64_tr_b16 v[106:107], v13 offset:9216
s_waitcnt lgkmcnt(8)
v_mfma_f32_32x32x16_bf16 v[40:55], a[68:71], v[120:123], v[40:55]
ds_read_b64_tr_b16 v[108:109], v14 offset:8192
ds_read_b64_tr_b16 v[110:111], v14 offset:9216
s_waitcnt lgkmcnt(8)
v_mfma_f32_32x32x16_bf16 v[56:71], a[68:71], v[124:127], v[56:71]
ds_read_b64_tr_b16 v[112:113], v15 offset:8192
ds_read_b64_tr_b16 v[114:115], v15 offset:9216
s_waitcnt lgkmcnt(8)
v_mfma_f32_32x32x16_bf16 v[72:87], a[68:71], v[128:131], v[72:87]
ds_read_b64_tr_b16 v[116:117], v16 offset:8192
ds_read_b64_tr_b16 v[118:119], v16 offset:9216
s_waitcnt lgkmcnt(8)
v_mfma_f32_32x32x16_bf16 v[88:103], a[68:71], v[132:135], v[88:103]
ds_read_b64_tr_b16 v[120:121], v13 offset:12288
ds_read_b64_tr_b16 v[122:123], v13 offset:13312
s_waitcnt lgkmcnt(8)
v_mfma_f32_32x32x16_bf16 v[40:55], a[72:75], v[104:107], v[40:55]
ds_read_b64_tr_b16 v[124:125], v14 offset:12288
ds_read_b64_tr_b16 v[126:127], v14 offset:13312
s_waitcnt lgkmcnt(8)
v_mfma_f32_32x32x16_bf16 v[56:71], a[72:75], v[108:111], v[56:71]
ds_read_b64_tr_b16 v[128:129], v15 offset:12288
ds_read_b64_tr_b16 v[130:131], v15 offset:13312
s_waitcnt lgkmcnt(8)
v_mfma_f32_32x32x16_bf16 v[72:87], a[72:75], v[112:115], v[72:87]
ds_read_b64_tr_b16 v[132:133], v16 offset:12288
ds_read_b64_tr_b16 v[134:135], v16 offset:13312
s_waitcnt lgkmcnt(8)
v_mfma_f32_32x32x16_bf16 v[88:103], a[72:75], v[116:119], v[88:103]
s_waitcnt vmcnt(13)
s_barrier
ds_read_b64_tr_b16 v[104:105], v13 offset:16384
ds_read_b64_tr_b16 v[106:107], v13 offset:17408
s_waitcnt lgkmcnt(8)
v_mfma_f32_32x32x16_bf16 v[40:55], a[76:79], v[120:123], v[40:55]
ds_read_b64_tr_b16 v[108:109], v14 offset:16384
ds_read_b64_tr_b16 v[110:111], v14 offset:17408
s_waitcnt lgkmcnt(8)
v_mfma_f32_32x32x16_bf16 v[56:71], a[76:79], v[124:127], v[56:71]
ds_read_b64_tr_b16 v[112:113], v15 offset:16384
ds_read_b64_tr_b16 v[114:115], v15 offset:17408
s_waitcnt lgkmcnt(8)
v_mfma_f32_32x32x16_bf16 v[72:87], a[76:79], v[128:131], v[72:87]
ds_read_b64_tr_b16 v[116:117], v16 offset:16384
ds_read_b64_tr_b16 v[118:119], v16 offset:17408
s_waitcnt lgkmcnt(8)
v_mfma_f32_32x32x16_bf16 v[88:103], a[76:79], v[132:135], v[88:103]
ds_read_b64_tr_b16 v[120:121], v13 offset:20480
ds_read_b64_tr_b16 v[122:123], v13 offset:21504
s_waitcnt lgkmcnt(8)
v_mfma_f32_32x32x16_bf16 v[40:55], a[80:83], v[104:107], v[40:55]
ds_read_b64_tr_b16 v[124:125], v14 offset:20480
ds_read_b64_tr_b16 v[126:127], v14 offset:21504
s_waitcnt lgkmcnt(8)
v_mfma_f32_32x32x16_bf16 v[56:71], a[80:83], v[108:111], v[56:71]
ds_read_b64_tr_b16 v[128:129], v15 offset:20480
ds_read_b64_tr_b16 v[130:131], v15 offset:21504
s_waitcnt lgkmcnt(8)
v_mfma_f32_32x32x16_bf16 v[72:87], a[80:83], v[112:115], v[72:87]
ds_read_b64_tr_b16 v[132:133], v16 offset:20480
ds_read_b64_tr_b16 v[134:135], v16 offset:21504
s_waitcnt lgkmcnt(8)
v_mfma_f32_32x32x16_bf16 v[88:103], a[80:83], v[116:119], v[88:103]
ds_read_b64_tr_b16 v[104:105], v13 offset:24576
ds_read_b64_tr_b16 v[106:107], v13 offset:25600
s_waitcnt lgkmcnt(8)
v_mfma_f32_32x32x16_bf16 v[40:55], a[84:87], v[120:123], v[40:55]
ds_read_b64_tr_b16 v[108:109], v14 offset:24576
ds_read_b64_tr_b16 v[110:111], v14 offset:25600
s_waitcnt lgkmcnt(8)
v_mfma_f32_32x32x16_bf16 v[56:71], a[84:87], v[124:127], v[56:71]
ds_read_b64_tr_b16 v[112:113], v15 offset:24576
ds_read_b64_tr_b16 v[114:115], v15 offset:25600
s_waitcnt lgkmcnt(8)
v_mfma_f32_32x32x16_bf16 v[72:87], a[84:87], v[128:131], v[72:87]
ds_read_b64_tr_b16 v[116:117], v16 offset:24576
ds_read_b64_tr_b16 v[118:119], v16 offset:25600
s_waitcnt lgkmcnt(8)
v_mfma_f32_32x32x16_bf16 v[88:103], a[84:87], v[132:135], v[88:103]
ds_read_b64_tr_b16 v[120:121], v13 offset:28672
ds_read_b64_tr_b16 v[122:123], v13 offset:29696
s_waitcnt lgkmcnt(8)
v_mfma_f32_32x32x16_bf16 v[40:55], a[88:91], v[104:107], v[40:55]
ds_read_b64_tr_b16 v[124:125], v14 offset:28672
ds_read_b64_tr_b16 v[126:127], v14 offset:29696
s_waitcnt lgkmcnt(8)
v_mfma_f32_32x32x16_bf16 v[56:71], a[88:91], v[108:111], v[56:71]
ds_read_b64_tr_b16 v[128:129], v15 offset:28672
ds_read_b64_tr_b16 v[130:131], v15 offset:29696
s_waitcnt lgkmcnt(8)
v_mfma_f32_32x32x16_bf16 v[72:87], a[88:91], v[112:115], v[72:87]
ds_read_b64_tr_b16 v[132:133], v16 offset:28672
ds_read_b64_tr_b16 v[134:135], v16 offset:29696
s_waitcnt lgkmcnt(8)
v_mfma_f32_32x32x16_bf16 v[88:103], a[88:91], v[116:119], v[88:103]
s_waitcnt vmcnt(8)
s_barrier
ds_read_b64_tr_b16 v[104:105], v13 offset:32768
ds_read_b64_tr_b16 v[106:107], v13 offset:33792
s_waitcnt lgkmcnt(8)
v_mfma_f32_32x32x16_bf16 v[40:55], a[92:95], v[120:123], v[40:55]
s_add_u32 s65, s40, 0
buffer_load_dword v34, v4, s[8:11], s65 offen sc1
ds_read_b64_tr_b16 v[108:109], v14 offset:32768
ds_read_b64_tr_b16 v[110:111], v14 offset:33792
s_waitcnt lgkmcnt(8)
v_mfma_f32_32x32x16_bf16 v[56:71], a[92:95], v[124:127], v[56:71]
ds_read_b64_tr_b16 v[112:113], v15 offset:32768
ds_read_b64_tr_b16 v[114:115], v15 offset:33792
s_waitcnt lgkmcnt(8)
v_mfma_f32_32x32x16_bf16 v[72:87], a[92:95], v[128:131], v[72:87]
ds_read_b64_tr_b16 v[116:117], v16 offset:32768
ds_read_b64_tr_b16 v[118:119], v16 offset:33792
s_waitcnt lgkmcnt(8)
v_mfma_f32_32x32x16_bf16 v[88:103], a[92:95], v[132:135], v[88:103]
ds_read_b64_tr_b16 v[120:121], v13 offset:36864
ds_read_b64_tr_b16 v[122:123], v13 offset:37888
s_waitcnt lgkmcnt(8)
v_mfma_f32_32x32x16_bf16 v[40:55], a[96:99], v[104:107], v[40:55]
ds_read_b64_tr_b16 v[124:125], v14 offset:36864
ds_read_b64_tr_b16 v[126:127], v14 offset:37888
s_waitcnt lgkmcnt(8)
v_mfma_f32_32x32x16_bf16 v[56:71], a[96:99], v[108:111], v[56:71]
ds_read_b64_tr_b16 v[128:129], v15 offset:36864
ds_read_b64_tr_b16 v[130:131], v15 offset:37888
s_waitcnt lgkmcnt(8)
v_mfma_f32_32x32x16_bf16 v[72:87], a[96:99], v[112:115], v[72:87]
ds_read_b64_tr_b16 v[132:133], v16 offset:36864
ds_read_b64_tr_b16 v[134:135], v16 offset:37888
s_waitcnt lgkmcnt(8)
v_mfma_f32_32x32x16_bf16 v[88:103], a[96:99], v[116:119], v[88:103]
ds_read_b64_tr_b16 v[104:105], v13 offset:40960
ds_read_b64_tr_b16 v[106:107], v13 offset:41984
s_waitcnt lgkmcnt(8)
v_mfma_f32_32x32x16_bf16 v[40:55], a[100:103], v[120:123], v[40:55]
s_waitcnt vmcnt(1)
s_mov_b32 s62, 0x03020302
v_and_b32 v152, v136, v138
v_and_b32 v153, v140, v142
ds_read_b64_tr_b16 v[108:109], v14 offset:40960
ds_read_b64_tr_b16 v[110:111], v14 offset:41984
s_waitcnt lgkmcnt(8)
v_mfma_f32_32x32x16_bf16 v[56:71], a[100:103], v[124:127], v[56:71]
v_and_b32 v152, v152, v153
v_and_b32 v152, 1, v152
v_cmp_eq_u32 vcc, 0, v152
ds_read_b64_tr_b16 v[112:113], v15 offset:40960
ds_read_b64_tr_b16 v[114:115], v15 offset:41984
s_waitcnt lgkmcnt(8)
v_mfma_f32_32x32x16_bf16 v[72:87], a[100:103], v[128:131], v[72:87]
s_cbranch_vccnz Llg_28
Llgd_29:
v_perm_b32 v144, v136, v136, s62
ds_read_b64_tr_b16 v[116:117], v16 offset:40960
ds_read_b64_tr_b16 v[118:119], v16 offset:41984
s_waitcnt lgkmcnt(8)
v_mfma_f32_32x32x16_bf16 v[88:103], a[100:103], v[132:135], v[88:103]
v_perm_b32 v145, v136, v136, s62
v_perm_b32 v146, v138, v138, s62
v_perm_b32 v147, v138, v138, s62
ds_read_b64_tr_b16 v[120:121], v13 offset:45056
ds_read_b64_tr_b16 v[122:123], v13 offset:46080
s_waitcnt lgkmcnt(8)
v_mfma_f32_32x32x16_bf16 v[40:55], a[104:107], v[104:107], v[40:55]
v_perm_b32 v148, v140, v140, s62
v_perm_b32 v149, v140, v140, s62
v_perm_b32 v150, v142, v142, s62
ds_read_b64_tr_b16 v[124:125], v14 offset:45056
ds_read_b64_tr_b16 v[126:127], v14 offset:46080
s_waitcnt lgkmcnt(8)
v_mfma_f32_32x32x16_bf16 v[56:71], a[104:107], v[108:111], v[56:71]
v_perm_b32 v151, v142, v142, s62
v_mov_b32 v152, 0
v_mov_b32 v153, 0
ds_read_b64_tr_b16 v[128:129], v15 offset:45056
ds_read_b64_tr_b16 v[130:131], v15 offset:46080
s_waitcnt lgkmcnt(8)
v_mfma_f32_32x32x16_bf16 v[72:87], a[104:107], v[112:115], v[72:87]
ds_read_b64_tr_b16 v[132:133], v16 offset:45056
ds_read_b64_tr_b16 v[134:135], v16 offset:46080
s_waitcnt lgkmcnt(8)
v_mfma_f32_32x32x16_bf16 v[88:103], a[104:107], v[116:119], v[88:103]
s_waitcnt vmcnt(0)
v_cmp_gt_u32 vcc, s101, v34
s_cbranch_vccz Lsd_32
s_mov_b32 s80, 0
Lsq_33:
buffer_load_dword v34, v4, s[8:11], s65 offen sc1
s_add_u32 s80, s80, 1
s_cmp_lt_u32 s80, 0x8000
s_cbranch_scc0 Lsd_32
s_waitcnt vmcnt(0)
v_cmp_gt_u32 vcc, s101, v34
s_nop 1
s_cbranch_vccnz Lsq_33
Lsd_32:
s_barrier
ds_read_b64_tr_b16 v[104:105], v17 offset:0
ds_read_b64_tr_b16 v[106:107], v17 offset:1024
s_waitcnt lgkmcnt(8)
v_mfma_f32_32x32x16_bf16 v[40:55], a[108:111], v[120:123], v[40:55]
s_add_u32 m0, s29, 65536
s_add_u32 s59, s35, 16777216
ds_read_b64_tr_b16 v[108:109], v17 offset:4096
ds_read_b64_tr_b16 v[110:111], v17 offset:5120
s_waitcnt lgkmcnt(8)
v_mfma_f32_32x32x16_bf16 v[56:71], a[108:111], v[124:127], v[56:71]
buffer_load_dwordx4 v22, s[8:11], s59 offen sc1 lds
ds_read_b64_tr_b16 v[112:113], v17 offset:8192
ds_read_b64_tr_b16 v[114:115], v17 offset:9216
s_waitcnt lgkmcnt(8)
v_mfma_f32_32x32x16_bf16 v[72:87], a[108:111], v[128:131], v[72:87]
s_add_u32 m0, s29, 69632
s_add_u32 s59, s35, 16778240
ds_read_b64_tr_b16 v[116:117], v17 offset:12288
ds_read_b64_tr_b16 v[118:119], v17 offset:13312
s_waitcnt lgkmcnt(8)
v_mfma_f32_32x32x16_bf16 v[88:103], a[108:111], v[132:135], v[88:103]
buffer_load_dwordx4 v22, s[8:11], s59 offen sc1 lds
v_mfma_f32_32x32x16_bf16 v[40:55], v[156:159], v[144:147], v[40:55]
s_add_u32 m0, s29, 73728
s_add_u32 s59, s35, 16779264
v_mfma_f32_32x32x16_bf16 v[56:71], v[156:159], v[146:149], v[56:71]
buffer_load_dwordx4 v22, s[8:11], s59 offen sc1 lds
v_mfma_f32_32x32x16_bf16 v[72:87], v[156:159], v[148:151], v[72:87]
s_add_u32 m0, s29, 77824
s_add_u32 s59, s35, 16780288
v_mfma_f32_32x32x16_bf16 v[88:103], v[156:159], v[150:153], v[88:103]
buffer_load_dwordx4 v22, s[8:11], s59 offen sc1 lds
ds_read_b64_tr_b16 v[120:121], v18 offset:0
ds_read_b64_tr_b16 v[122:123], v18 offset:1024
s_waitcnt lgkmcnt(8)
v_mfma_f32_32x32x16_bf16 v[40:55], a[112:115], v[104:107], v[40:55]
s_add_u32 m0, s29, 81920
s_add_u32 s59, s35, 16781312
ds_read_b64_tr_b16 v[124:125], v18 offset:4096
ds_read_b64_tr_b16 v[126:127], v18 offset:5120
s_waitcnt lgkmcnt(8)
v_mfma_f32_32x32x16_bf16 v[40:55], a[116:119], v[108:111], v[40:55]
buffer_load_dwordx4 v22, s[8:11], s59 offen sc1 lds
ds_read_b64_tr_b16 v[128:129], v18 offset:8192
ds_read_b64_tr_b16 v[130:131], v18 offset:9216
s_waitcnt lgkmcnt(8)
v_mfma_f32_32x32x16_bf16 v[40:55], a[120:123], v[112:115], v[40:55]
s_add_u32 m0, s29, 86016
s_add_u32 s59, s35, 16782336
ds_read_b64_tr_b16 v[132:133], v18 offset:12288
ds_read_b64_tr_b16 v[134:135], v18 offset:13312
s_waitcnt lgkmcnt(8)
v_mfma_f32_32x32x16_bf16 v[40:55], a[124:127], v[116:119], v[40:55]
buffer_load_dwordx4 v22, s[8:11], s59 offen sc1 lds
ds_read_b64_tr_b16 v[104:105], v19 offset:0
ds_read_b64_tr_b16 v[106:107], v19 offset:1024
s_waitcnt lgkmcnt(8)
v_mfma_f32_32x32x16_bf16 v[56:71], a[112:115], v[120:123], v[56:71]
s_add_u32 m0, s29, 90112
s_add_u32 s59, s35, 16783360
ds_read_b64_tr_b16 v[108:109], v19 offset:4096
ds_read_b64_tr_b16 v[110:111], v19 offset:5120
s_waitcnt lgkmcnt(8)
v_mfma_f32_32x32x16_bf16 v[56:71], a[116:119], v[124:127], v[56:71]
buffer_load_dwordx4 v22, s[8:11], s59 offen sc1 lds
v_max_f32 v40, 0, v40
v_max_f32 v41, 0, v41
v_max_f32 v42, 0, v42
v_max_f32 v43, 0, v43
v_max_f32 v44, 0, v44
v_max_f32 v45, 0, v45
v_max_f32 v46, 0, v46
v_max_f32 v47, 0, v47
ds_read_b64_tr_b16 v[112:113], v19 offset:8192
ds_read_b64_tr_b16 v[114:115], v19 offset:9216
s_waitcnt lgkmcnt(8)
v_mfma_f32_32x32x16_bf16 v[56:71], a[120:123], v[128:131], v[56:71]
s_add_u32 m0, s29, 94208
s_add_u32 s59, s35, 16784384
v_mul_f32 v40, v40, v48
v_mul_f32 v41, v41, v49
v_mul_f32 v42, v42, v50
v_mul_f32 v43, v43, v51
v_mul_f32 v44, v44, v52
v_mul_f32 v45, v45, v53
v_mul_f32 v46, v46, v54
v_mul_f32 v47, v47, v55
ds_read_b64_tr_b16 v[116:117], v19 offset:12288
ds_read_b64_tr_b16 v[118:119], v19 offset:13312
s_waitcnt lgkmcnt(8)
v_mfma_f32_32x32x16_bf16 v[56:71], a[124:127], v[132:135], v[56:71]
buffer_load_dwordx4 v22, s[8:11], s59 offen sc1 lds
v_cvt_pk_bf16_f32 v48, v40, v41
v_cvt_pk_bf16_f32 v49, v42, v43
v_cvt_pk_bf16_f32 v50, v44, v45
v_cvt_pk_bf16_f32 v51, v46, v47
s_add_u32 s67, s34, 20447232
buffer_store_dwordx4 v[48:51], v22, s[8:11], s67 offen sc1
ds_read_b64_tr_b16 v[120:121], v20 offset:0
ds_read_b64_tr_b16 v[122:123], v20 offset:1024
s_waitcnt lgkmcnt(8)
v_mfma_f32_32x32x16_bf16 v[72:87], a[112:115], v[104:107], v[72:87]
s_add_u32 m0, s29, 0
s_add_u32 s59, s35, 16785408
ds_read_b64_tr_b16 v[124:125], v20 offset:4096
ds_read_b64_tr_b16 v[126:127], v20 offset:5120
s_waitcnt lgkmcnt(8)
v_mfma_f32_32x32x16_bf16 v[72:87], a[116:119], v[108:111], v[72:87]
buffer_load_dwordx4 v22, s[8:11], s59 offen sc1 lds
v_max_f32 v56, 0, v56
v_max_f32 v57, 0, v57
v_max_f32 v58, 0, v58
v_max_f32 v59, 0, v59
v_max_f32 v60, 0, v60
v_max_f32 v61, 0, v61
v_max_f32 v62, 0, v62
v_max_f32 v63, 0, v63
ds_read_b64_tr_b16 v[128:129], v20 offset:8192
ds_read_b64_tr_b16 v[130:131], v20 offset:9216
s_waitcnt lgkmcnt(8)
v_mfma_f32_32x32x16_bf16 v[72:87], a[120:123], v[112:115], v[72:87]
s_add_u32 m0, s29, 4096
s_add_u32 s59, s35, 16786432
v_mul_f32 v56, v56, v64
v_mul_f32 v57, v57, v65
v_mul_f32 v58, v58, v66
v_mul_f32 v59, v59, v67
v_mul_f32 v60, v60, v68
v_mul_f32 v61, v61, v69
v_mul_f32 v62, v62, v70
v_mul_f32 v63, v63, v71
ds_read_b64_tr_b16 v[132:133], v20 offset:12288
ds_read_b64_tr_b16 v[134:135], v20 offset:13312
s_waitcnt lgkmcnt(8)
v_mfma_f32_32x32x16_bf16 v[72:87], a[124:127], v[116:119], v[72:87]
buffer_load_dwordx4 v22, s[8:11], s59 offen sc1 lds
v_cvt_pk_bf16_f32 v64, v56, v57
v_cvt_pk_bf16_f32 v65, v58, v59
v_cvt_pk_bf16_f32 v66, v60, v61
v_cvt_pk_bf16_f32 v67, v62, v63
s_add_u32 s67, s34, 20561920
buffer_store_dwordx4 v[64:67], v22, s[8:11], s67 offen sc1
s_waitcnt lgkmcnt(6)
v_mfma_f32_32x32x16_bf16 v[88:103], a[112:115], v[120:123], v[88:103]
s_add_u32 m0, s29, 8192
s_add_u32 s59, s35, 16787456
s_waitcnt lgkmcnt(4)
v_mfma_f32_32x32x16_bf16 v[88:103], a[116:119], v[124:127], v[88:103]
buffer_load_dwordx4 v22, s[8:11], s59 offen sc1 lds
v_max_f32 v72, 0, v72
v_max_f32 v73, 0, v73
v_max_f32 v74, 0, v74
v_max_f32 v75, 0, v75
v_max_f32 v76, 0, v76
v_max_f32 v77, 0, v77
v_max_f32 v78, 0, v78
v_max_f32 v79, 0, v79
s_waitcnt lgkmcnt(2)
v_mfma_f32_32x32x16_bf16 v[88:103], a[120:123], v[128:131], v[88:103]
s_add_u32 m0, s29, 12288
s_add_u32 s59, s35, 16788480
v_mul_f32 v72, v72, v80
v_mul_f32 v73, v73, v81
v_mul_f32 v74, v74, v82
v_mul_f32 v75, v75, v83
v_mul_f32 v76, v76, v84
v_mul_f32 v77, v77, v85
v_mul_f32 v78, v78, v86
v_mul_f32 v79, v79, v87
s_waitcnt lgkmcnt(0)
v_mfma_f32_32x32x16_bf16 v[88:103], a[124:127], v[132:135], v[88:103]
buffer_load_dwordx4 v22, s[8:11], s59 offen sc1 lds
v_cvt_pk_bf16_f32 v80, v72, v73
v_cvt_pk_bf16_f32 v81, v74, v75
v_cvt_pk_bf16_f32 v82, v76, v77
v_cvt_pk_bf16_f32 v83, v78, v79
s_add_u32 s67, s34, 20676608
buffer_store_dwordx4 v[80:83], v22, s[8:11], s67 offen sc1
s_barrier
s_branch Ljoin_21
Lst_20:
v_and_b32 v41, 3, v1
v_lshrrev_b32 v42, 5, v1
v_bfe_u32 v43, v1, 2, 2
v_lshlrev_b32 v42, 9, v42
v_lshl_add_u32 v42, v43, 6, v42
v_bfe_u32 v43, v1, 4, 1
v_lshl_add_u32 v42, v43, 5, v42
v_lshl_add_u32 v42, v41, 3, v42
v_add_u32 v42, s29, v42
v_lshrrev_b32 v43, 5, v1
v_lshl_add_u32 v43, v43, 2, v23
s_lshl_b32 s60, s28, 8
s_add_u32 s60, s60, 33280
v_add_u32 v43, s60, v43
s_mov_b32 s62, 0x3f803f80
v_mov_b32 v44, 0
v_mov_b32 v45, 0
v_mov_b32 v46, 0
v_mov_b32 v47, 0
s_waitcnt vmcnt(8)
ds_read_b64_tr_b16 v[48:49], v42 offset:0
ds_read_b64_tr_b16 v[50:51], v42 offset:256
s_waitcnt vmcnt(7)
ds_read_b64_tr_b16 v[52:53], v42 offset:4096
ds_read_b64_tr_b16 v[54:55], v42 offset:4352
s_waitcnt vmcnt(6)
ds_read_b64_tr_b16 v[56:57], v42 offset:8192
ds_read_b64_tr_b16 v[58:59], v42 offset:8448
s_waitcnt vmcnt(5)
ds_read_b64_tr_b16 v[60:61], v42 offset:12288
ds_read_b64_tr_b16 v[62:63], v42 offset:12544
s_waitcnt vmcnt(4)
ds_read_b64_tr_b16 v[64:65], v42 offset:16384
ds_read_b64_tr_b16 v[66:67], v42 offset:16640
s_waitcnt vmcnt(3)
ds_read_b64_tr_b16 v[68:69], v42 offset:20480
ds_read_b64_tr_b16 v[70:71], v42 offset:20736
s_waitcnt vmcnt(2)
ds_read_b64_tr_b16 v[72:73], v42 offset:24576
ds_read_b64_tr_b16 v[74:75], v42 offset:24832
s_waitcnt vmcnt(1)
ds_read_b64_tr_b16 v[76:77], v42 offset:28672
ds_read_b64_tr_b16 v[78:79], v42 offset:28928
s_waitcnt lgkmcnt(14)
v_dot2_f32_bf16 v44, v48, s62, v44
v_dot2_f32_bf16 v45, v48, v48, v45
v_dot2_f32_bf16 v46, v49, s62, v46
v_dot2_f32_bf16 v47, v49, v49, v47
v_dot2_f32_bf16 v44, v50, s62, v44
v_dot2_f32_bf16 v45, v50, v50, v45
v_dot2_f32_bf16 v46, v51, s62, v46
v_dot2_f32_bf16 v47, v51, v51, v47
s_waitcnt lgkmcnt(12)
v_dot2_f32_bf16 v44, v52, s62, v44
v_dot2_f32_bf16 v45, v52, v52, v45
v_dot2_f32_bf16 v46, v53, s62, v46
v_dot2_f32_bf16 v47, v53, v53, v47
v_dot2_f32_bf16 v44, v54, s62, v44
v_dot2_f32_bf16 v45, v54, v54, v45
v_dot2_f32_bf16 v46, v55, s62, v46
v_dot2_f32_bf16 v47, v55, v55, v47
s_waitcnt lgkmcnt(10)
v_dot2_f32_bf16 v44, v56, s62, v44
v_dot2_f32_bf16 v45, v56, v56, v45
v_dot2_f32_bf16 v46, v57, s62, v46
v_dot2_f32_bf16 v47, v57, v57, v47
v_dot2_f32_bf16 v44, v58, s62, v44
v_dot2_f32_bf16 v45, v58, v58, v45
v_dot2_f32_bf16 v46, v59, s62, v46
v_dot2_f32_bf16 v47, v59, v59, v47
s_waitcnt lgkmcnt(8)
v_dot2_f32_bf16 v44, v60, s62, v44
v_dot2_f32_bf16 v45, v60, v60, v45
v_dot2_f32_bf16 v46, v61, s62, v46
v_dot2_f32_bf16 v47, v61, v61, v47
v_dot2_f32_bf16 v44, v62, s62, v44
v_dot2_f32_bf16 v45, v62, v62, v45
v_dot2_f32_bf16 v46, v63, s62, v46
v_dot2_f32_bf16 v47, v63, v63, v47
s_waitcnt lgkmcnt(6)
v_dot2_f32_bf16 v44, v64, s62, v44
v_dot2_f32_bf16 v45, v64, v64, v45
v_dot2_f32_bf16 v46, v65, s62, v46
v_dot2_f32_bf16 v47, v65, v65, v47
v_dot2_f32_bf16 v44, v66, s62, v44
v_dot2_f32_bf16 v45, v66, v66, v45
v_dot2_f32_bf16 v46, v67, s62, v46
v_dot2_f32_bf16 v47, v67, v67, v47
s_waitcnt lgkmcnt(4)
v_dot2_f32_bf16 v44, v68, s62, v44
v_dot2_f32_bf16 v45, v68, v68, v45
v_dot2_f32_bf16 v46, v69, s62, v46
v_dot2_f32_bf16 v47, v69, v69, v47
v_dot2_f32_bf16 v44, v70, s62, v44
v_dot2_f32_bf16 v45, v70, v70, v45
v_dot2_f32_bf16 v46, v71, s62, v46
v_dot2_f32_bf16 v47, v71, v71, v47
s_waitcnt lgkmcnt(2)
v_dot2_f32_bf16 v44, v72, s62, v44
v_dot2_f32_bf16 v45, v72, v72, v45
v_dot2_f32_bf16 v46, v73, s62, v46
v_dot2_f32_bf16 v47, v73, v73, v47
v_dot2_f32_bf16 v44, v74, s62, v44
v_dot2_f32_bf16 v45, v74, v74, v45
v_dot2_f32_bf16 v46, v75, s62, v46
v_dot2_f32_bf16 v47, v75, v75, v47
s_waitcnt lgkmcnt(0)
v_dot2_f32_bf16 v44, v76, s62, v44
v_dot2_f32_bf16 v45, v76, v76, v45
v_dot2_f32_bf16 v46, v77, s62, v46
v_dot2_f32_bf16 v47, v77, v77, v47
v_dot2_f32_bf16 v44, v78, s62, v44
v_dot2_f32_bf16 v45, v78, v78, v45
v_dot2_f32_bf16 v46, v79, s62, v46
v_dot2_f32_bf16 v47, v79, v79, v47
s_nop 1
v_add_f32 v44, v44, v46
v_add_f32 v45, v45, v47
s_nop 1
v_permlane32_swap_b32 v44, v45
v_add_f32 v44, v44, v45
ds_write_b32 v43, v44 offset:0
s_waitcnt vmcnt(0)
s_waitcnt lgkmcnt(0)
s_barrier
s_add_u32 s63, s56, 16384
s_mov_b64 exec, 255
buffer_atomic_add v35, v3, s[8:11], s63 offen sc1
s_mov_b64 exec, -1
s_cmp_lg_u32 s28, 0
s_cbranch_scc1 Lc_1034
ds_read_b64 v[48:49], v23 offset:33280
ds_read_b64 v[50:51], v23 offset:33536
ds_read_b64 v[52:53], v23 offset:33792
ds_read_b64 v[54:55], v23 offset:34048
s_waitcnt lgkmcnt(0)
v_add_f32 v48, v48, v50
v_add_f32 v49, v49, v51
v_add_f32 v52, v52, v54
v_add_f32 v53, v53, v55
v_add_f32 v48, v48, v52
v_add_f32 v49, v49, v53
v_mul_f32 v48, 0x3b000000, v48
v_mul_f32 v49, 0x3b000000, v49
v_fma_f32 v49, -v48, v48, v49
v_max_f32 v49, 0, v49
v_cvt_pk_bf16_f32 v50, v48, v49
v_lshlrev_b32 v48, 16, v50
v_and_b32 v49, 0xffff0000, v50
v_add_f32 v49, 0x3727c5ac, v49
v_cvt_pk_bf16_f32 v49, v49, v49
v_lshlrev_b32 v49, 16, v49
v_sqrt_f32 v49, v49
s_nop 0
v_cvt_pk_bf16_f32 v49, v49, v49
v_lshlrev_b32 v49, 16, v49
v_rcp_f32 v49, v49
v_or_b32 v48, 1, v48
s_and_b32 s60, s45, 0x7ff
s_lshl_b32 s60, s60, 2
s_add_u32 s60, s60, 131072
s_mov_b32 exec_hi, 0
buffer_store_dwordx2 v[48:49], v23, s[8:11], s60 offen sc1
s_mov_b64 exec, -1
Lc_1034:
s_add_u32 s58, s91, 43008
buffer_load_dwordx4 v[204:207], v30, s[8:11], s58 offen sc1
s_add_u32 s58, s44, 45056
buffer_load_dwordx4 v[208:211], v30, s[8:11], s58 offen sc1
s_add_u32 s58, s91, 45056
buffer_load_dwordx4 v[212:215], v30, s[8:11], s58 offen sc1
s_add_u32 s58, s44, 47104
buffer_load_dwordx4 v[216:219], v30, s[8:11], s58 offen sc1
s_add_u32 s58, s91, 47104
buffer_load_dwordx4 v[220:223], v30, s[8:11], s58 offen sc1
s_add_u32 s58, s44, 49152
buffer_load_dwordx4 v[224:227], v30, s[8:11], s58 offen sc1
s_add_u32 s58, s91, 49152
buffer_load_dwordx4 v[228:231], v30, s[8:11], s58 offen sc1
s_add_u32 s58, s44, 51200
buffer_load_dwordx4 v[232:235], v30, s[8:11], s58 offen sc1
s_add_u32 s58, s91, 51200
buffer_load_dwordx4 v[236:239], v30, s[8:11], s58 offen sc1
s_add_u32 s58, s44, 53248
buffer_load_dwordx4 v[240:243], v30, s[8:11], s58 offen sc1
s_add_u32 s58, s91, 53248
buffer_load_dwordx4 v[244:247], v30, s[8:11], s58 offen sc1
s_add_u32 s58, s44, 55296
buffer_load_dwordx4 v[248:251], v30, s[8:11], s58 offen sc1
s_add_u32 s58, s91, 55296
buffer_load_dwordx4 v[252:255], v30, s[8:11], s58 offen sc1
s_add_u32 s64, s56, 16384
buffer_load_dword v34, v2, s[8:11], s64 offen sc1
s_waitcnt vmcnt(0)
v_cmp_gt_u32 vcc, s57, v34
s_cbranch_vccnz Lsp_1035
Lsd_1036:
s_barrier
s_add_u32 m0, s29, 0
s_add_u32 s61, s45, 4196352
buffer_load_dwordx4 v21, s[8:11], s61 offen sc1 lds
s_add_u32 m0, s29, 4096
s_add_u32 s61, s45, 4261888
buffer_load_dwordx4 v21, s[8:11], s61 offen sc1 lds
s_add_u32 m0, s29, 8192
s_add_u32 s61, s45, 4327424
buffer_load_dwordx4 v21, s[8:11], s61 offen sc1 lds
s_add_u32 m0, s29, 12288
s_add_u32 s61, s45, 4392960
buffer_load_dwordx4 v21, s[8:11], s61 offen sc1 lds
s_add_u32 m0, s29, 16384
s_add_u32 s61, s45, 4458496
buffer_load_dwordx4 v21, s[8:11], s61 offen sc1 lds
s_add_u32 m0, s29, 20480
s_add_u32 s61, s45, 4524032
buffer_load_dwordx4 v21, s[8:11], s61 offen sc1 lds
s_add_u32 m0, s29, 24576
s_add_u32 s61, s45, 4589568
buffer_load_dwordx4 v21, s[8:11], s61 offen sc1 lds
s_add_u32 m0, s29, 28672
s_add_u32 s61, s45, 4655104
buffer_load_dwordx4 v21, s[8:11], s61 offen sc1 lds
s_waitcnt vmcnt(0)
s_mov_b32 s62, 0x3f803f80
v_mov_b32 v44, 0
v_mov_b32 v45, 0
v_mov_b32 v46, 0
v_mov_b32 v47, 0
ds_read_b64_tr_b16 v[48:49], v42 offset:0
ds_read_b64_tr_b16 v[50:51], v42 offset:256
ds_read_b64_tr_b16 v[52:53], v42 offset:4096
ds_read_b64_tr_b16 v[54:55], v42 offset:4352
ds_read_b64_tr_b16 v[56:57], v42 offset:8192
ds_read_b64_tr_b16 v[58:59], v42 offset:8448
ds_read_b64_tr_b16 v[60:61], v42 offset:12288
ds_read_b64_tr_b16 v[62:63], v42 offset:12544
ds_read_b64_tr_b16 v[64:65], v42 offset:16384
ds_read_b64_tr_b16 v[66:67], v42 offset:16640
ds_read_b64_tr_b16 v[68:69], v42 offset:20480
ds_read_b64_tr_b16 v[70:71], v42 offset:20736
ds_read_b64_tr_b16 v[72:73], v42 offset:24576
ds_read_b64_tr_b16 v[74:75], v42 offset:24832
ds_read_b64_tr_b16 v[76:77], v42 offset:28672
ds_read_b64_tr_b16 v[78:79], v42 offset:28928
s_waitcnt lgkmcnt(14)
v_dot2_f32_bf16 v44, v48, s62, v44
v_dot2_f32_bf16 v45, v48, v48, v45
v_dot2_f32_bf16 v46, v49, s62, v46
v_dot2_f32_bf16 v47, v49, v49, v47
v_dot2_f32_bf16 v44, v50, s62, v44
v_dot2_f32_bf16 v45, v50, v50, v45
v_dot2_f32_bf16 v46, v51, s62, v46
v_dot2_f32_bf16 v47, v51, v51, v47
s_waitcnt lgkmcnt(12)
v_dot2_f32_bf16 v44, v52, s62, v44
v_dot2_f32_bf16 v45, v52, v52, v45
v_dot2_f32_bf16 v46, v53, s62, v46
v_dot2_f32_bf16 v47, v53, v53, v47
v_dot2_f32_bf16 v44, v54, s62, v44
v_dot2_f32_bf16 v45, v54, v54, v45
v_dot2_f32_bf16 v46, v55, s62, v46
v_dot2_f32_bf16 v47, v55, v55, v47
s_waitcnt lgkmcnt(10)
v_dot2_f32_bf16 v44, v56, s62, v44
v_dot2_f32_bf16 v45, v56, v56, v45
v_dot2_f32_bf16 v46, v57, s62, v46
v_dot2_f32_bf16 v47, v57, v57, v47
v_dot2_f32_bf16 v44, v58, s62, v44
v_dot2_f32_bf16 v45, v58, v58, v45
v_dot2_f32_bf16 v46, v59, s62, v46
v_dot2_f32_bf16 v47, v59, v59, v47
s_waitcnt lgkmcnt(8)
v_dot2_f32_bf16 v44, v60, s62, v44
v_dot2_f32_bf16 v45, v60, v60, v45
v_dot2_f32_bf16 v46, v61, s62, v46
v_dot2_f32_bf16 v47, v61, v61, v47
v_dot2_f32_bf16 v44, v62, s62, v44
v_dot2_f32_bf16 v45, v62, v62, v45
v_dot2_f32_bf16 v46, v63, s62, v46
v_dot2_f32_bf16 v47, v63, v63, v47
s_waitcnt lgkmcnt(6)
v_dot2_f32_bf16 v44, v64, s62, v44
v_dot2_f32_bf16 v45, v64, v64, v45
v_dot2_f32_bf16 v46, v65, s62, v46
v_dot2_f32_bf16 v47, v65, v65, v47
v_dot2_f32_bf16 v44, v66, s62, v44
v_dot2_f32_bf16 v45, v66, v66, v45
v_dot2_f32_bf16 v46, v67, s62, v46
v_dot2_f32_bf16 v47, v67, v67, v47
s_waitcnt lgkmcnt(4)
v_dot2_f32_bf16 v44, v68, s62, v44
v_dot2_f32_bf16 v45, v68, v68, v45
v_dot2_f32_bf16 v46, v69, s62, v46
v_dot2_f32_bf16 v47, v69, v69, v47
v_dot2_f32_bf16 v44, v70, s62, v44
v_dot2_f32_bf16 v45, v70, v70, v45
v_dot2_f32_bf16 v46, v71, s62, v46
v_dot2_f32_bf16 v47, v71, v71, v47
s_waitcnt lgkmcnt(2)
v_dot2_f32_bf16 v44, v72, s62, v44
v_dot2_f32_bf16 v45, v72, v72, v45
v_dot2_f32_bf16 v46, v73, s62, v46
v_dot2_f32_bf16 v47, v73, v73, v47
v_dot2_f32_bf16 v44, v74, s62, v44
v_dot2_f32_bf16 v45, v74, v74, v45
v_dot2_f32_bf16 v46, v75, s62, v46
v_dot2_f32_bf16 v47, v75, v75, v47
s_waitcnt lgkmcnt(0)
v_dot2_f32_bf16 v44, v76, s62, v44
v_dot2_f32_bf16 v45, v76, v76, v45
v_dot2_f32_bf16 v46, v77, s62, v46
v_dot2_f32_bf16 v47, v77, v77, v47
v_dot2_f32_bf16 v44, v78, s62, v44
v_dot2_f32_bf16 v45, v78, v78, v45
v_dot2_f32_bf16 v46, v79, s62, v46
v_dot2_f32_bf16 v47, v79, v79, v47
s_nop 1
v_add_f32 v44, v44, v46
v_add_f32 v45, v45, v47
s_nop 1
v_permlane32_swap_b32 v44, v45
v_add_f32 v44, v44, v45
ds_write_b32 v43, v44 offset:1024
s_waitcnt lgkmcnt(0)
s_barrier
s_cmp_lg_u32 s28, 0
s_cbranch_scc1 Lc_1038
ds_read_b64 v[48:49], v23 offset:34304
ds_read_b64 v[50:51], v23 offset:34560
ds_read_b64 v[52:53], v23 offset:34816
ds_read_b64 v[54:55], v23 offset:35072
s_waitcnt lgkmcnt(0)
v_add_f32 v48, v48, v50
v_add_f32 v49, v49, v51
v_add_f32 v52, v52, v54
v_add_f32 v53, v53, v55
v_add_f32 v48, v48, v52
v_add_f32 v49, v49, v53
v_mul_f32 v48, 0x3b000000, v48
v_mul_f32 v49, 0x3b000000, v49
v_fma_f32 v49, -v48, v48, v49
v_max_f32 v49, 0, v49
v_cvt_pk_bf16_f32 v50, v48, v49
v_lshlrev_b32 v48, 16, v50
v_and_b32 v49, 0xffff0000, v50
v_add_f32 v49, 0x3727c5ac, v49
v_cvt_pk_bf16_f32 v49, v49, v49
v_lshlrev_b32 v49, 16, v49
v_sqrt_f32 v49, v49
s_nop 0
v_cvt_pk_bf16_f32 v49, v49, v49
v_lshlrev_b32 v49, 16, v49
v_rcp_f32 v49, v49
v_or_b32 v48, 1, v48
s_and_b32 s60, s45, 0x7ff
s_lshl_b32 s60, s60, 2
s_add_u32 s60, s60, 139264
s_mov_b32 exec_hi, 0
buffer_store_dwordx2 v[48:49], v23, s[8:11], s60 offen sc1
s_mov_b64 exec, -1
Lc_1038:
s_add_u32 s65, s40, 0
buffer_load_dword v34, v4, s[8:11], s65 offen sc1
s_waitcnt vmcnt(0)
v_cmp_gt_u32 vcc, s101, v34
s_cbranch_vccnz Lsp_1039
Lsd_1040:
s_barrier
s_add_u32 m0, s29, 65536
s_add_u32 s59, s35, 16777216
buffer_load_dwordx4 v22, s[8:11], s59 offen sc1 lds
s_add_u32 m0, s29, 69632
s_add_u32 s59, s35, 16778240
buffer_load_dwordx4 v22, s[8:11], s59 offen sc1 lds
s_add_u32 m0, s29, 73728
s_add_u32 s59, s35, 16779264
buffer_load_dwordx4 v22, s[8:11], s59 offen sc1 lds
s_add_u32 m0, s29, 77824
s_add_u32 s59, s35, 16780288
buffer_load_dwordx4 v22, s[8:11], s59 offen sc1 lds
s_add_u32 m0, s29, 81920
s_add_u32 s59, s35, 16781312
buffer_load_dwordx4 v22, s[8:11], s59 offen sc1 lds
s_add_u32 m0, s29, 86016
s_add_u32 s59, s35, 16782336
buffer_load_dwordx4 v22, s[8:11], s59 offen sc1 lds
s_add_u32 m0, s29, 90112
s_add_u32 s59, s35, 16783360
buffer_load_dwordx4 v22, s[8:11], s59 offen sc1 lds
s_add_u32 m0, s29, 94208
s_add_u32 s59, s35, 16784384
buffer_load_dwordx4 v22, s[8:11], s59 offen sc1 lds
s_add_u32 m0, s29, 0
s_add_u32 s59, s35, 16785408
buffer_load_dwordx4 v22, s[8:11], s59 offen sc1 lds
s_add_u32 m0, s29, 4096
s_add_u32 s59, s35, 16786432
buffer_load_dwordx4 v22, s[8:11], s59 offen sc1 lds
s_add_u32 m0, s29, 8192
s_add_u32 s59, s35, 16787456
buffer_load_dwordx4 v22, s[8:11], s59 offen sc1 lds
s_add_u32 m0, s29, 12288
s_add_u32 s59, s35, 16788480
buffer_load_dwordx4 v22, s[8:11], s59 offen sc1 lds
s_waitcnt vmcnt(0)
s_waitcnt lgkmcnt(0)
Ljoin_21:
s_nop 7
s_nop 1
s_waitcnt vmcnt(14)
ds_read_b128 v[104:107], v25 offset:16384
s_waitcnt vmcnt(13)
ds_read_b128 v[108:111], v25 offset:20480
s_waitcnt vmcnt(12)
ds_read_b128 v[112:115], v25 offset:24576
s_waitcnt vmcnt(11)
ds_read_b128 v[116:119], v25 offset:28672
v_max_f32 v88, 0, v88
v_max_f32 v89, 0, v89
v_max_f32 v90, 0, v90
v_max_f32 v91, 0, v91
v_max_f32 v92, 0, v92
v_max_f32 v93, 0, v93
v_max_f32 v94, 0, v94
v_max_f32 v95, 0, v95
v_mul_f32 v88, v88, v96
v_mul_f32 v89, v89, v97
v_mul_f32 v90, v90, v98
v_mul_f32 v91, v91, v99
v_mul_f32 v92, v92, v100
v_mul_f32 v93, v93, v101
v_mul_f32 v94, v94, v102
v_mul_f32 v95, v95, v103
v_cvt_pk_bf16_f32 v96, v88, v89
v_cvt_pk_bf16_f32 v97, v90, v91
v_cvt_pk_bf16_f32 v98, v92, v93
v_cvt_pk_bf16_f32 v99, v94, v95
s_add_u32 s67, s34, 20791296
buffer_store_dwordx4 v[96:99], v22, s[8:11], s67 offen sc1
s_waitcnt vmcnt(11)
ds_read_b128 v[120:123], v25 offset:32768
s_waitcnt lgkmcnt(4)
v_mfma_f32_32x32x16_bf16 v[40:55], a[128:131], v[104:107], 0
s_add_u32 m0, s29, 16384
s_add_u32 s59, s35, 16789504
v_mfma_f32_32x32x16_bf16 v[56:71], a[132:135], v[104:107], 0
buffer_load_dwordx4 v22, s[8:11], s59 offen sc1 lds
s_waitcnt vmcnt(11)
ds_read_b128 v[124:127], v25 offset:36864
s_waitcnt lgkmcnt(4)
v_mfma_f32_32x32x16_bf16 v[40:55], a[136:139], v[108:111], v[40:55]
s_add_u32 m0, s29, 20480
s_add_u32 s59, s35, 16790528
v_mfma_f32_32x32x16_bf16 v[56:71], a[140:143], v[108:111], v[56:71]
buffer_load_dwordx4 v22, s[8:11], s59 offen sc1 lds
s_waitcnt vmcnt(11)
ds_read_b128 v[128:131], v25 offset:40960
s_waitcnt lgkmcnt(4)
v_mfma_f32_32x32x16_bf16 v[40:55], a[144:147], v[112:115], v[40:55]
s_add_u32 m0, s29, 24576
s_add_u32 s59, s35, 16791552
v_mfma_f32_32x32x16_bf16 v[56:71], a[148:151], v[112:115], v[56:71]
buffer_load_dwordx4 v22, s[8:11], s59 offen sc1 lds
s_waitcnt vmcnt(11)
ds_read_b128 v[132:135], v25 offset:45056
s_waitcnt lgkmcnt(4)
v_mfma_f32_32x32x16_bf16 v[40:55], a[152:155], v[116:119], v[40:55]
s_add_u32 m0, s29, 28672
s_add_u32 s59, s35, 16792576
v_mfma_f32_32x32x16_bf16 v[56:71], a[156:159], v[116:119], v[56:71]
buffer_load_dwordx4 v22, s[8:11], s59 offen sc1 lds
s_waitcnt vmcnt(10)
ds_read_b128 v[104:107], v24 offset:0
s_waitcnt lgkmcnt(4)
v_mfma_f32_32x32x16_bf16 v[40:55], a[160:163], v[120:123], v[40:55]
s_add_u32 m0, s29, 32768
s_add_u32 s59, s35, 16793600
v_mfma_f32_32x32x16_bf16 v[56:71], a[164:167], v[120:123], v[56:71]
buffer_load_dwordx4 v22, s[8:11], s59 offen sc1 lds
s_waitcnt vmcnt(10)
ds_read_b128 v[108:111], v24 offset:4096
s_waitcnt lgkmcnt(4)
v_mfma_f32_32x32x16_bf16 v[40:55], a[168:171], v[124:127], v[40:55]
s_add_u32 m0, s29, 36864
s_add_u32 s59, s35, 16794624
v_mfma_f32_32x32x16_bf16 v[56:71], a[172:175], v[124:127], v[56:71]
buffer_load_dwordx4 v22, s[8:11], s59 offen sc1 lds
s_waitcnt vmcnt(6)
s_add_u32 s63, s31, 16384
v_mov_b32 v38, 0
s_mov_b64 exec, 1
buffer_atomic_add v35, v38, s[8:11], s63 offen sc1
s_mov_b64 exec, -1
ds_read_b128 v[112:115], v24 offset:8192
s_waitcnt lgkmcnt(4)
v_mfma_f32_32x32x16_bf16 v[40:55], a[176:179], v[128:131], v[40:55]
s_add_u32 m0, s29, 40960
s_add_u32 s59, s35, 16795648
v_mfma_f32_32x32x16_bf16 v[56:71], a[180:183], v[128:131], v[56:71]
buffer_load_dwordx4 v22, s[8:11], s59 offen sc1 lds
ds_read_b128 v[116:119], v24 offset:12288
s_waitcnt lgkmcnt(4)
v_mfma_f32_32x32x16_bf16 v[40:55], a[184:187], v[132:135], v[40:55]
s_add_u32 m0, s29, 45056
s_add_u32 s59, s35, 16796672
v_mfma_f32_32x32x16_bf16 v[56:71], a[188:191], v[132:135], v[56:71]
buffer_load_dwordx4 v22, s[8:11], s59 offen sc1 lds
s_waitcnt vmcnt(8)
ds_read_b128 v[120:123], v24 offset:16384
s_waitcnt lgkmcnt(4)
v_mfma_f32_32x32x16_bf16 v[40:55], a[192:195], v[104:107], v[40:55]
s_add_u32 m0, s29, 49152
s_add_u32 s59, s35, 16797696
v_mfma_f32_32x32x16_bf16 v[56:71], a[196:199], v[104:107], v[56:71]
buffer_load_dwordx4 v22, s[8:11], s59 offen sc1 lds
s_waitcnt vmcnt(8)
ds_read_b128 v[124:127], v24 offset:20480
s_waitcnt lgkmcnt(4)
v_mfma_f32_32x32x16_bf16 v[40:55], a[200:203], v[108:111], v[40:55]
s_add_u32 m0, s29, 53248
s_add_u32 s59, s35, 16798720
v_mfma_f32_32x32x16_bf16 v[56:71], a[204:207], v[108:111], v[56:71]
buffer_load_dwordx4 v22, s[8:11], s59 offen sc1 lds
s_waitcnt vmcnt(8)
ds_read_b128 v[128:131], v24 offset:24576
s_waitcnt lgkmcnt(4)
v_mfma_f32_32x32x16_bf16 v[40:55], a[208:211], v[112:115], v[40:55]
s_add_u32 m0, s29, 57344
s_add_u32 s59, s35, 16799744
v_mfma_f32_32x32x16_bf16 v[56:71], a[212:215], v[112:115], v[56:71]
buffer_load_dwordx4 v22, s[8:11], s59 offen sc1 lds
s_waitcnt vmcnt(8)
ds_read_b128 v[132:135], v24 offset:28672
s_waitcnt lgkmcnt(4)
v_mfma_f32_32x32x16_bf16 v[40:55], a[216:219], v[116:119], v[40:55]
s_add_u32 m0, s29, 61440
s_add_u32 s59, s35, 16800768
v_mfma_f32_32x32x16_bf16 v[56:71], a[220:223], v[116:119], v[56:71]
buffer_load_dwordx4 v22, s[8:11], s59 offen sc1 lds
s_waitcnt vmcnt(8)
ds_read_b128 v[104:107], v24 offset:32768
s_waitcnt lgkmcnt(4)
v_mfma_f32_32x32x16_bf16 v[40:55], a[224:227], v[120:123], v[40:55]
s_add_u32 m0, s29, 65536
s_add_u32 s59, s35, 16801792
v_mfma_f32_32x32x16_bf16 v[56:71], a[228:231], v[120:123], v[56:71]
buffer_load_dwordx4 v22, s[8:11], s59 offen sc1 lds
s_waitcnt vmcnt(8)
ds_read_b128 v[108:111], v24 offset:36864
s_waitcnt lgkmcnt(4)
v_mfma_f32_32x32x16_bf16 v[40:55], a[232:235], v[124:127], v[40:55]
s_add_u32 m0, s29, 69632
s_add_u32 s59, s35, 16802816
v_mov_b32 v136, 0
v_mov_b32 v137, 0
v_mov_b32 v138, 0
v_mov_b32 v139, 0
v_mfma_f32_32x32x16_bf16 v[56:71], a[236:239], v[124:127], v[56:71]
buffer_load_dwordx4 v22, s[8:11], s59 offen sc1 lds
v_mov_b32 v140, 0
v_mov_b32 v141, 0
v_mov_b32 v142, 0
v_mov_b32 v143, 0
s_waitcnt vmcnt(7)
ds_read_b128 v[112:115], v24 offset:40960
s_waitcnt lgkmcnt(4)
v_mfma_f32_32x32x16_bf16 v[40:55], a[240:243], v[128:131], v[40:55]
s_add_u32 m0, s29, 73728
s_add_u32 s59, s35, 16803840
s_add_u32 s60, s36, 4194304
buffer_load_short_d16_hi v136, v26, s[8:11], s60 offen sc1
s_add_u32 s60, s36, 4198400
buffer_load_short_d16_hi v137, v26, s[8:11], s60 offen sc1
v_mfma_f32_32x32x16_bf16 v[56:71], a[244:247], v[128:131], v[56:71]
buffer_load_dwordx4 v22, s[8:11], s59 offen sc1 lds
s_add_u32 s60, s36, 4202496
buffer_load_short_d16_hi v138, v26, s[8:11], s60 offen sc1
s_waitcnt vmcnt(10)
ds_read_b128 v[116:119], v24 offset:45056
s_waitcnt lgkmcnt(4)
v_mfma_f32_32x32x16_bf16 v[40:55], a[248:251], v[132:135], v[40:55]
s_add_u32 m0, s29, 77824
s_add_u32 s59, s35, 16804864
s_add_u32 s60, s36, 4206592
buffer_load_short_d16_hi v139, v26, s[8:11], s60 offen sc1
v_mfma_f32_32x32x16_bf16 v[56:71], a[252:255], v[132:135], v[56:71]
buffer_load_dwordx4 v22, s[8:11], s59 offen sc1 lds
s_add_u32 s60, s36, 4227072
buffer_load_short_d16_hi v140, v26, s[8:11], s60 offen sc1
s_add_u32 s60, s36, 4231168
buffer_load_short_d16_hi v141, v26, s[8:11], s60 offen sc1
s_waitcnt vmcnt(13)
ds_read_b128 v[120:123], v25 offset:0
s_waitcnt lgkmcnt(4)
v_mfma_f32_32x32x16_bf16 v[40:55], v[160:163], v[104:107], v[40:55]
s_add_u32 s60, s36, 4235264
buffer_load_short_d16_hi v142, v26, s[8:11], s60 offen sc1
v_mfma_f32_32x32x16_bf16 v[56:71], v[164:167], v[104:107], v[56:71]
s_add_u32 s60, s36, 4239360
buffer_load_short_d16_hi v143, v26, s[8:11], s60 offen sc1
s_waitcnt vmcnt(14)
ds_read_b128 v[124:127], v25 offset:4096
s_waitcnt lgkmcnt(4)
v_mfma_f32_32x32x16_bf16 v[40:55], v[168:171], v[108:111], v[40:55]
s_add_u32 s60, s38, 131072
buffer_load_dword v148, v23, s[8:11], s60 offen offset:4 sc1
v_add_u32 v149, s86, v22
v_add_u32 v150, s87, v22
v_add_u32 v151, s88, v22
v_mfma_f32_32x32x16_bf16 v[56:71], v[172:175], v[108:111], v[56:71]
v_add_u32 v152, s89, v22
s_waitcnt vmcnt(14)
ds_read_b128 v[128:131], v25 offset:8192
s_waitcnt lgkmcnt(4)
v_mfma_f32_32x32x16_bf16 v[40:55], v[176:179], v[112:115], v[40:55]
v_mfma_f32_32x32x16_bf16 v[56:71], v[180:183], v[112:115], v[56:71]
s_waitcnt vmcnt(13)
ds_read_b128 v[132:135], v25 offset:12288
s_waitcnt lgkmcnt(4)
v_mfma_f32_32x32x16_bf16 v[40:55], v[184:187], v[116:119], v[40:55]
v_mfma_f32_32x32x16_bf16 v[56:71], v[188:191], v[116:119], v[56:71]
s_waitcnt vmcnt(12)
ds_read_b128 v[104:107], v25 offset:16384
s_waitcnt lgkmcnt(4)
v_mfma_f32_32x32x16_bf16 v[40:55], v[192:195], v[120:123], v[40:55]
v_mfma_f32_32x32x16_bf16 v[56:71], v[196:199], v[120:123], v[56:71]
s_waitcnt vmcnt(11)
ds_read_b128 v[108:111], v25 offset:20480
s_waitcnt lgkmcnt(4)
v_mfma_f32_32x32x16_bf16 v[40:55], v[200:203], v[124:127], v[40:55]
v_mfma_f32_32x32x16_bf16 v[56:71], v[204:207], v[124:127], v[56:71]
s_waitcnt vmcnt(8)
ds_read_b128 v[112:115], v25 offset:24576
s_waitcnt lgkmcnt(4)
v_mfma_f32_32x32x16_bf16 v[40:55], v[208:211], v[128:131], v[40:55]
v_mfma_f32_32x32x16_bf16 v[56:71], v[212:215], v[128:131], v[56:71]
s_waitcnt vmcnt(5)
ds_read_b128 v[116:119], v25 offset:28672
s_waitcnt lgkmcnt(4)
v_mfma_f32_32x32x16_bf16 v[40:55], v[216:219], v[132:135], v[40:55]
v_mfma_f32_32x32x16_bf16 v[56:71], v[220:223], v[132:135], v[56:71]
s_add_u32 s65, s40, 16384
buffer_load_dword v34, v4, s[8:11], s65 offen sc1
s_waitcnt lgkmcnt(3)
v_mfma_f32_32x32x16_bf16 v[56:71], v[228:231], v[104:107], v[56:71]
s_waitcnt lgkmcnt(2)
v_mfma_f32_32x32x16_bf16 v[56:71], v[236:239], v[108:111], v[56:71]
s_waitcnt lgkmcnt(1)
v_mfma_f32_32x32x16_bf16 v[56:71], v[244:247], v[112:115], v[56:71]
s_waitcnt lgkmcnt(0)
v_mfma_f32_32x32x16_bf16 v[56:71], v[252:255], v[116:119], v[56:71]
v_mfma_f32_32x32x16_bf16 v[40:55], v[224:227], v[104:107], v[40:55]
s_nop 4
v_mfma_f32_32x32x16_bf16 v[40:55], v[232:235], v[108:111], v[40:55]
s_nop 4
v_mfma_f32_32x32x16_bf16 v[40:55], v[240:243], v[112:115], v[40:55]
ds_write_b128 v149, v[56:59] offset:2048
v_mfma_f32_32x32x16_bf16 v[40:55], v[248:251], v[116:119], v[40:55]
ds_write_b128 v149, v[60:63] offset:3072
ds_write_b128 v149, v[64:67] offset:4096
ds_write_b128 v149, v[68:71] offset:5120
s_nop 8
ds_write_b128 v149, v[48:51] offset:0
ds_write_b128 v149, v[52:55] offset:1024
s_waitcnt vmcnt(1)
v_mul_f32 v148, v148, v148
s_waitcnt vmcnt(0)
v_cmp_gt_u32 vcc, s101, v34
s_cbranch_vccz Lsd_1044
s_mov_b32 s80, 0
Lsq_1045:
buffer_load_dword v34, v4, s[8:11], s65 offen sc1
s_add_u32 s80, s80, 1
s_cmp_lt_u32 s80, 0x8000
s_cbranch_scc0 Lsd_1044
s_waitcnt vmcnt(0)
v_cmp_gt_u32 vcc, s101, v34
s_nop 1
s_cbranch_vccnz Lsq_1045
Lsd_1044:
s_waitcnt lgkmcnt(0)
s_barrier
ds_read_b128 v[72:75], v150 offset:0
ds_read_b128 v[76:79], v150 offset:1024
ds_read_b128 v[80:83], v151 offset:0
ds_read_b128 v[84:87], v151 offset:1024
ds_read_b128 v[88:91], v152 offset:0
ds_read_b128 v[92:95], v152 offset:1024
s_add_u32 m0, s29, 81920
s_add_u32 s59, s35, 20447232
buffer_load_dwordx4 v22, s[8:11], s59 offen sc1 lds
s_add_u32 m0, s29, 86016
s_add_u32 s59, s35, 20448256
buffer_load_dwordx4 v22, s[8:11], s59 offen sc1 lds
s_add_u32 m0, s29, 90112
s_add_u32 s59, s35, 20449280
buffer_load_dwordx4 v22, s[8:11], s59 offen sc1 lds
s_waitcnt lgkmcnt(4)
v_pk_add_f32 v[40:41], v[40:41], v[72:73]
v_pk_add_f32 v[42:43], v[42:43], v[74:75]
v_pk_add_f32 v[44:45], v[44:45], v[76:77]
v_pk_add_f32 v[46:47], v[46:47], v[78:79]
s_waitcnt lgkmcnt(0)
v_pk_add_f32 v[80:81], v[80:81], v[88:89]
v_pk_add_f32 v[82:83], v[82:83], v[90:91]
v_pk_add_f32 v[84:85], v[84:85], v[92:93]
v_pk_add_f32 v[86:87], v[86:87], v[94:95]
v_pk_add_f32 v[40:41], v[40:41], v[80:81]
v_pk_add_f32 v[42:43], v[42:43], v[82:83]
v_pk_add_f32 v[44:45], v[44:45], v[84:85]
v_pk_add_f32 v[46:47], v[46:47], v[86:87]
v_fmac_f32 v136, v40, v148
v_fmac_f32 v137, v41, v148
v_fmac_f32 v138, v42, v148
v_fmac_f32 v139, v43, v148
v_fmac_f32 v140, v44, v148
v_fmac_f32 v141, v45, v148
v_fmac_f32 v142, v46, v148
v_fmac_f32 v143, v47, v148
v_cvt_pk_bf16_f32 v96, v136, v137
v_cvt_pk_bf16_f32 v97, v138, v139
v_cvt_pk_bf16_f32 v98, v140, v141
v_cvt_pk_bf16_f32 v99, v142, v143
ds_write_b16 v28, v96 offset:57856
ds_write_b16_d16_hi v28, v96 offset:57920
ds_write_b16 v28, v97 offset:57984
ds_write_b16_d16_hi v28, v97 offset:58048
ds_write_b16 v28, v98 offset:58368
ds_write_b16_d16_hi v28, v98 offset:58432
ds_write_b16 v28, v99 offset:58496
ds_write_b16_d16_hi v28, v99 offset:58560
s_mov_b32 s62, 0x3f803f80
s_lshl_b32 s60, s28, 8
s_add_u32 m0, s60, 61952
v_dot2_f32_bf16 v154, v96, s62, 0
v_dot2_f32_bf16 v155, v96, v96, 0
v_dot2_f32_bf16 v154, v97, s62, v154
v_dot2_f32_bf16 v155, v97, v97, v155
v_dot2_f32_bf16 v154, v98, s62, v154
v_dot2_f32_bf16 v155, v98, v98, v155
v_dot2_f32_bf16 v154, v99, s62, v154
v_dot2_f32_bf16 v155, v99, v99, v155
s_add_u32 s60, s38, 163840
v_lshlrev_b32 v153, 2, v1
s_nop 0
v_permlane32_swap_b32 v154, v155
v_add_f32 v154, v154, v155
ds_write_addtid_b32 v154
s_waitcnt lgkmcnt(0)
s_barrier
ds_read_b128 v[100:103], v9 offset:57856
ds_read2st64_b32 v[72:73], v153 offset0:242 offset1:243
ds_read2st64_b32 v[74:75], v153 offset0:244 offset1:245
s_add_u32 s61, s60, s56
s_add_u32 s60, s37, 6291456
s_waitcnt lgkmcnt(0)
buffer_store_dwordx4 v[100:103], v29, s[8:11], s60 offen sc1
v_add_f32 v72, v72, v73
v_add_f32 v74, v74, v75
v_add_f32 v72, v72, v74
buffer_atomic_add_f32 v72, v27, s[8:11], s61 offen
s_add_u32 m0, s29, 94208
s_add_u32 s59, s35, 20450304
buffer_load_dwordx4 v22, s[8:11], s59 offen sc1 lds
s_add_u32 m0, s29, 0
s_add_u32 s59, s35, 20451328
buffer_load_dwordx4 v22, s[8:11], s59 offen sc1 lds
s_add_u32 m0, s29, 4096
s_add_u32 s59, s35, 20452352
buffer_load_dwordx4 v22, s[8:11], s59 offen sc1 lds
s_add_u32 m0, s29, 8192
s_add_u32 s59, s35, 20453376
buffer_load_dwordx4 v22, s[8:11], s59 offen sc1 lds
s_add_u32 m0, s29, 12288
s_add_u32 s59, s35, 20454400
buffer_load_dwordx4 v22, s[8:11], s59 offen sc1 lds
s_add_u32 m0, s29, 16384
s_add_u32 s59, s35, 20455424
buffer_load_dwordx4 v22, s[8:11], s59 offen sc1 lds
s_add_u32 m0, s29, 20480
s_add_u32 s59, s35, 20456448
buffer_load_dwordx4 v22, s[8:11], s59 offen sc1 lds
s_add_u32 m0, s29, 24576
s_add_u32 s59, s35, 20457472
buffer_load_dwordx4 v22, s[8:11], s59 offen sc1 lds
s_add_u32 m0, s29, 28672
s_add_u32 s59, s35, 20458496
buffer_load_dwordx4 v22, s[8:11], s59 offen sc1 lds
s_add_u32 m0, s29, 32768
s_add_u32 s59, s35, 20459520
buffer_load_dwordx4 v22, s[8:11], s59 offen sc1 lds
s_waitcnt vmcnt(14)
ds_read_b128 v[104:107], v25 offset:32768
s_waitcnt vmcnt(13)
ds_read_b128 v[108:111], v25 offset:36864
s_waitcnt vmcnt(12)
ds_read_b128 v[112:115], v25 offset:40960
s_waitcnt vmcnt(9)
ds_read_b128 v[116:119], v25 offset:45056
s_waitcnt vmcnt(8)
ds_read_b128 v[120:123], v24 offset:0
s_waitcnt lgkmcnt(4)
v_mfma_f32_32x32x16_bf16 v[40:55], a[128:131], v[104:107], 0
s_add_u32 m0, s29, 36864
s_add_u32 s59, s35, 20460544
v_mfma_f32_32x32x16_bf16 v[56:71], a[132:135], v[104:107], 0
buffer_load_dwordx4 v22, s[8:11], s59 offen sc1 lds
s_waitcnt vmcnt(8)
ds_read_b128 v[124:127], v24 offset:4096
s_waitcnt lgkmcnt(4)
v_mfma_f32_32x32x16_bf16 v[40:55], a[136:139], v[108:111], v[40:55]
s_add_u32 m0, s29, 40960
s_add_u32 s59, s35, 20461568
v_mfma_f32_32x32x16_bf16 v[56:71], a[140:143], v[108:111], v[56:71]
buffer_load_dwordx4 v22, s[8:11], s59 offen sc1 lds
s_waitcnt vmcnt(8)
ds_read_b128 v[128:131], v24 offset:8192
s_waitcnt lgkmcnt(4)
v_mfma_f32_32x32x16_bf16 v[40:55], a[144:147], v[112:115], v[40:55]
s_add_u32 m0, s29, 45056
s_add_u32 s59, s35, 20462592
v_mfma_f32_32x32x16_bf16 v[56:71], a[148:151], v[112:115], v[56:71]
buffer_load_dwordx4 v22, s[8:11], s59 offen sc1 lds
s_waitcnt vmcnt(8)
ds_read_b128 v[132:135], v24 offset:12288
s_waitcnt lgkmcnt(4)
v_mfma_f32_32x32x16_bf16 v[40:55], a[152:155], v[116:119], v[40:55]
s_add_u32 m0, s29, 49152
s_add_u32 s59, s35, 20463616
v_mfma_f32_32x32x16_bf16 v[56:71], a[156:159], v[116:119], v[56:71]
buffer_load_dwordx4 v22, s[8:11], s59 offen sc1 lds
s_barrier
s_add_u32 s63, s56, 65536
s_mov_b64 exec, 255
buffer_atomic_add v35, v3, s[8:11], s63 offen sc1
s_mov_b64 exec, -1
s_waitcnt vmcnt(9)
ds_read_b128 v[104:107], v24 offset:16384
s_waitcnt lgkmcnt(4)
v_mfma_f32_32x32x16_bf16 v[40:55], a[160:163], v[120:123], v[40:55]
s_add_u32 m0, s29, 53248
s_add_u32 s59, s35, 20464640
v_mfma_f32_32x32x16_bf16 v[56:71], a[164:167], v[120:123], v[56:71]
buffer_load_dwordx4 v22, s[8:11], s59 offen sc1 lds
s_waitcnt vmcnt(9)
ds_read_b128 v[108:111], v24 offset:20480
s_waitcnt lgkmcnt(4)
v_mfma_f32_32x32x16_bf16 v[40:55], a[168:171], v[124:127], v[40:55]
s_add_u32 m0, s29, 57344
s_add_u32 s59, s35, 20465664
v_mfma_f32_32x32x16_bf16 v[56:71], a[172:175], v[124:127], v[56:71]
buffer_load_dwordx4 v22, s[8:11], s59 offen sc1 lds
s_waitcnt vmcnt(9)
ds_read_b128 v[112:115], v24 offset:24576
s_waitcnt lgkmcnt(4)
v_mfma_f32_32x32x16_bf16 v[40:55], a[176:179], v[128:131], v[40:55]
s_add_u32 m0, s29, 61440
s_add_u32 s59, s35, 20466688
v_mfma_f32_32x32x16_bf16 v[56:71], a[180:183], v[128:131], v[56:71]
buffer_load_dwordx4 v22, s[8:11], s59 offen sc1 lds
s_waitcnt vmcnt(9)
ds_read_b128 v[116:119], v24 offset:28672
s_waitcnt lgkmcnt(4)
v_mfma_f32_32x32x16_bf16 v[40:55], a[184:187], v[132:135], v[40:55]
s_add_u32 m0, s29, 65536
s_add_u32 s59, s35, 20467712
v_mfma_f32_32x32x16_bf16 v[56:71], a[188:191], v[132:135], v[56:71]
buffer_load_dwordx4 v22, s[8:11], s59 offen sc1 lds
s_waitcnt vmcnt(9)
ds_read_b128 v[120:123], v24 offset:32768
s_waitcnt lgkmcnt(4)
v_mfma_f32_32x32x16_bf16 v[40:55], a[192:195], v[104:107], v[40:55]
s_add_u32 m0, s29, 69632
s_add_u32 s59, s35, 20468736
v_mfma_f32_32x32x16_bf16 v[56:71], a[196:199], v[104:107], v[56:71]
buffer_load_dwordx4 v22, s[8:11], s59 offen sc1 lds
s_waitcnt vmcnt(9)
ds_read_b128 v[124:127], v24 offset:36864
s_waitcnt lgkmcnt(4)
v_mfma_f32_32x32x16_bf16 v[40:55], a[200:203], v[108:111], v[40:55]
s_add_u32 m0, s29, 73728
s_add_u32 s59, s35, 20469760
v_mfma_f32_32x32x16_bf16 v[56:71], a[204:207], v[108:111], v[56:71]
buffer_load_dwordx4 v22, s[8:11], s59 offen sc1 lds
s_waitcnt vmcnt(9)
ds_read_b128 v[128:131], v24 offset:40960
s_waitcnt lgkmcnt(4)
v_mfma_f32_32x32x16_bf16 v[40:55], a[208:211], v[112:115], v[40:55]
s_add_u32 m0, s29, 77824
s_add_u32 s59, s35, 20470784
v_mfma_f32_32x32x16_bf16 v[56:71], a[212:215], v[112:115], v[56:71]
buffer_load_dwordx4 v22, s[8:11], s59 offen sc1 lds
s_waitcnt vmcnt(9)
ds_read_b128 v[132:135], v24 offset:45056
s_waitcnt lgkmcnt(4)
v_mfma_f32_32x32x16_bf16 v[40:55], a[216:219], v[116:119], v[40:55]
s_add_u32 m0, s29, 81920
s_add_u32 s59, s35, 20471808
v_mfma_f32_32x32x16_bf16 v[56:71], a[220:223], v[116:119], v[56:71]
buffer_load_dwordx4 v22, s[8:11], s59 offen sc1 lds
s_waitcnt vmcnt(9)
ds_read_b128 v[104:107], v25 offset:0
s_waitcnt lgkmcnt(4)
v_mfma_f32_32x32x16_bf16 v[40:55], a[224:227], v[120:123], v[40:55]
s_add_u32 m0, s29, 86016
s_add_u32 s59, s35, 20472832
v_mfma_f32_32x32x16_bf16 v[56:71], a[228:231], v[120:123], v[56:71]
buffer_load_dwordx4 v22, s[8:11], s59 offen sc1 lds
s_waitcnt vmcnt(8)
ds_read_b128 v[108:111], v25 offset:4096
s_waitcnt lgkmcnt(4)
v_mfma_f32_32x32x16_bf16 v[40:55], a[232:235], v[124:127], v[40:55]
s_add_u32 m0, s29, 90112
s_add_u32 s59, s35, 20473856
v_mov_b32 v136, 0
v_mov_b32 v137, 0
v_mov_b32 v138, 0
v_mov_b32 v139, 0
v_mfma_f32_32x32x16_bf16 v[56:71], a[236:239], v[124:127], v[56:71]
buffer_load_dwordx4 v22, s[8:11], s59 offen sc1 lds
v_mov_b32 v140, 0
v_mov_b32 v141, 0
v_mov_b32 v142, 0
v_mov_b32 v143, 0
s_waitcnt vmcnt(8)
ds_read_b128 v[112:115], v25 offset:8192
s_waitcnt lgkmcnt(4)
v_mfma_f32_32x32x16_bf16 v[40:55], a[240:243], v[128:131], v[40:55]
s_add_u32 m0, s29, 94208
s_add_u32 s59, s35, 20474880
s_add_u32 s60, s36, 4196352
buffer_load_short_d16_hi v136, v26, s[8:11], s60 offen sc1
s_add_u32 s60, s36, 4200448
buffer_load_short_d16_hi v137, v26, s[8:11], s60 offen sc1
v_mfma_f32_32x32x16_bf16 v[56:71], a[244:247], v[128:131], v[56:71]
buffer_load_dwordx4 v22, s[8:11], s59 offen sc1 lds
s_add_u32 s60, s36, 4204544
buffer_load_short_d16_hi v138, v26, s[8:11], s60 offen sc1
s_waitcnt vmcnt(11)
ds_read_b128 v[116:119], v25 offset:12288
s_waitcnt lgkmcnt(4)
v_mfma_f32_32x32x16_bf16 v[40:55], a[248:251], v[132:135], v[40:55]
s_add_u32 s60, s36, 4208640
buffer_load_short_d16_hi v139, v26, s[8:11], s60 offen sc1
v_mfma_f32_32x32x16_bf16 v[56:71], a[252:255], v[132:135], v[56:71]
s_add_u32 s60, s36, 4229120
buffer_load_short_d16_hi v140, v26, s[8:11], s60 offen sc1
s_add_u32 s60, s36, 4233216
buffer_load_short_d16_hi v141, v26, s[8:11], s60 offen sc1
s_waitcnt vmcnt(13)
ds_read_b128 v[120:123], v25 offset:16384
s_waitcnt lgkmcnt(4)
v_mfma_f32_32x32x16_bf16 v[40:55], v[160:163], v[104:107], v[40:55]
s_add_u32 s60, s36, 4237312
buffer_load_short_d16_hi v142, v26, s[8:11], s60 offen sc1
v_mfma_f32_32x32x16_bf16 v[56:71], v[164:167], v[104:107], v[56:71]
s_add_u32 s60, s36, 4241408
buffer_load_short_d16_hi v143, v26, s[8:11], s60 offen sc1
s_waitcnt vmcnt(14)
ds_read_b128 v[124:127], v25 offset:20480
s_waitcnt lgkmcnt(4)
v_mfma_f32_32x32x16_bf16 v[40:55], v[168:171], v[108:111], v[40:55]
s_add_u32 s60, s38, 139264
buffer_load_dword v148, v23, s[8:11], s60 offen offset:4 sc1
v_add_u32 v149, s86, v22
v_add_u32 v150, s87, v22
v_add_u32 v151, s88, v22
v_mfma_f32_32x32x16_bf16 v[56:71], v[172:175], v[108:111], v[56:71]
v_add_u32 v152, s89, v22
s_waitcnt vmcnt(14)
ds_read_b128 v[128:131], v25 offset:24576
s_waitcnt lgkmcnt(4)
v_mfma_f32_32x32x16_bf16 v[40:55], v[176:179], v[112:115], v[40:55]
v_mfma_f32_32x32x16_bf16 v[56:71], v[180:183], v[112:115], v[56:71]
s_waitcnt vmcnt(13)
ds_read_b128 v[132:135], v25 offset:28672
s_waitcnt lgkmcnt(4)
v_mfma_f32_32x32x16_bf16 v[40:55], v[184:187], v[116:119], v[40:55]
v_mfma_f32_32x32x16_bf16 v[56:71], v[188:191], v[116:119], v[56:71]
s_waitcnt vmcnt(12)
ds_read_b128 v[104:107], v25 offset:32768
s_waitcnt lgkmcnt(4)
v_mfma_f32_32x32x16_bf16 v[40:55], v[192:195], v[120:123], v[40:55]
v_mfma_f32_32x32x16_bf16 v[56:71], v[196:199], v[120:123], v[56:71]
s_waitcnt vmcnt(11)
ds_read_b128 v[108:111], v25 offset:36864
s_waitcnt lgkmcnt(4)
v_mfma_f32_32x32x16_bf16 v[40:55], v[200:203], v[124:127], v[40:55]
v_mfma_f32_32x32x16_bf16 v[56:71], v[204:207], v[124:127], v[56:71]
s_waitcnt vmcnt(10)
ds_read_b128 v[112:115], v25 offset:40960
s_waitcnt lgkmcnt(4)
v_mfma_f32_32x32x16_bf16 v[40:55], v[208:211], v[128:131], v[40:55]
v_mfma_f32_32x32x16_bf16 v[56:71], v[212:215], v[128:131], v[56:71]
s_waitcnt vmcnt(7)
ds_read_b128 v[116:119], v25 offset:45056
s_waitcnt lgkmcnt(4)
v_mfma_f32_32x32x16_bf16 v[40:55], v[216:219], v[132:135], v[40:55]
v_mfma_f32_32x32x16_bf16 v[56:71], v[220:223], v[132:135], v[56:71]
s_add_u32 s64, s56, 65536
buffer_load_dword v34, v2, s[8:11], s64 offen sc1
s_waitcnt lgkmcnt(3)
v_mfma_f32_32x32x16_bf16 v[56:71], v[228:231], v[104:107], v[56:71]
s_waitcnt lgkmcnt(2)
v_mfma_f32_32x32x16_bf16 v[56:71], v[236:239], v[108:111], v[56:71]
s_waitcnt lgkmcnt(1)
v_mfma_f32_32x32x16_bf16 v[56:71], v[244:247], v[112:115], v[56:71]
s_waitcnt lgkmcnt(0)
v_mfma_f32_32x32x16_bf16 v[56:71], v[252:255], v[116:119], v[56:71]
v_mfma_f32_32x32x16_bf16 v[40:55], v[224:227], v[104:107], v[40:55]
s_nop 4
v_mfma_f32_32x32x16_bf16 v[40:55], v[232:235], v[108:111], v[40:55]
s_nop 4
v_mfma_f32_32x32x16_bf16 v[40:55], v[240:243], v[112:115], v[40:55]
ds_write_b128 v149, v[56:59] offset:2048
v_mfma_f32_32x32x16_bf16 v[40:55], v[248:251], v[116:119], v[40:55]
ds_write_b128 v149, v[60:63] offset:3072
ds_write_b128 v149, v[64:67] offset:4096
ds_write_b128 v149, v[68:71] offset:5120
s_nop 8
ds_write_b128 v149, v[48:51] offset:0
ds_write_b128 v149, v[52:55] offset:1024
s_waitcnt vmcnt(1)
v_mul_f32 v148, v148, v148
s_waitcnt vmcnt(0)
v_cmp_gt_u32 vcc, s57, v34
s_cbranch_vccz Lsd_1047
s_mov_b32 s80, 0
Lsq_1048:
buffer_load_dword v34, v2, s[8:11], s64 offen sc1
s_add_u32 s80, s80, 1
s_cmp_lt_u32 s80, 0x8000
s_cbranch_scc0 Lsd_1047
s_waitcnt vmcnt(0)
v_cmp_gt_u32 vcc, s57, v34
s_nop 1
s_cbranch_vccnz Lsq_1048
Lsd_1047:
s_waitcnt lgkmcnt(0)
s_barrier
ds_read_b128 v[72:75], v150 offset:0
ds_read_b128 v[76:79], v150 offset:1024
ds_read_b128 v[80:83], v151 offset:0
ds_read_b128 v[84:87], v151 offset:1024
ds_read_b128 v[88:91], v152 offset:0
ds_read_b128 v[92:95], v152 offset:1024
s_mov_b32 s60, 163840
buffer_load_dwordx4 v[104:107], v9, s[8:11], s60 offen sc1
s_mov_b32 s60, 167936
buffer_load_dwordx4 v[108:111], v9, s[8:11], s60 offen sc1
s_add_u32 s60, s32, 6291456
buffer_load_dword v112, v10, s[8:11], s60 offen offset:0 sc1
buffer_load_dword v113, v10, s[8:11], s60 offen offset:1024 sc1
s_add_u32 s60, s32, 6295552
buffer_load_dword v114, v10, s[8:11], s60 offen offset:0 sc1
buffer_load_dword v115, v10, s[8:11], s60 offen offset:1024 sc1
s_waitcnt lgkmcnt(4)
v_pk_add_f32 v[40:41], v[40:41], v[72:73]
v_pk_add_f32 v[42:43], v[42:43], v[74:75]
v_pk_add_f32 v[44:45], v[44:45], v[76:77]
v_pk_add_f32 v[46:47], v[46:47], v[78:79]
s_waitcnt lgkmcnt(0)
v_pk_add_f32 v[80:81], v[80:81], v[88:89]
v_pk_add_f32 v[82:83], v[82:83], v[90:91]
v_pk_add_f32 v[84:85], v[84:85], v[92:93]
v_pk_add_f32 v[86:87], v[86:87], v[94:95]
v_pk_add_f32 v[40:41], v[40:41], v[80:81]
v_pk_add_f32 v[42:43], v[42:43], v[82:83]
v_pk_add_f32 v[44:45], v[44:45], v[84:85]
v_pk_add_f32 v[46:47], v[46:47], v[86:87]
v_fmac_f32 v136, v40, v148
v_fmac_f32 v137, v41, v148
v_fmac_f32 v138, v42, v148
v_fmac_f32 v139, v43, v148
v_fmac_f32 v140, v44, v148
v_fmac_f32 v141, v45, v148
v_fmac_f32 v142, v46, v148
v_fmac_f32 v143, v47, v148
v_cvt_pk_bf16_f32 v96, v136, v137
v_cvt_pk_bf16_f32 v97, v138, v139
v_cvt_pk_bf16_f32 v98, v140, v141
v_cvt_pk_bf16_f32 v99, v142, v143
ds_write_b16 v28, v96 offset:57856
ds_write_b16_d16_hi v28, v96 offset:57920
ds_write_b16 v28, v97 offset:57984
ds_write_b16_d16_hi v28, v97 offset:58048
ds_write_b16 v28, v98 offset:58368
ds_write_b16_d16_hi v28, v98 offset:58432
ds_write_b16 v28, v99 offset:58496
ds_write_b16_d16_hi v28, v99 offset:58560
s_mov_b32 s62, 0x3f803f80
s_lshl_b32 s60, s28, 8
s_add_u32 m0, s60, 61952
v_dot2_f32_bf16 v154, v96, s62, 0
v_dot2_f32_bf16 v155, v96, v96, 0
v_dot2_f32_bf16 v154, v97, s62, v154
v_dot2_f32_bf16 v155, v97, v97, v155
v_dot2_f32_bf16 v154, v98, s62, v154
v_dot2_f32_bf16 v155, v98, v98, v155
v_dot2_f32_bf16 v154, v99, s62, v154
v_dot2_f32_bf16 v155, v99, v99, v155
s_add_u32 s60, s38, 172032
v_lshlrev_b32 v153, 2, v1
s_nop 0
v_permlane32_swap_b32 v154, v155
v_add_f32 v154, v154, v155
ds_write_addtid_b32 v154
s_waitcnt lgkmcnt(0)
s_barrier
ds_read_b128 v[100:103], v9 offset:57856
ds_read2st64_b32 v[72:73], v153 offset0:242 offset1:243
ds_read2st64_b32 v[74:75], v153 offset0:244 offset1:245
s_add_u32 s61, s60, s56
s_add_u32 s60, s37, 6293504
s_waitcnt lgkmcnt(0)
buffer_store_dwordx4 v[100:103], v29, s[8:11], s60 offen sc1
v_add_f32 v72, v72, v73
v_add_f32 v74, v74, v75
v_add_f32 v72, v72, v74
buffer_atomic_add_f32 v72, v27, s[8:11], s61 offen
v_mov_b32 v40, 0
v_mov_b32 v41, 0
v_mov_b32 v42, 0
v_mov_b32 v43, 0
ds_write_b128 v36, v[40:43] offset:33280
ds_write_b128 v37, v[40:43] offset:35328
s_waitcnt vmcnt(2)
v_mul_f32 v104, 0x3b000000, v104
v_mul_f32 v105, 0x3b000000, v105
v_mul_f32 v106, 0x3b000000, v106
v_mul_f32 v107, 0x3b000000, v107
v_mul_f32 v108, 0x3b000000, v108
v_mul_f32 v109, 0x3b000000, v109
v_mul_f32 v110, 0x3b000000, v110
v_mul_f32 v111, 0x3b000000, v111
v_fma_f32 v105, -v104, v104, v105
v_fma_f32 v107, -v106, v106, v107
v_fma_f32 v109, -v108, v108, v109
v_fma_f32 v111, -v110, v110, v111
v_max_f32 v105, 0, v105
v_max_f32 v107, 0, v107
v_max_f32 v109, 0, v109
v_max_f32 v111, 0, v111
v_cvt_pk_bf16_f32 v152, v104, v105
v_cvt_pk_bf16_f32 v153, v106, v107
v_cvt_pk_bf16_f32 v154, v108, v109
v_cvt_pk_bf16_f32 v155, v110, v111
v_and_b32 v105, 0xffff0000, v152
v_and_b32 v107, 0xffff0000, v153
v_and_b32 v109, 0xffff0000, v154
v_and_b32 v111, 0xffff0000, v155
v_add_f32 v105, 0x3727c5ac, v105
v_add_f32 v107, 0x3727c5ac, v107
v_add_f32 v109, 0x3727c5ac, v109
v_add_f32 v111, 0x3727c5ac, v111
v_cvt_pk_bf16_f32 v105, v105, v105
v_cvt_pk_bf16_f32 v107, v107, v107
v_cvt_pk_bf16_f32 v109, v109, v109
v_cvt_pk_bf16_f32 v111, v111, v111
v_lshlrev_b32 v105, 16, v105
v_lshlrev_b32 v107, 16, v107
v_lshlrev_b32 v109, 16, v109
v_lshlrev_b32 v111, 16, v111
v_sqrt_f32 v105, v105
v_sqrt_f32 v107, v107
v_sqrt_f32 v109, v109
v_sqrt_f32 v111, v111
v_cvt_pk_bf16_f32 v105, v105, v105
v_cvt_pk_bf16_f32 v107, v107, v107
v_cvt_pk_bf16_f32 v109, v109, v109
v_cvt_pk_bf16_f32 v111, v111, v111
v_lshlrev_b32 v105, 16, v105
v_lshlrev_b32 v107, 16, v107
v_lshlrev_b32 v109, 16, v109
v_lshlrev_b32 v111, 16, v111
v_lshlrev_b32 v104, 16, v152
v_lshlrev_b32 v106, 16, v153
v_lshlrev_b32 v108, 16, v154
v_lshlrev_b32 v110, 16, v155
v_lshlrev_b32 v140, 16, v112
v_and_b32 v141, 0xffff0000, v112
v_lshlrev_b32 v142, 16, v113
v_and_b32 v143, 0xffff0000, v113
v_lshlrev_b32 v144, 16, v114
v_and_b32 v145, 0xffff0000, v114
v_lshlrev_b32 v146, 16, v115
v_and_b32 v147, 0xffff0000, v115
v_rcp_f32 v105, v105
v_rcp_f32 v107, v107
v_rcp_f32 v109, v109
v_rcp_f32 v111, v111
v_sub_f32 v140, v140, v104
v_sub_f32 v141, v141, v106
v_sub_f32 v142, v142, v108
v_sub_f32 v143, v143, v110
v_sub_f32 v144, v144, v104
v_sub_f32 v145, v145, v106
v_sub_f32 v146, v146, v108
v_sub_f32 v147, v147, v110
v_mul_f32 v140, v140, v105
v_mul_f32 v141, v141, v107
v_mul_f32 v142, v142, v109
v_mul_f32 v143, v143, v111
v_mul_f32 v144, v144, v105
v_mul_f32 v145, v145, v107
v_mul_f32 v146, v146, v109
v_mul_f32 v147, v147, v111
v_cvt_pk_bf16_f32 v140, v140, v141
v_cvt_pk_bf16_f32 v142, v142, v143
v_cvt_pk_bf16_f32 v144, v144, v145
v_cvt_pk_bf16_f32 v146, v146, v147
ds_write_b32 v8, v112 offset:48640
ds_write_b32 v8, v140 offset:35840
ds_write_b32 v8, v113 offset:49920
ds_write_b32 v8, v142 offset:37120
ds_write_b32 v8, v114 offset:53760
ds_write_b32 v8, v144 offset:43520
ds_write_b32 v8, v115 offset:55040
ds_write_b32 v8, v146 offset:44800
s_waitcnt vmcnt(0)
s_waitcnt lgkmcnt(0)
s_barrier
s_add_u32 s63, s56, 81920
s_mov_b64 exec, 255
buffer_atomic_add v35, v3, s[8:11], s63 offen sc1
s_mov_b64 exec, -1
ds_read_b128 v[72:75], v7 offset:1200
ds_read_b64 v[76:77], v6 offset:3008
ds_read_b64 v[78:79], v6 offset:3016
ds_read_b128 v[80:83], v7 offset:1232
ds_read_b64 v[84:85], v6 offset:3040
ds_read_b64 v[86:87], v6 offset:3048
ds_read_b128 v[88:91], v7 offset:1120
ds_read_b64 v[92:93], v6 offset:2944
ds_read_b64 v[94:95], v6 offset:2952
ds_read_b128 v[96:99], v7 offset:1152
ds_read_b64 v[100:101], v6 offset:2976
ds_read_b64 v[102:103], v6 offset:2984
s_waitcnt lgkmcnt(9)
v_mfma_f32_32x32x16_bf16 v[40:55], v[76:79], v[72:75], 0
v_add_u32 v150, s84, v22
v_add_u32 v151, s85, v22
ds_read_b128 v[104:107], v7 offset:1040
ds_read_b64 v[108:109], v6 offset:2880
ds_read_b64 v[110:111], v6 offset:2888
s_waitcnt lgkmcnt(9)
v_mfma_f32_32x32x16_bf16 v[40:55], v[84:87], v[80:83], v[40:55]
ds_read_b64 v[140:141], v11 offset:0
ds_read_b64 v[144:145], v33 offset:0
ds_read_b128 v[72:75], v7 offset:1072
ds_read_b64 v[76:77], v6 offset:2912
ds_read_b64 v[78:79], v6 offset:2920
s_waitcnt lgkmcnt(11)
v_mfma_f32_32x32x16_bf16 v[40:55], v[92:95], v[88:91], v[40:55]
ds_read_b64 v[142:143], v11 offset:16
ds_read_b64 v[146:147], v33 offset:16
ds_read_b128 v[80:83], v7 offset:960
ds_read_b64 v[84:85], v6 offset:2816
ds_read_b64 v[86:87], v6 offset:2824
s_waitcnt lgkmcnt(13)
v_mfma_f32_32x32x16_bf16 v[40:55], v[100:103], v[96:99], v[40:55]
ds_read_b128 v[88:91], v7 offset:992
ds_read_b64 v[92:93], v6 offset:2848
ds_read_b64 v[94:95], v6 offset:2856
s_waitcnt lgkmcnt(13)
v_mfma_f32_32x32x16_bf16 v[40:55], v[108:111], v[104:107], v[40:55]
ds_read_b128 v[96:99], v7 offset:880
ds_read_b64 v[100:101], v6 offset:2752
ds_read_b64 v[102:103], v6 offset:2760
s_waitcnt lgkmcnt(11)
v_mfma_f32_32x32x16_bf16 v[40:55], v[76:79], v[72:75], v[40:55]
s_waitcnt lgkmcnt(9)
v_lshlrev_b32 v132, 16, v144
v_and_b32 v133, 0xffff0000, v144
ds_read_b128 v[104:107], v7 offset:912
ds_read_b64 v[108:109], v6 offset:2784
ds_read_b64 v[110:111], v6 offset:2792
s_waitcnt lgkmcnt(9)
v_mfma_f32_32x32x16_bf16 v[40:55], v[84:87], v[80:83], v[40:55]
v_lshlrev_b32 v134, 16, v145
v_and_b32 v135, 0xffff0000, v145
ds_read_b128 v[72:75], v7 offset:800
ds_read_b64 v[76:77], v6 offset:2688
ds_read_b64 v[78:79], v6 offset:2696
s_waitcnt lgkmcnt(9)
v_mfma_f32_32x32x16_bf16 v[40:55], v[92:95], v[88:91], v[40:55]
v_lshlrev_b32 v136, 16, v146
v_and_b32 v137, 0xffff0000, v146
ds_read_b128 v[80:83], v7 offset:832
ds_read_b64 v[84:85], v6 offset:2720
ds_read_b64 v[86:87], v6 offset:2728
s_waitcnt lgkmcnt(9)
v_mfma_f32_32x32x16_bf16 v[40:55], v[100:103], v[96:99], v[40:55]
v_lshlrev_b32 v138, 16, v147
v_and_b32 v139, 0xffff0000, v147
ds_read_b128 v[88:91], v7 offset:720
ds_read_b64 v[92:93], v6 offset:2624
ds_read_b64 v[94:95], v6 offset:2632
s_waitcnt lgkmcnt(9)
v_mfma_f32_32x32x16_bf16 v[40:55], v[108:111], v[104:107], v[40:55]
v_lshlrev_b32 v144, 16, v140
v_lshlrev_b32 v145, 16, v141
ds_read_b128 v[96:99], v7 offset:752
ds_read_b64 v[100:101], v6 offset:2656
ds_read_b64 v[102:103], v6 offset:2664
s_waitcnt lgkmcnt(9)
v_mfma_f32_32x32x16_bf16 v[40:55], v[76:79], v[72:75], v[40:55]
v_lshlrev_b32 v146, 16, v142
v_lshlrev_b32 v147, 16, v143
ds_read_b128 v[104:107], v7 offset:640
ds_read_b64 v[108:109], v6 offset:2560
ds_read_b64 v[110:111], v6 offset:2568
s_waitcnt lgkmcnt(9)
v_mfma_f32_32x32x16_bf16 v[40:55], v[84:87], v[80:83], v[40:55]
v_and_b32 v140, 0xffff0000, v140
v_and_b32 v141, 0xffff0000, v141
ds_read_b128 v[72:75], v7 offset:672
ds_read_b64 v[76:77], v6 offset:2592
ds_read_b64 v[78:79], v6 offset:2600
s_waitcnt lgkmcnt(9)
v_mfma_f32_32x32x16_bf16 v[40:55], v[92:95], v[88:91], v[40:55]
v_and_b32 v142, 0xffff0000, v142
v_and_b32 v143, 0xffff0000, v143
ds_read_b128 v[80:83], v7 offset:560
ds_read_b64 v[84:85], v6 offset:2496
ds_read_b64 v[86:87], v6 offset:2504
s_waitcnt lgkmcnt(9)
v_mfma_f32_32x32x16_bf16 v[40:55], v[100:103], v[96:99], v[40:55]
v_fmac_f32 v132, v144, v5
v_fmac_f32 v133, v140, v5
ds_read_b128 v[88:91], v7 offset:592
ds_read_b64 v[92:93], v6 offset:2528
ds_read_b64 v[94:95], v6 offset:2536
s_waitcnt lgkmcnt(9)
v_mfma_f32_32x32x16_bf16 v[40:55], v[108:111], v[104:107], v[40:55]
v_fmac_f32 v134, v145, v5
v_fmac_f32 v135, v141, v5
ds_read_b128 v[96:99], v7 offset:480
ds_read_b64 v[100:101], v6 offset:2432
ds_read_b64 v[102:103], v6 offset:2440
s_waitcnt lgkmcnt(9)
v_mfma_f32_32x32x16_bf16 v[40:55], v[76:79], v[72:75], v[40:55]
v_fmac_f32 v136, v146, v5
v_fmac_f32 v137, v142, v5
ds_read_b128 v[104:107], v7 offset:512
ds_read_b64 v[108:109], v6 offset:2464
ds_read_b64 v[110:111], v6 offset:2472
s_waitcnt lgkmcnt(9)
v_mfma_f32_32x32x16_bf16 v[40:55], v[84:87], v[80:83], v[40:55]
v_fmac_f32 v138, v147, v5
v_fmac_f32 v139, v143, v5
ds_read_b128 v[72:75], v7 offset:400
ds_read_b64 v[76:77], v6 offset:2368
ds_read_b64 v[78:79], v6 offset:2376
s_waitcnt lgkmcnt(9)
v_mfma_f32_32x32x16_bf16 v[40:55], v[92:95], v[88:91], v[40:55]
ds_read_b128 v[80:83], v7 offset:432
ds_read_b64 v[84:85], v6 offset:2400
ds_read_b64 v[86:87], v6 offset:2408
s_waitcnt lgkmcnt(9)
v_mfma_f32_32x32x16_bf16 v[40:55], v[100:103], v[96:99], v[40:55]
ds_read_b128 v[88:91], v7 offset:320
ds_read_b64 v[92:93], v6 offset:2304
ds_read_b64 v[94:95], v6 offset:2312
s_waitcnt lgkmcnt(9)
v_mfma_f32_32x32x16_bf16 v[40:55], v[108:111], v[104:107], v[40:55]
ds_read_b128 v[96:99], v7 offset:352
ds_read_b64 v[100:101], v6 offset:2336
ds_read_b64 v[102:103], v6 offset:2344
s_waitcnt lgkmcnt(9)
v_mfma_f32_32x32x16_bf16 v[40:55], v[76:79], v[72:75], v[40:55]
ds_read_b128 v[104:107], v7 offset:240
ds_read_b64 v[108:109], v6 offset:2240
ds_read_b64 v[110:111], v6 offset:2248
s_waitcnt lgkmcnt(9)
v_mfma_f32_32x32x16_bf16 v[40:55], v[84:87], v[80:83], v[40:55]
ds_read_b128 v[72:75], v7 offset:272
ds_read_b64 v[76:77], v6 offset:2272
ds_read_b64 v[78:79], v6 offset:2280
s_waitcnt lgkmcnt(9)
v_mfma_f32_32x32x16_bf16 v[40:55], v[92:95], v[88:91], v[40:55]
ds_read_b128 v[80:83], v7 offset:160
ds_read_b64 v[84:85], v6 offset:2176
ds_read_b64 v[86:87], v6 offset:2184
s_waitcnt lgkmcnt(9)
v_mfma_f32_32x32x16_bf16 v[40:55], v[100:103], v[96:99], v[40:55]
ds_read_b128 v[88:91], v7 offset:192
ds_read_b64 v[92:93], v6 offset:2208
ds_read_b64 v[94:95], v6 offset:2216
s_waitcnt lgkmcnt(9)
v_mfma_f32_32x32x16_bf16 v[40:55], v[108:111], v[104:107], v[40:55]
ds_read_b128 v[96:99], v7 offset:80
ds_read_b64 v[100:101], v6 offset:2112
ds_read_b64 v[102:103], v6 offset:2120
s_waitcnt lgkmcnt(9)
v_mfma_f32_32x32x16_bf16 v[40:55], v[76:79], v[72:75], v[40:55]
ds_read_b128 v[104:107], v7 offset:112
ds_read_b64 v[108:109], v6 offset:2144
ds_read_b64 v[110:111], v6 offset:2152
s_waitcnt lgkmcnt(9)
v_mfma_f32_32x32x16_bf16 v[40:55], v[84:87], v[80:83], v[40:55]
ds_read_b128 v[72:75], v7 offset:0
ds_read_b64 v[76:77], v6 offset:2048
ds_read_b64 v[78:79], v6 offset:2056
s_waitcnt lgkmcnt(9)
v_mfma_f32_32x32x16_bf16 v[40:55], v[92:95], v[88:91], v[40:55]
ds_read_b128 v[80:83], v7 offset:32
ds_read_b64 v[84:85], v6 offset:2080
ds_read_b64 v[86:87], v6 offset:2088
s_waitcnt lgkmcnt(9)
v_mfma_f32_32x32x16_bf16 v[40:55], v[100:103], v[96:99], v[40:55]
s_waitcnt lgkmcnt(6)
v_mfma_f32_32x32x16_bf16 v[40:55], v[108:111], v[104:107], v[40:55]
s_waitcnt lgkmcnt(3)
v_mfma_f32_32x32x16_bf16 v[40:55], v[76:79], v[72:75], v[40:55]
s_waitcnt lgkmcnt(0)
v_mfma_f32_32x32x16_bf16 v[40:55], v[84:87], v[80:83], v[40:55]
s_add_u32 s64, s56, 81920
buffer_load_dword v34, v2, s[8:11], s64 offen sc1
ds_read_b128 v[72:75], v7 offset:1200
ds_read_b64 v[76:77], v6 offset:960
ds_read_b64 v[78:79], v6 offset:968
ds_read_b128 v[80:83], v7 offset:1232
ds_read_b64 v[84:85], v6 offset:992
ds_read_b64 v[86:87], v6 offset:1000
ds_read_b128 v[88:91], v7 offset:1120
ds_read_b64 v[92:93], v6 offset:896
ds_read_b64 v[94:95], v6 offset:904
ds_read_b128 v[96:99], v7 offset:1152
ds_read_b64 v[100:101], v6 offset:928
ds_read_b64 v[102:103], v6 offset:936
s_waitcnt lgkmcnt(9)
v_mfma_f32_32x32x16_bf16 v[56:71], v[76:79], v[72:75], 0
ds_read_b128 v[104:107], v7 offset:1040
ds_read_b64 v[108:109], v6 offset:832
ds_read_b64 v[110:111], v6 offset:840
s_waitcnt lgkmcnt(9)
v_mfma_f32_32x32x16_bf16 v[56:71], v[84:87], v[80:83], v[56:71]
ds_write_b128 v150, v[48:51]
ds_write_b128 v150, v[52:55] offset:1024
v_add_f32 v132, v132, v40
v_add_f32 v133, v133, v41
v_add_f32 v134, v134, v42
v_add_f32 v135, v135, v43
v_add_f32 v136, v136, v44
v_add_f32 v137, v137, v45
v_add_f32 v138, v138, v46
v_add_f32 v139, v139, v47
s_add_u32 s67, s90, 8388608
s_waitcnt lgkmcnt(0)
s_barrier
ds_read_b128 v[112:115], v151
ds_read_b128 v[116:119], v151 offset:1024
ds_read_b128 v[72:75], v7 offset:1072
ds_read_b64 v[76:77], v6 offset:864
ds_read_b64 v[78:79], v6 offset:872
v_mfma_f32_32x32x16_bf16 v[56:71], v[92:95], v[88:91], v[56:71]
ds_read_b128 v[80:83], v7 offset:960
ds_read_b64 v[84:85], v6 offset:768
ds_read_b64 v[86:87], v6 offset:776
v_mfma_f32_32x32x16_bf16 v[56:71], v[100:103], v[96:99], v[56:71]
s_waitcnt lgkmcnt(6)
v_add_f32 v132, v132, v112
v_add_f32 v133, v133, v113
v_add_f32 v134, v134, v114
v_add_f32 v135, v135, v115
v_add_f32 v136, v136, v116
v_add_f32 v137, v137, v117
v_add_f32 v138, v138, v118
v_add_f32 v139, v139, v119
v_cvt_pk_bf16_f32 v140, v132, v133
v_cvt_pk_bf16_f32 v141, v134, v135
v_cvt_pk_bf16_f32 v142, v136, v137
v_cvt_pk_bf16_f32 v143, v138, v139
ds_write_b64 v33, v[140:141] offset:0
ds_write_b64 v33, v[142:143] offset:16
ds_read_b128 v[88:91], v7 offset:992
ds_read_b64 v[92:93], v6 offset:800
ds_read_b64 v[94:95], v6 offset:808
v_mfma_f32_32x32x16_bf16 v[56:71], v[108:111], v[104:107], v[56:71]
s_waitcnt vmcnt(0)
v_cmp_gt_u32 vcc, s57, v34
s_cbranch_vccz Lsd_1050
s_mov_b32 s80, 0
Lsq_1051:
buffer_load_dword v34, v2, s[8:11], s64 offen sc1
s_add_u32 s80, s80, 1
s_cmp_lt_u32 s80, 0x8000
s_cbranch_scc0 Lsd_1050
s_waitcnt vmcnt(0)
v_cmp_gt_u32 vcc, s57, v34
s_nop 1
s_cbranch_vccnz Lsq_1051
Lsd_1050:
s_waitcnt lgkmcnt(3)
s_barrier
ds_read_b128 v[112:115], v12 offset:0
ds_read_b128 v[96:99], v7 offset:880
ds_read_b64 v[100:101], v6 offset:704
ds_read_b64 v[102:103], v6 offset:712
v_mfma_f32_32x32x16_bf16 v[56:71], v[76:79], v[72:75], v[56:71]
ds_read_b128 v[104:107], v7 offset:912
ds_read_b64 v[108:109], v6 offset:736
ds_read_b64 v[110:111], v6 offset:744
v_mfma_f32_32x32x16_bf16 v[56:71], v[84:87], v[80:83], v[56:71]
s_waitcnt lgkmcnt(6)
buffer_store_dwordx4 v[112:115], v22, s[8:11], s67 offen sc1
s_mov_b32 s60, 172032
buffer_load_dwordx4 v[120:123], v9, s[8:11], s60 offen sc1
s_mov_b32 s60, 176128
buffer_load_dwordx4 v[124:127], v9, s[8:11], s60 offen sc1
s_add_u32 s60, s32, 6293504
buffer_load_dword v128, v10, s[8:11], s60 offen offset:0 sc1
buffer_load_dword v129, v10, s[8:11], s60 offen offset:1024 sc1
s_add_u32 s60, s32, 6297600
buffer_load_dword v130, v10, s[8:11], s60 offen offset:0 sc1
buffer_load_dword v131, v10, s[8:11], s60 offen offset:1024 sc1
ds_read_b128 v[72:75], v7 offset:800
ds_read_b64 v[76:77], v6 offset:640
ds_read_b64 v[78:79], v6 offset:648
v_mfma_f32_32x32x16_bf16 v[56:71], v[92:95], v[88:91], v[56:71]
ds_read_b128 v[80:83], v7 offset:832
ds_read_b64 v[84:85], v6 offset:672
ds_read_b64 v[86:87], v6 offset:680
s_waitcnt lgkmcnt(9)
v_mfma_f32_32x32x16_bf16 v[56:71], v[100:103], v[96:99], v[56:71]
ds_read_b128 v[88:91], v7 offset:720
ds_read_b64 v[92:93], v6 offset:576
ds_read_b64 v[94:95], v6 offset:584
s_waitcnt lgkmcnt(9)
v_mfma_f32_32x32x16_bf16 v[56:71], v[108:111], v[104:107], v[56:71]
ds_read_b128 v[96:99], v7 offset:752
ds_read_b64 v[100:101], v6 offset:608
ds_read_b64 v[102:103], v6 offset:616
s_waitcnt lgkmcnt(9)
v_mfma_f32_32x32x16_bf16 v[56:71], v[76:79], v[72:75], v[56:71]
ds_read_b128 v[104:107], v7 offset:640
ds_read_b64 v[108:109], v6 offset:512
ds_read_b64 v[110:111], v6 offset:520
s_waitcnt lgkmcnt(9)
v_mfma_f32_32x32x16_bf16 v[56:71], v[84:87], v[80:83], v[56:71]
ds_read_b128 v[72:75], v7 offset:672
ds_read_b64 v[76:77], v6 offset:544
ds_read_b64 v[78:79], v6 offset:552
s_waitcnt lgkmcnt(9)
v_mfma_f32_32x32x16_bf16 v[56:71], v[92:95], v[88:91], v[56:71]
ds_read_b128 v[80:83], v7 offset:560
ds_read_b64 v[84:85], v6 offset:448
ds_read_b64 v[86:87], v6 offset:456
s_waitcnt lgkmcnt(9)
v_mfma_f32_32x32x16_bf16 v[56:71], v[100:103], v[96:99], v[56:71]
ds_read_b128 v[88:91], v7 offset:592
ds_read_b64 v[92:93], v6 offset:480
ds_read_b64 v[94:95], v6 offset:488
s_waitcnt lgkmcnt(9)
v_mfma_f32_32x32x16_bf16 v[56:71], v[108:111], v[104:107], v[56:71]
ds_read_b128 v[96:99], v7 offset:480
ds_read_b64 v[100:101], v6 offset:384
ds_read_b64 v[102:103], v6 offset:392
s_waitcnt lgkmcnt(9)
v_mfma_f32_32x32x16_bf16 v[56:71], v[76:79], v[72:75], v[56:71]
ds_read_b128 v[104:107], v7 offset:512
ds_read_b64 v[108:109], v6 offset:416
ds_read_b64 v[110:111], v6 offset:424
s_waitcnt lgkmcnt(9)
v_mfma_f32_32x32x16_bf16 v[56:71], v[84:87], v[80:83], v[56:71]
ds_read_b128 v[72:75], v7 offset:400
ds_read_b64 v[76:77], v6 offset:320
ds_read_b64 v[78:79], v6 offset:328
s_waitcnt lgkmcnt(9)
v_mfma_f32_32x32x16_bf16 v[56:71], v[92:95], v[88:91], v[56:71]
ds_read_b128 v[80:83], v7 offset:432
ds_read_b64 v[84:85], v6 offset:352
ds_read_b64 v[86:87], v6 offset:360
s_waitcnt lgkmcnt(9)
v_mfma_f32_32x32x16_bf16 v[56:71], v[100:103], v[96:99], v[56:71]
ds_read_b128 v[88:91], v7 offset:320
ds_read_b64 v[92:93], v6 offset:256
ds_read_b64 v[94:95], v6 offset:264
s_waitcnt lgkmcnt(9)
v_mfma_f32_32x32x16_bf16 v[56:71], v[108:111], v[104:107], v[56:71]
ds_read_b128 v[96:99], v7 offset:352
ds_read_b64 v[100:101], v6 offset:288
ds_read_b64 v[102:103], v6 offset:296
s_waitcnt lgkmcnt(9)
v_mfma_f32_32x32x16_bf16 v[56:71], v[76:79], v[72:75], v[56:71]
ds_read_b128 v[104:107], v7 offset:240
ds_read_b64 v[108:109], v6 offset:192
ds_read_b64 v[110:111], v6 offset:200
s_waitcnt lgkmcnt(9)
v_mfma_f32_32x32x16_bf16 v[56:71], v[84:87], v[80:83], v[56:71]
ds_read_b128 v[72:75], v7 offset:272
ds_read_b64 v[76:77], v6 offset:224
ds_read_b64 v[78:79], v6 offset:232
s_waitcnt lgkmcnt(9)
v_mfma_f32_32x32x16_bf16 v[56:71], v[92:95], v[88:91], v[56:71]
ds_read_b128 v[80:83], v7 offset:160
ds_read_b64 v[84:85], v6 offset:128
ds_read_b64 v[86:87], v6 offset:136
s_waitcnt lgkmcnt(9)
v_mfma_f32_32x32x16_bf16 v[56:71], v[100:103], v[96:99], v[56:71]
ds_read_b128 v[88:91], v7 offset:192
ds_read_b64 v[92:93], v6 offset:160
ds_read_b64 v[94:95], v6 offset:168
s_waitcnt lgkmcnt(9)
v_mfma_f32_32x32x16_bf16 v[56:71], v[108:111], v[104:107], v[56:71]
s_waitcnt vmcnt(6)
s_barrier
s_add_u32 s63, s56, 32768
s_mov_b64 exec, 255
buffer_atomic_add v35, v3, s[8:11], s63 offen sc1
s_mov_b64 exec, -1
ds_read_b128 v[96:99], v7 offset:80
ds_read_b64 v[100:101], v6 offset:64
ds_read_b64 v[102:103], v6 offset:72
s_waitcnt lgkmcnt(9)
v_mfma_f32_32x32x16_bf16 v[56:71], v[76:79], v[72:75], v[56:71]
s_waitcnt vmcnt(1)
v_mul_f32 v120, 0x3b000000, v120
v_mul_f32 v121, 0x3b000000, v121
v_mul_f32 v122, 0x3b000000, v122
ds_read_b128 v[104:107], v7 offset:112
ds_read_b64 v[108:109], v6 offset:96
ds_read_b64 v[110:111], v6 offset:104
s_waitcnt lgkmcnt(9)
v_mfma_f32_32x32x16_bf16 v[56:71], v[84:87], v[80:83], v[56:71]
v_mul_f32 v123, 0x3b000000, v123
v_mul_f32 v124, 0x3b000000, v124
v_mul_f32 v125, 0x3b000000, v125
ds_read_b128 v[72:75], v7 offset:0
ds_read_b64 v[76:77], v6 offset:0
ds_read_b64 v[78:79], v6 offset:8
s_waitcnt lgkmcnt(9)
v_mfma_f32_32x32x16_bf16 v[56:71], v[92:95], v[88:91], v[56:71]
v_mul_f32 v126, 0x3b000000, v126
v_mul_f32 v127, 0x3b000000, v127
v_fma_f32 v121, -v120, v120, v121
ds_read_b128 v[80:83], v7 offset:32
ds_read_b64 v[84:85], v6 offset:32
ds_read_b64 v[86:87], v6 offset:40
s_waitcnt lgkmcnt(9)
v_mfma_f32_32x32x16_bf16 v[56:71], v[100:103], v[96:99], v[56:71]
v_fma_f32 v123, -v122, v122, v123
v_fma_f32 v125, -v124, v124, v125
v_fma_f32 v127, -v126, v126, v127
s_waitcnt lgkmcnt(6)
v_mfma_f32_32x32x16_bf16 v[56:71], v[108:111], v[104:107], v[56:71]
v_max_f32 v121, 0, v121
v_max_f32 v123, 0, v123
v_max_f32 v125, 0, v125
s_waitcnt lgkmcnt(3)
v_mfma_f32_32x32x16_bf16 v[56:71], v[76:79], v[72:75], v[56:71]
v_max_f32 v127, 0, v127
v_cvt_pk_bf16_f32 v152, v120, v121
v_cvt_pk_bf16_f32 v153, v122, v123
s_waitcnt lgkmcnt(0)
v_mfma_f32_32x32x16_bf16 v[56:71], v[84:87], v[80:83], v[56:71]
v_cvt_pk_bf16_f32 v154, v124, v125
v_cvt_pk_bf16_f32 v155, v126, v127
v_and_b32 v121, 0xffff0000, v152
v_and_b32 v123, 0xffff0000, v153
v_and_b32 v125, 0xffff0000, v154
v_and_b32 v127, 0xffff0000, v155
v_add_f32 v121, 0x3727c5ac, v121
v_add_f32 v123, 0x3727c5ac, v123
v_add_f32 v125, 0x3727c5ac, v125
v_add_f32 v127, 0x3727c5ac, v127
v_cvt_pk_bf16_f32 v121, v121, v121
v_cvt_pk_bf16_f32 v123, v123, v123
v_cvt_pk_bf16_f32 v125, v125, v125
v_cvt_pk_bf16_f32 v127, v127, v127
v_lshlrev_b32 v121, 16, v121
v_lshlrev_b32 v123, 16, v123
v_lshlrev_b32 v125, 16, v125
v_lshlrev_b32 v127, 16, v127
v_sqrt_f32 v121, v121
v_sqrt_f32 v123, v123
v_sqrt_f32 v125, v125
v_sqrt_f32 v127, v127
v_cvt_pk_bf16_f32 v121, v121, v121
v_cvt_pk_bf16_f32 v123, v123, v123
v_cvt_pk_bf16_f32 v125, v125, v125
v_cvt_pk_bf16_f32 v127, v127, v127
v_lshlrev_b32 v121, 16, v121
v_lshlrev_b32 v123, 16, v123
v_lshlrev_b32 v125, 16, v125
v_lshlrev_b32 v127, 16, v127
v_lshlrev_b32 v120, 16, v152
v_lshlrev_b32 v122, 16, v153
v_lshlrev_b32 v124, 16, v154
v_lshlrev_b32 v126, 16, v155
v_lshlrev_b32 v140, 16, v128
v_and_b32 v141, 0xffff0000, v128
v_lshlrev_b32 v142, 16, v129
v_and_b32 v143, 0xffff0000, v129
v_lshlrev_b32 v144, 16, v130
v_and_b32 v145, 0xffff0000, v130
v_lshlrev_b32 v146, 16, v131
v_and_b32 v147, 0xffff0000, v131
v_rcp_f32 v121, v121
v_rcp_f32 v123, v123
v_rcp_f32 v125, v125
v_rcp_f32 v127, v127
v_sub_f32 v140, v140, v120
v_sub_f32 v141, v141, v122
v_sub_f32 v142, v142, v124
v_sub_f32 v143, v143, v126
v_sub_f32 v144, v144, v120
v_sub_f32 v145, v145, v122
v_sub_f32 v146, v146, v124
v_sub_f32 v147, v147, v126
v_mul_f32 v140, v140, v121
v_mul_f32 v141, v141, v123
v_mul_f32 v142, v142, v125
v_mul_f32 v143, v143, v127
v_mul_f32 v144, v144, v121
v_mul_f32 v145, v145, v123
v_mul_f32 v146, v146, v125
v_mul_f32 v147, v147, v127
v_cvt_pk_bf16_f32 v140, v140, v141
v_cvt_pk_bf16_f32 v142, v142, v143
v_cvt_pk_bf16_f32 v144, v144, v145
v_cvt_pk_bf16_f32 v146, v146, v147
ds_write_b32 v8, v128 offset:51200
ds_write_b32 v8, v140 offset:38400
ds_write_b32 v8, v129 offset:52480
ds_write_b32 v8, v142 offset:39680
ds_write_b32 v8, v130 offset:56320
ds_write_b32 v8, v144 offset:46080
ds_write_b32 v8, v131 offset:57600
ds_write_b32 v8, v146 offset:47360
s_waitcnt lgkmcnt(0)
s_barrier
ds_read_b128 v[72:75], v7 offset:3760
ds_read_b64 v[76:77], v6 offset:3008
ds_read_b64 v[78:79], v6 offset:3016
ds_read_b128 v[80:83], v7 offset:3792
ds_read_b64 v[84:85], v6 offset:3040
ds_read_b64 v[86:87], v6 offset:3048
ds_read_b128 v[88:91], v7 offset:3680
ds_read_b64 v[92:93], v6 offset:2944
ds_read_b64 v[94:95], v6 offset:2952
ds_read_b128 v[96:99], v7 offset:3712
ds_read_b64 v[100:101], v6 offset:2976
ds_read_b64 v[102:103], v6 offset:2984
s_waitcnt lgkmcnt(9)
v_mfma_f32_32x32x16_bf16 v[56:71], v[76:79], v[72:75], v[56:71]
v_add_u32 v150, s84, v22
v_add_u32 v151, s85, v22
ds_read_b128 v[104:107], v7 offset:3600
ds_read_b64 v[108:109], v6 offset:2880
ds_read_b64 v[110:111], v6 offset:2888
s_waitcnt lgkmcnt(9)
v_mfma_f32_32x32x16_bf16 v[56:71], v[84:87], v[80:83], v[56:71]
ds_read_b64 v[140:141], v11 offset:2560
ds_read_b64 v[144:145], v33 offset:2560
ds_read_b128 v[72:75], v7 offset:3632
ds_read_b64 v[76:77], v6 offset:2912
ds_read_b64 v[78:79], v6 offset:2920
s_waitcnt lgkmcnt(11)
v_mfma_f32_32x32x16_bf16 v[56:71], v[92:95], v[88:91], v[56:71]
ds_read_b64 v[142:143], v11 offset:2576
ds_read_b64 v[146:147], v33 offset:2576
ds_read_b128 v[80:83], v7 offset:3520
ds_read_b64 v[84:85], v6 offset:2816
ds_read_b64 v[86:87], v6 offset:2824
s_waitcnt lgkmcnt(13)
v_mfma_f32_32x32x16_bf16 v[56:71], v[100:103], v[96:99], v[56:71]
ds_read_b128 v[88:91], v7 offset:3552
ds_read_b64 v[92:93], v6 offset:2848
ds_read_b64 v[94:95], v6 offset:2856
s_waitcnt lgkmcnt(13)
v_mfma_f32_32x32x16_bf16 v[56:71], v[108:111], v[104:107], v[56:71]
ds_read_b128 v[96:99], v7 offset:3440
ds_read_b64 v[100:101], v6 offset:2752
ds_read_b64 v[102:103], v6 offset:2760
s_waitcnt lgkmcnt(11)
v_mfma_f32_32x32x16_bf16 v[56:71], v[76:79], v[72:75], v[56:71]
s_waitcnt lgkmcnt(9)
v_lshlrev_b32 v132, 16, v144
v_and_b32 v133, 0xffff0000, v144
ds_read_b128 v[104:107], v7 offset:3472
ds_read_b64 v[108:109], v6 offset:2784
ds_read_b64 v[110:111], v6 offset:2792
s_waitcnt lgkmcnt(9)
v_mfma_f32_32x32x16_bf16 v[56:71], v[84:87], v[80:83], v[56:71]
v_lshlrev_b32 v134, 16, v145
v_and_b32 v135, 0xffff0000, v145
ds_read_b128 v[72:75], v7 offset:3360
ds_read_b64 v[76:77], v6 offset:2688
ds_read_b64 v[78:79], v6 offset:2696
s_waitcnt lgkmcnt(9)
v_mfma_f32_32x32x16_bf16 v[56:71], v[92:95], v[88:91], v[56:71]
v_lshlrev_b32 v136, 16, v146
v_and_b32 v137, 0xffff0000, v146
ds_read_b128 v[80:83], v7 offset:3392
ds_read_b64 v[84:85], v6 offset:2720
ds_read_b64 v[86:87], v6 offset:2728
s_waitcnt lgkmcnt(9)
v_mfma_f32_32x32x16_bf16 v[56:71], v[100:103], v[96:99], v[56:71]
s_add_u32 s64, s56, 32768
buffer_load_dword v34, v2, s[8:11], s64 offen sc1
v_lshlrev_b32 v138, 16, v147
v_and_b32 v139, 0xffff0000, v147
ds_read_b128 v[88:91], v7 offset:3280
ds_read_b64 v[92:93], v6 offset:2624
ds_read_b64 v[94:95], v6 offset:2632
s_waitcnt lgkmcnt(9)
v_mfma_f32_32x32x16_bf16 v[56:71], v[108:111], v[104:107], v[56:71]
v_lshlrev_b32 v144, 16, v140
v_lshlrev_b32 v145, 16, v141
ds_read_b128 v[96:99], v7 offset:3312
ds_read_b64 v[100:101], v6 offset:2656
ds_read_b64 v[102:103], v6 offset:2664
s_waitcnt lgkmcnt(9)
v_mfma_f32_32x32x16_bf16 v[56:71], v[76:79], v[72:75], v[56:71]
v_lshlrev_b32 v146, 16, v142
v_lshlrev_b32 v147, 16, v143
ds_read_b128 v[104:107], v7 offset:3200
ds_read_b64 v[108:109], v6 offset:2560
ds_read_b64 v[110:111], v6 offset:2568
s_waitcnt lgkmcnt(9)
v_mfma_f32_32x32x16_bf16 v[56:71], v[84:87], v[80:83], v[56:71]
v_and_b32 v140, 0xffff0000, v140
v_and_b32 v141, 0xffff0000, v141
ds_read_b128 v[72:75], v7 offset:3232
ds_read_b64 v[76:77], v6 offset:2592
ds_read_b64 v[78:79], v6 offset:2600
s_waitcnt lgkmcnt(9)
v_mfma_f32_32x32x16_bf16 v[56:71], v[92:95], v[88:91], v[56:71]
v_and_b32 v142, 0xffff0000, v142
v_and_b32 v143, 0xffff0000, v143
ds_read_b128 v[80:83], v7 offset:3120
ds_read_b64 v[84:85], v6 offset:2496
ds_read_b64 v[86:87], v6 offset:2504
s_waitcnt lgkmcnt(9)
v_mfma_f32_32x32x16_bf16 v[56:71], v[100:103], v[96:99], v[56:71]
v_fmac_f32 v132, v144, v5
v_fmac_f32 v133, v140, v5
ds_read_b128 v[88:91], v7 offset:3152
ds_read_b64 v[92:93], v6 offset:2528
ds_read_b64 v[94:95], v6 offset:2536
s_waitcnt lgkmcnt(9)
v_mfma_f32_32x32x16_bf16 v[56:71], v[108:111], v[104:107], v[56:71]
v_fmac_f32 v134, v145, v5
v_fmac_f32 v135, v141, v5
ds_read_b128 v[96:99], v7 offset:3040
ds_read_b64 v[100:101], v6 offset:2432
ds_read_b64 v[102:103], v6 offset:2440
s_waitcnt lgkmcnt(9)
v_mfma_f32_32x32x16_bf16 v[56:71], v[76:79], v[72:75], v[56:71]
v_fmac_f32 v136, v146, v5
v_fmac_f32 v137, v142, v5
ds_read_b128 v[104:107], v7 offset:3072
ds_read_b64 v[108:109], v6 offset:2464
ds_read_b64 v[110:111], v6 offset:2472
s_waitcnt lgkmcnt(9)
v_mfma_f32_32x32x16_bf16 v[56:71], v[84:87], v[80:83], v[56:71]
s_waitcnt vmcnt(0)
v_cmp_gt_u32 vcc, s57, v34
s_cbranch_vccz Lsd_1053
s_mov_b32 s80, 0
Lsq_1054:
buffer_load_dword v34, v2, s[8:11], s64 offen sc1
s_add_u32 s80, s80, 1
s_cmp_lt_u32 s80, 0x8000
s_cbranch_scc0 Lsd_1053
s_waitcnt vmcnt(0)
v_cmp_gt_u32 vcc, s57, v34
s_nop 1
s_cbranch_vccnz Lsq_1054
Lsd_1053:
s_barrier
s_add_u32 m0, s29, 0
s_add_u32 s59, s33, 8388608
buffer_load_dwordx4 v21, s[8:11], s59 offen sc1 lds
v_fmac_f32 v138, v147, v5
v_fmac_f32 v139, v143, v5
ds_read_b128 v[72:75], v7 offset:2960
ds_read_b64 v[76:77], v6 offset:2368
ds_read_b64 v[78:79], v6 offset:2376
s_waitcnt lgkmcnt(9)
v_mfma_f32_32x32x16_bf16 v[56:71], v[92:95], v[88:91], v[56:71]
s_add_u32 m0, s29, 4096
s_add_u32 s59, s33, 8454144
ds_read_b128 v[80:83], v7 offset:2992
ds_read_b64 v[84:85], v6 offset:2400
ds_read_b64 v[86:87], v6 offset:2408
s_waitcnt lgkmcnt(9)
v_mfma_f32_32x32x16_bf16 v[56:71], v[100:103], v[96:99], v[56:71]
buffer_load_dwordx4 v21, s[8:11], s59 offen sc1 lds
ds_read_b128 v[88:91], v7 offset:2880
ds_read_b64 v[92:93], v6 offset:2304
ds_read_b64 v[94:95], v6 offset:2312
s_waitcnt lgkmcnt(9)
v_mfma_f32_32x32x16_bf16 v[56:71], v[108:111], v[104:107], v[56:71]
s_add_u32 m0, s29, 8192
s_add_u32 s59, s33, 8519680
ds_read_b128 v[96:99], v7 offset:2912
ds_read_b64 v[100:101], v6 offset:2336
ds_read_b64 v[102:103], v6 offset:2344
s_waitcnt lgkmcnt(9)
v_mfma_f32_32x32x16_bf16 v[56:71], v[76:79], v[72:75], v[56:71]
buffer_load_dwordx4 v21, s[8:11], s59 offen sc1 lds
ds_read_b128 v[104:107], v7 offset:2800
ds_read_b64 v[108:109], v6 offset:2240
ds_read_b64 v[110:111], v6 offset:2248
s_waitcnt lgkmcnt(9)
v_mfma_f32_32x32x16_bf16 v[56:71], v[84:87], v[80:83], v[56:71]
s_add_u32 m0, s29, 12288
s_add_u32 s59, s33, 8585216
ds_read_b128 v[72:75], v7 offset:2832
ds_read_b64 v[76:77], v6 offset:2272
ds_read_b64 v[78:79], v6 offset:2280
s_waitcnt lgkmcnt(9)
v_mfma_f32_32x32x16_bf16 v[56:71], v[92:95], v[88:91], v[56:71]
buffer_load_dwordx4 v21, s[8:11], s59 offen sc1 lds
ds_read_b128 v[80:83], v7 offset:2720
ds_read_b64 v[84:85], v6 offset:2176
ds_read_b64 v[86:87], v6 offset:2184
s_waitcnt lgkmcnt(9)
v_mfma_f32_32x32x16_bf16 v[56:71], v[100:103], v[96:99], v[56:71]
s_add_u32 m0, s29, 16384
s_add_u32 s59, s33, 8650752
ds_read_b128 v[88:91], v7 offset:2752
ds_read_b64 v[92:93], v6 offset:2208
ds_read_b64 v[94:95], v6 offset:2216
s_waitcnt lgkmcnt(9)
v_mfma_f32_32x32x16_bf16 v[56:71], v[108:111], v[104:107], v[56:71]
buffer_load_dwordx4 v21, s[8:11], s59 offen sc1 lds
ds_read_b128 v[96:99], v7 offset:2640
ds_read_b64 v[100:101], v6 offset:2112
ds_read_b64 v[102:103], v6 offset:2120
s_waitcnt lgkmcnt(9)
v_mfma_f32_32x32x16_bf16 v[56:71], v[76:79], v[72:75], v[56:71]
s_add_u32 m0, s29, 20480
s_add_u32 s59, s33, 8716288
ds_read_b128 v[104:107], v7 offset:2672
ds_read_b64 v[108:109], v6 offset:2144
ds_read_b64 v[110:111], v6 offset:2152
s_waitcnt lgkmcnt(9)
v_mfma_f32_32x32x16_bf16 v[56:71], v[84:87], v[80:83], v[56:71]
buffer_load_dwordx4 v21, s[8:11], s59 offen sc1 lds
ds_read_b128 v[72:75], v7 offset:2560
ds_read_b64 v[76:77], v6 offset:2048
ds_read_b64 v[78:79], v6 offset:2056
s_waitcnt lgkmcnt(9)
v_mfma_f32_32x32x16_bf16 v[56:71], v[92:95], v[88:91], v[56:71]
s_add_u32 m0, s29, 24576
s_add_u32 s59, s33, 8781824
ds_read_b128 v[80:83], v7 offset:2592
ds_read_b64 v[84:85], v6 offset:2080
ds_read_b64 v[86:87], v6 offset:2088
s_waitcnt lgkmcnt(9)
v_mfma_f32_32x32x16_bf16 v[56:71], v[100:103], v[96:99], v[56:71]
buffer_load_dwordx4 v21, s[8:11], s59 offen sc1 lds
s_waitcnt lgkmcnt(6)
v_mfma_f32_32x32x16_bf16 v[56:71], v[108:111], v[104:107], v[56:71]
s_add_u32 m0, s29, 28672
s_add_u32 s59, s33, 8847360
s_waitcnt lgkmcnt(3)
v_mfma_f32_32x32x16_bf16 v[56:71], v[76:79], v[72:75], v[56:71]
buffer_load_dwordx4 v21, s[8:11], s59 offen sc1 lds
s_waitcnt lgkmcnt(0)
v_mfma_f32_32x32x16_bf16 v[56:71], v[84:87], v[80:83], v[56:71]
s_nop 11
ds_write_b128 v150, v[64:67]
ds_write_b128 v150, v[68:71] offset:1024
v_add_f32 v132, v132, v56
v_add_f32 v133, v133, v57
v_add_f32 v134, v134, v58
v_add_f32 v135, v135, v59
v_add_f32 v136, v136, v60
v_add_f32 v137, v137, v61
v_add_f32 v138, v138, v62
v_add_f32 v139, v139, v63
s_add_u32 s67, s90, 8390656
s_waitcnt lgkmcnt(0)
s_barrier
ds_read_b128 v[112:115], v151
ds_read_b128 v[116:119], v151 offset:1024
s_waitcnt lgkmcnt(0)
v_add_f32 v132, v132, v112
v_add_f32 v133, v133, v113
v_add_f32 v134, v134, v114
v_add_f32 v135, v135, v115
v_add_f32 v136, v136, v116
v_add_f32 v137, v137, v117
v_add_f32 v138, v138, v118
v_add_f32 v139, v139, v119
v_cvt_pk_bf16_f32 v140, v132, v133
v_cvt_pk_bf16_f32 v141, v134, v135
v_cvt_pk_bf16_f32 v142, v136, v137
v_cvt_pk_bf16_f32 v143, v138, v139
ds_write_b64 v33, v[140:141] offset:2560
ds_write_b64 v33, v[142:143] offset:2576
s_waitcnt lgkmcnt(0)
s_barrier
ds_read_b128 v[112:115], v12 offset:2560
s_waitcnt lgkmcnt(0)
buffer_store_dwordx4 v[112:115], v22, s[8:11], s67 offen sc1
s_cmp_ge_u32 s41, 28
s_cbranch_scc1 Lsk_1055
s_add_u32 m0, s29, 32768
s_add_u32 s59, s33, 8912896
buffer_load_dwordx4 v21, s[8:11], s59 offen sc1 lds
s_add_u32 m0, s29, 36864
s_add_u32 s59, s33, 8978432
buffer_load_dwordx4 v21, s[8:11], s59 offen sc1 lds
Lsk_1055:
s_cmp_ge_u32 s41, 28
s_cbranch_scc1 Lst_1056
s_waitcnt vmcnt(7)
s_barrier
ds_read_b64_tr_b16 v[104:105], v13 offset:0
ds_read_b64_tr_b16 v[106:107], v13 offset:1024
ds_read_b64_tr_b16 v[108:109], v14 offset:0
ds_read_b64_tr_b16 v[110:111], v14 offset:1024
ds_read_b64_tr_b16 v[112:113], v15 offset:0
ds_read_b64_tr_b16 v[114:115], v15 offset:1024
ds_read_b64_tr_b16 v[116:117], v16 offset:0
ds_read_b64_tr_b16 v[118:119], v16 offset:1024
ds_read_b64_tr_b16 v[120:121], v13 offset:4096
ds_read_b64_tr_b16 v[122:123], v13 offset:5120
s_waitcnt lgkmcnt(8)
v_mfma_f32_32x32x16_bf16 v[40:55], a[0:3], v[104:107], 0
s_add_u32 m0, s29, 40960
s_add_u32 s59, s33, 9043968
ds_read_b64_tr_b16 v[124:125], v14 offset:4096
ds_read_b64_tr_b16 v[126:127], v14 offset:5120
s_waitcnt lgkmcnt(8)
v_mfma_f32_32x32x16_bf16 v[56:71], a[0:3], v[108:111], 0
buffer_load_dwordx4 v21, s[8:11], s59 offen sc1 lds
ds_read_b64_tr_b16 v[128:129], v15 offset:4096
ds_read_b64_tr_b16 v[130:131], v15 offset:5120
s_waitcnt lgkmcnt(8)
v_mfma_f32_32x32x16_bf16 v[72:87], a[0:3], v[112:115], 0
s_add_u32 m0, s29, 45056
s_add_u32 s59, s33, 9109504
ds_read_b64_tr_b16 v[132:133], v16 offset:4096
ds_read_b64_tr_b16 v[134:135], v16 offset:5120
s_waitcnt lgkmcnt(8)
v_mfma_f32_32x32x16_bf16 v[88:103], a[0:3], v[116:119], 0
buffer_load_dwordx4 v21, s[8:11], s59 offen sc1 lds
ds_read_b64_tr_b16 v[104:105], v13 offset:8192
ds_read_b64_tr_b16 v[106:107], v13 offset:9216
s_waitcnt lgkmcnt(8)
v_mfma_f32_32x32x16_bf16 v[40:55], a[4:7], v[120:123], v[40:55]
s_add_u32 m0, s29, 49152
s_add_u32 s59, s33, 9175040
ds_read_b64_tr_b16 v[108:109], v14 offset:8192
ds_read_b64_tr_b16 v[110:111], v14 offset:9216
s_waitcnt lgkmcnt(8)
v_mfma_f32_32x32x16_bf16 v[56:71], a[4:7], v[124:127], v[56:71]
buffer_load_dwordx4 v21, s[8:11], s59 offen sc1 lds
ds_read_b64_tr_b16 v[112:113], v15 offset:8192
ds_read_b64_tr_b16 v[114:115], v15 offset:9216
s_waitcnt lgkmcnt(8)
v_mfma_f32_32x32x16_bf16 v[72:87], a[4:7], v[128:131], v[72:87]
s_add_u32 m0, s29, 53248
s_add_u32 s59, s33, 9240576
ds_read_b64_tr_b16 v[116:117], v16 offset:8192
ds_read_b64_tr_b16 v[118:119], v16 offset:9216
s_waitcnt lgkmcnt(8)
v_mfma_f32_32x32x16_bf16 v[88:103], a[4:7], v[132:135], v[88:103]
buffer_load_dwordx4 v21, s[8:11], s59 offen sc1 lds
ds_read_b64_tr_b16 v[120:121], v13 offset:12288
ds_read_b64_tr_b16 v[122:123], v13 offset:13312
s_waitcnt lgkmcnt(8)
v_mfma_f32_32x32x16_bf16 v[40:55], a[8:11], v[104:107], v[40:55]
s_add_u32 m0, s29, 57344
s_add_u32 s59, s33, 9306112
ds_read_b64_tr_b16 v[124:125], v14 offset:12288
ds_read_b64_tr_b16 v[126:127], v14 offset:13312
s_waitcnt lgkmcnt(8)
v_mfma_f32_32x32x16_bf16 v[56:71], a[8:11], v[108:111], v[56:71]
buffer_load_dwordx4 v21, s[8:11], s59 offen sc1 lds
ds_read_b64_tr_b16 v[128:129], v15 offset:12288
ds_read_b64_tr_b16 v[130:131], v15 offset:13312
s_waitcnt lgkmcnt(8)
v_mfma_f32_32x32x16_bf16 v[72:87], a[8:11], v[112:115], v[72:87]
s_add_u32 m0, s29, 61440
s_add_u32 s59, s33, 9371648
ds_read_b64_tr_b16 v[132:133], v16 offset:12288
ds_read_b64_tr_b16 v[134:135], v16 offset:13312
s_waitcnt lgkmcnt(8)
v_mfma_f32_32x32x16_bf16 v[88:103], a[8:11], v[116:119], v[88:103]
buffer_load_dwordx4 v21, s[8:11], s59 offen sc1 lds
s_waitcnt vmcnt(9)
s_barrier
ds_read_b64_tr_b16 v[104:105], v13 offset:16384
ds_read_b64_tr_b16 v[106:107], v13 offset:17408
s_waitcnt lgkmcnt(8)
v_mfma_f32_32x32x16_bf16 v[40:55], a[12:15], v[120:123], v[40:55]
s_add_u32 m0, s29, 65536
s_add_u32 s59, s33, 9437184
ds_read_b64_tr_b16 v[108:109], v14 offset:16384
ds_read_b64_tr_b16 v[110:111], v14 offset:17408
s_waitcnt lgkmcnt(8)
v_mfma_f32_32x32x16_bf16 v[56:71], a[12:15], v[124:127], v[56:71]
buffer_load_dwordx4 v21, s[8:11], s59 offen sc1 lds
ds_read_b64_tr_b16 v[112:113], v15 offset:16384
ds_read_b64_tr_b16 v[114:115], v15 offset:17408
s_waitcnt lgkmcnt(8)
v_mfma_f32_32x32x16_bf16 v[72:87], a[12:15], v[128:131], v[72:87]
s_add_u32 m0, s29, 69632
s_add_u32 s59, s33, 9502720
ds_read_b64_tr_b16 v[116:117], v16 offset:16384
ds_read_b64_tr_b16 v[118:119], v16 offset:17408
s_waitcnt lgkmcnt(8)
v_mfma_f32_32x32x16_bf16 v[88:103], a[12:15], v[132:135], v[88:103]
buffer_load_dwordx4 v21, s[8:11], s59 offen sc1 lds
ds_read_b64_tr_b16 v[120:121], v13 offset:20480
ds_read_b64_tr_b16 v[122:123], v13 offset:21504
s_waitcnt lgkmcnt(8)
v_mfma_f32_32x32x16_bf16 v[40:55], a[16:19], v[104:107], v[40:55]
s_waitcnt vmcnt(10)
s_barrier
s_add_u32 s63, s56, 49152
s_mov_b64 exec, 255
buffer_atomic_add v35, v3, s[8:11], s63 offen sc1
s_mov_b64 exec, -1
s_add_u32 m0, s29, 73728
s_add_u32 s59, s33, 9568256
ds_read_b64_tr_b16 v[124:125], v14 offset:20480
ds_read_b64_tr_b16 v[126:127], v14 offset:21504
s_waitcnt lgkmcnt(8)
v_mfma_f32_32x32x16_bf16 v[56:71], a[16:19], v[108:111], v[56:71]
buffer_load_dwordx4 v21, s[8:11], s59 offen sc1 lds
ds_read_b64_tr_b16 v[128:129], v15 offset:20480
ds_read_b64_tr_b16 v[130:131], v15 offset:21504
s_waitcnt lgkmcnt(8)
v_mfma_f32_32x32x16_bf16 v[72:87], a[16:19], v[112:115], v[72:87]
s_add_u32 m0, s29, 77824
s_add_u32 s59, s33, 9633792
ds_read_b64_tr_b16 v[132:133], v16 offset:20480
ds_read_b64_tr_b16 v[134:135], v16 offset:21504
s_waitcnt lgkmcnt(8)
v_mfma_f32_32x32x16_bf16 v[88:103], a[16:19], v[116:119], v[88:103]
buffer_load_dwordx4 v21, s[8:11], s59 offen sc1 lds
ds_read_b64_tr_b16 v[104:105], v13 offset:24576
ds_read_b64_tr_b16 v[106:107], v13 offset:25600
s_waitcnt lgkmcnt(8)
v_mfma_f32_32x32x16_bf16 v[40:55], a[20:23], v[120:123], v[40:55]
s_add_u32 m0, s29, 81920
s_add_u32 s59, s33, 9699328
ds_read_b64_tr_b16 v[108:109], v14 offset:24576
ds_read_b64_tr_b16 v[110:111], v14 offset:25600
s_waitcnt lgkmcnt(8)
v_mfma_f32_32x32x16_bf16 v[56:71], a[20:23], v[124:127], v[56:71]
buffer_load_dwordx4 v21, s[8:11], s59 offen sc1 lds
ds_read_b64_tr_b16 v[112:113], v15 offset:24576
ds_read_b64_tr_b16 v[114:115], v15 offset:25600
s_waitcnt lgkmcnt(8)
v_mfma_f32_32x32x16_bf16 v[72:87], a[20:23], v[128:131], v[72:87]
s_add_u32 m0, s29, 86016
s_add_u32 s59, s33, 9764864
ds_read_b64_tr_b16 v[116:117], v16 offset:24576
ds_read_b64_tr_b16 v[118:119], v16 offset:25600
s_waitcnt lgkmcnt(8)
v_mfma_f32_32x32x16_bf16 v[88:103], a[20:23], v[132:135], v[88:103]
buffer_load_dwordx4 v21, s[8:11], s59 offen sc1 lds
ds_read_b64_tr_b16 v[120:121], v13 offset:28672
ds_read_b64_tr_b16 v[122:123], v13 offset:29696
s_waitcnt lgkmcnt(8)
v_mfma_f32_32x32x16_bf16 v[40:55], a[24:27], v[104:107], v[40:55]
s_add_u32 m0, s29, 90112
s_add_u32 s59, s33, 9830400
ds_read_b64_tr_b16 v[124:125], v14 offset:28672
ds_read_b64_tr_b16 v[126:127], v14 offset:29696
s_waitcnt lgkmcnt(8)
v_mfma_f32_32x32x16_bf16 v[56:71], a[24:27], v[108:111], v[56:71]
buffer_load_dwordx4 v21, s[8:11], s59 offen sc1 lds
ds_read_b64_tr_b16 v[128:129], v15 offset:28672
ds_read_b64_tr_b16 v[130:131], v15 offset:29696
s_waitcnt lgkmcnt(8)
v_mfma_f32_32x32x16_bf16 v[72:87], a[24:27], v[112:115], v[72:87]
s_add_u32 m0, s29, 94208
s_add_u32 s59, s33, 9895936
ds_read_b64_tr_b16 v[132:133], v16 offset:28672
ds_read_b64_tr_b16 v[134:135], v16 offset:29696
s_waitcnt lgkmcnt(8)
v_mfma_f32_32x32x16_bf16 v[88:103], a[24:27], v[116:119], v[88:103]
buffer_load_dwordx4 v21, s[8:11], s59 offen sc1 lds
s_waitcnt vmcnt(13)
s_barrier
ds_read_b64_tr_b16 v[104:105], v13 offset:32768
ds_read_b64_tr_b16 v[106:107], v13 offset:33792
s_waitcnt lgkmcnt(8)
v_mfma_f32_32x32x16_bf16 v[40:55], a[28:31], v[120:123], v[40:55]
s_add_u32 m0, s29, 0
s_add_u32 s59, s33, 9961472
ds_read_b64_tr_b16 v[108:109], v14 offset:32768
ds_read_b64_tr_b16 v[110:111], v14 offset:33792
s_waitcnt lgkmcnt(8)
v_mfma_f32_32x32x16_bf16 v[56:71], a[28:31], v[124:127], v[56:71]
buffer_load_dwordx4 v21, s[8:11], s59 offen sc1 lds
ds_read_b64_tr_b16 v[112:113], v15 offset:32768
ds_read_b64_tr_b16 v[114:115], v15 offset:33792
s_waitcnt lgkmcnt(8)
v_mfma_f32_32x32x16_bf16 v[72:87], a[28:31], v[128:131], v[72:87]
ds_read_b64_tr_b16 v[116:117], v16 offset:32768
ds_read_b64_tr_b16 v[118:119], v16 offset:33792
s_waitcnt lgkmcnt(8)
v_mfma_f32_32x32x16_bf16 v[88:103], a[28:31], v[132:135], v[88:103]
ds_read_b64_tr_b16 v[120:121], v13 offset:36864
ds_read_b64_tr_b16 v[122:123], v13 offset:37888
s_waitcnt lgkmcnt(8)
v_mfma_f32_32x32x16_bf16 v[40:55], a[32:35], v[104:107], v[40:55]
s_add_u32 m0, s29, 4096
s_add_u32 s59, s33, 10027008
ds_read_b64_tr_b16 v[124:125], v14 offset:36864
ds_read_b64_tr_b16 v[126:127], v14 offset:37888
s_waitcnt lgkmcnt(8)
v_mfma_f32_32x32x16_bf16 v[56:71], a[32:35], v[108:111], v[56:71]
buffer_load_dwordx4 v21, s[8:11], s59 offen sc1 lds
ds_read_b64_tr_b16 v[128:129], v15 offset:36864
ds_read_b64_tr_b16 v[130:131], v15 offset:37888
s_waitcnt lgkmcnt(8)
v_mfma_f32_32x32x16_bf16 v[72:87], a[32:35], v[112:115], v[72:87]
ds_read_b64_tr_b16 v[132:133], v16 offset:36864
ds_read_b64_tr_b16 v[134:135], v16 offset:37888
s_waitcnt lgkmcnt(8)
v_mfma_f32_32x32x16_bf16 v[88:103], a[32:35], v[116:119], v[88:103]
ds_read_b64_tr_b16 v[104:105], v13 offset:40960
ds_read_b64_tr_b16 v[106:107], v13 offset:41984
s_waitcnt lgkmcnt(8)
v_mfma_f32_32x32x16_bf16 v[40:55], a[36:39], v[120:123], v[40:55]
s_add_u32 m0, s29, 8192
s_add_u32 s59, s33, 10092544
ds_read_b64_tr_b16 v[108:109], v14 offset:40960
ds_read_b64_tr_b16 v[110:111], v14 offset:41984
s_waitcnt lgkmcnt(8)
v_mfma_f32_32x32x16_bf16 v[56:71], a[36:39], v[124:127], v[56:71]
buffer_load_dwordx4 v21, s[8:11], s59 offen sc1 lds
ds_read_b64_tr_b16 v[112:113], v15 offset:40960
ds_read_b64_tr_b16 v[114:115], v15 offset:41984
s_waitcnt lgkmcnt(8)
v_mfma_f32_32x32x16_bf16 v[72:87], a[36:39], v[128:131], v[72:87]
ds_read_b64_tr_b16 v[116:117], v16 offset:40960
ds_read_b64_tr_b16 v[118:119], v16 offset:41984
s_waitcnt lgkmcnt(8)
v_mfma_f32_32x32x16_bf16 v[88:103], a[36:39], v[132:135], v[88:103]
ds_read_b64_tr_b16 v[120:121], v13 offset:45056
ds_read_b64_tr_b16 v[122:123], v13 offset:46080
s_waitcnt lgkmcnt(8)
v_mfma_f32_32x32x16_bf16 v[40:55], a[40:43], v[104:107], v[40:55]
s_add_u32 m0, s29, 12288
s_add_u32 s59, s33, 10158080
ds_read_b64_tr_b16 v[124:125], v14 offset:45056
ds_read_b64_tr_b16 v[126:127], v14 offset:46080
s_waitcnt lgkmcnt(8)
v_mfma_f32_32x32x16_bf16 v[56:71], a[40:43], v[108:111], v[56:71]
buffer_load_dwordx4 v21, s[8:11], s59 offen sc1 lds
ds_read_b64_tr_b16 v[128:129], v15 offset:45056
ds_read_b64_tr_b16 v[130:131], v15 offset:46080
s_waitcnt lgkmcnt(8)
v_mfma_f32_32x32x16_bf16 v[72:87], a[40:43], v[112:115], v[72:87]
ds_read_b64_tr_b16 v[132:133], v16 offset:45056
ds_read_b64_tr_b16 v[134:135], v16 offset:46080
s_waitcnt lgkmcnt(8)
v_mfma_f32_32x32x16_bf16 v[88:103], a[40:43], v[116:119], v[88:103]
s_waitcnt vmcnt(13)
s_barrier
ds_read_b64_tr_b16 v[104:105], v17 offset:0
ds_read_b64_tr_b16 v[106:107], v17 offset:1024
s_waitcnt lgkmcnt(8)
v_mfma_f32_32x32x16_bf16 v[40:55], a[44:47], v[120:123], v[40:55]
s_add_u32 m0, s29, 16384
s_add_u32 s59, s33, 10223616
ds_read_b64_tr_b16 v[108:109], v18 offset:0
ds_read_b64_tr_b16 v[110:111], v18 offset:1024
s_waitcnt lgkmcnt(8)
v_mfma_f32_32x32x16_bf16 v[56:71], a[44:47], v[124:127], v[56:71]
buffer_load_dwordx4 v21, s[8:11], s59 offen sc1 lds
ds_read_b64_tr_b16 v[112:113], v19 offset:0
ds_read_b64_tr_b16 v[114:115], v19 offset:1024
s_waitcnt lgkmcnt(8)
v_mfma_f32_32x32x16_bf16 v[72:87], a[44:47], v[128:131], v[72:87]
ds_read_b64_tr_b16 v[116:117], v20 offset:0
ds_read_b64_tr_b16 v[118:119], v20 offset:1024
s_waitcnt lgkmcnt(8)
v_mfma_f32_32x32x16_bf16 v[88:103], a[44:47], v[132:135], v[88:103]
ds_read_b64_tr_b16 v[120:121], v17 offset:4096
ds_read_b64_tr_b16 v[122:123], v17 offset:5120
s_waitcnt lgkmcnt(8)
v_mfma_f32_32x32x16_bf16 v[40:55], a[48:51], v[104:107], v[40:55]
s_add_u32 m0, s29, 20480
s_add_u32 s59, s33, 10289152
ds_read_b64_tr_b16 v[124:125], v18 offset:4096
ds_read_b64_tr_b16 v[126:127], v18 offset:5120
s_waitcnt lgkmcnt(8)
v_mfma_f32_32x32x16_bf16 v[56:71], a[48:51], v[108:111], v[56:71]
buffer_load_dwordx4 v21, s[8:11], s59 offen sc1 lds
ds_read_b64_tr_b16 v[128:129], v19 offset:4096
ds_read_b64_tr_b16 v[130:131], v19 offset:5120
s_waitcnt lgkmcnt(8)
v_mfma_f32_32x32x16_bf16 v[72:87], a[48:51], v[112:115], v[72:87]
ds_read_b64_tr_b16 v[132:133], v20 offset:4096
ds_read_b64_tr_b16 v[134:135], v20 offset:5120
s_waitcnt lgkmcnt(8)
v_mfma_f32_32x32x16_bf16 v[88:103], a[48:51], v[116:119], v[88:103]
ds_read_b64_tr_b16 v[104:105], v17 offset:8192
ds_read_b64_tr_b16 v[106:107], v17 offset:9216
s_waitcnt lgkmcnt(8)
v_mfma_f32_32x32x16_bf16 v[40:55], a[52:55], v[120:123], v[40:55]
s_add_u32 m0, s29, 24576
s_add_u32 s59, s33, 10354688
ds_read_b64_tr_b16 v[108:109], v18 offset:8192
ds_read_b64_tr_b16 v[110:111], v18 offset:9216
s_waitcnt lgkmcnt(8)
v_mfma_f32_32x32x16_bf16 v[56:71], a[52:55], v[124:127], v[56:71]
buffer_load_dwordx4 v21, s[8:11], s59 offen sc1 lds
ds_read_b64_tr_b16 v[112:113], v19 offset:8192
ds_read_b64_tr_b16 v[114:115], v19 offset:9216
s_waitcnt lgkmcnt(8)
v_mfma_f32_32x32x16_bf16 v[72:87], a[52:55], v[128:131], v[72:87]
ds_read_b64_tr_b16 v[116:117], v20 offset:8192
ds_read_b64_tr_b16 v[118:119], v20 offset:9216
s_waitcnt lgkmcnt(8)
v_mfma_f32_32x32x16_bf16 v[88:103], a[52:55], v[132:135], v[88:103]
ds_read_b64_tr_b16 v[120:121], v17 offset:12288
ds_read_b64_tr_b16 v[122:123], v17 offset:13312
s_waitcnt lgkmcnt(8)
v_mfma_f32_32x32x16_bf16 v[40:55], a[56:59], v[104:107], v[40:55]
s_add_u32 m0, s29, 28672
s_add_u32 s59, s33, 10420224
ds_read_b64_tr_b16 v[124:125], v18 offset:12288
ds_read_b64_tr_b16 v[126:127], v18 offset:13312
s_waitcnt lgkmcnt(8)
v_mfma_f32_32x32x16_bf16 v[56:71], a[56:59], v[108:111], v[56:71]
buffer_load_dwordx4 v21, s[8:11], s59 offen sc1 lds
ds_read_b64_tr_b16 v[128:129], v19 offset:12288
ds_read_b64_tr_b16 v[130:131], v19 offset:13312
s_waitcnt lgkmcnt(8)
v_mfma_f32_32x32x16_bf16 v[72:87], a[56:59], v[112:115], v[72:87]
ds_read_b64_tr_b16 v[132:133], v20 offset:12288
ds_read_b64_tr_b16 v[134:135], v20 offset:13312
s_waitcnt lgkmcnt(8)
v_mfma_f32_32x32x16_bf16 v[88:103], a[56:59], v[116:119], v[88:103]
s_waitcnt vmcnt(12)
s_barrier
ds_read_b64_tr_b16 v[104:105], v17 offset:16384
ds_read_b64_tr_b16 v[106:107], v17 offset:17408
s_waitcnt lgkmcnt(8)
v_mfma_f32_32x32x16_bf16 v[40:55], a[60:63], v[120:123], v[40:55]
ds_read_b64_tr_b16 v[108:109], v18 offset:16384
ds_read_b64_tr_b16 v[110:111], v18 offset:17408
s_waitcnt lgkmcnt(8)
v_mfma_f32_32x32x16_bf16 v[56:71], a[60:63], v[124:127], v[56:71]
ds_read_b64_tr_b16 v[112:113], v19 offset:16384
ds_read_b64_tr_b16 v[114:115], v19 offset:17408
s_waitcnt lgkmcnt(8)
v_mfma_f32_32x32x16_bf16 v[72:87], a[60:63], v[128:131], v[72:87]
ds_read_b64_tr_b16 v[116:117], v20 offset:16384
ds_read_b64_tr_b16 v[118:119], v20 offset:17408
s_waitcnt lgkmcnt(8)
v_mfma_f32_32x32x16_bf16 v[88:103], a[60:63], v[132:135], v[88:103]
ds_read_b64_tr_b16 v[120:121], v17 offset:20480
ds_read_b64_tr_b16 v[122:123], v17 offset:21504
s_waitcnt lgkmcnt(8)
v_mfma_f32_32x32x16_bf16 v[40:55], a[64:67], v[104:107], v[40:55]
ds_read_b64_tr_b16 v[124:125], v18 offset:20480
ds_read_b64_tr_b16 v[126:127], v18 offset:21504
s_waitcnt lgkmcnt(8)
v_mfma_f32_32x32x16_bf16 v[56:71], a[64:67], v[108:111], v[56:71]
ds_read_b64_tr_b16 v[128:129], v19 offset:20480
ds_read_b64_tr_b16 v[130:131], v19 offset:21504
s_waitcnt lgkmcnt(8)
v_mfma_f32_32x32x16_bf16 v[72:87], a[64:67], v[112:115], v[72:87]
ds_read_b64_tr_b16 v[132:133], v20 offset:20480
ds_read_b64_tr_b16 v[134:135], v20 offset:21504
s_waitcnt lgkmcnt(8)
v_mfma_f32_32x32x16_bf16 v[88:103], a[64:67], v[116:119], v[88:103]
ds_read_b64_tr_b16 v[104:105], v17 offset:24576
ds_read_b64_tr_b16 v[106:107], v17 offset:25600
s_waitcnt lgkmcnt(8)
v_mfma_f32_32x32x16_bf16 v[40:55], a[68:71], v[120:123], v[40:55]
ds_read_b64_tr_b16 v[108:109], v18 offset:24576
ds_read_b64_tr_b16 v[110:111], v18 offset:25600
s_waitcnt lgkmcnt(8)
v_mfma_f32_32x32x16_bf16 v[56:71], a[68:71], v[124:127], v[56:71]
ds_read_b64_tr_b16 v[112:113], v19 offset:24576
ds_read_b64_tr_b16 v[114:115], v19 offset:25600
s_waitcnt lgkmcnt(8)
v_mfma_f32_32x32x16_bf16 v[72:87], a[68:71], v[128:131], v[72:87]
ds_read_b64_tr_b16 v[116:117], v20 offset:24576
ds_read_b64_tr_b16 v[118:119], v20 offset:25600
s_waitcnt lgkmcnt(8)
v_mfma_f32_32x32x16_bf16 v[88:103], a[68:71], v[132:135], v[88:103]
ds_read_b64_tr_b16 v[120:121], v17 offset:28672
ds_read_b64_tr_b16 v[122:123], v17 offset:29696
s_waitcnt lgkmcnt(8)
v_mfma_f32_32x32x16_bf16 v[40:55], a[72:75], v[104:107], v[40:55]
ds_read_b64_tr_b16 v[124:125], v18 offset:28672
ds_read_b64_tr_b16 v[126:127], v18 offset:29696
s_waitcnt lgkmcnt(8)
v_mfma_f32_32x32x16_bf16 v[56:71], a[72:75], v[108:111], v[56:71]
ds_read_b64_tr_b16 v[128:129], v19 offset:28672
ds_read_b64_tr_b16 v[130:131], v19 offset:29696
s_waitcnt lgkmcnt(8)
v_mfma_f32_32x32x16_bf16 v[72:87], a[72:75], v[112:115], v[72:87]
s_add_u32 s66, s39, 147456
ds_read_b64_tr_b16 v[132:133], v20 offset:28672
ds_read_b64_tr_b16 v[134:135], v20 offset:29696
s_waitcnt lgkmcnt(8)
v_mfma_f32_32x32x16_bf16 v[88:103], a[72:75], v[116:119], v[88:103]
buffer_load_dwordx2 v[136:137], v23, s[8:11], s66 offen offset:0 sc1
s_waitcnt vmcnt(9)
s_barrier
ds_read_b64_tr_b16 v[104:105], v17 offset:32768
ds_read_b64_tr_b16 v[106:107], v17 offset:33792
s_waitcnt lgkmcnt(8)
v_mfma_f32_32x32x16_bf16 v[40:55], a[76:79], v[120:123], v[40:55]
s_add_u32 s64, s56, 49152
buffer_load_dword v34, v2, s[8:11], s64 offen sc1
ds_read_b64_tr_b16 v[108:109], v18 offset:32768
ds_read_b64_tr_b16 v[110:111], v18 offset:33792
s_waitcnt lgkmcnt(8)
v_mfma_f32_32x32x16_bf16 v[56:71], a[76:79], v[124:127], v[56:71]
ds_read_b64_tr_b16 v[112:113], v19 offset:32768
ds_read_b64_tr_b16 v[114:115], v19 offset:33792
s_waitcnt lgkmcnt(8)
v_mfma_f32_32x32x16_bf16 v[72:87], a[76:79], v[128:131], v[72:87]
ds_read_b64_tr_b16 v[116:117], v20 offset:32768
ds_read_b64_tr_b16 v[118:119], v20 offset:33792
s_waitcnt lgkmcnt(8)
v_mfma_f32_32x32x16_bf16 v[88:103], a[76:79], v[132:135], v[88:103]
buffer_load_dwordx2 v[138:139], v23, s[8:11], s66 offen offset:256 sc1
ds_read_b64_tr_b16 v[120:121], v17 offset:36864
ds_read_b64_tr_b16 v[122:123], v17 offset:37888
s_waitcnt lgkmcnt(8)
v_mfma_f32_32x32x16_bf16 v[40:55], a[80:83], v[104:107], v[40:55]
ds_read_b64_tr_b16 v[124:125], v18 offset:36864
ds_read_b64_tr_b16 v[126:127], v18 offset:37888
s_waitcnt lgkmcnt(8)
v_mfma_f32_32x32x16_bf16 v[56:71], a[80:83], v[108:111], v[56:71]
ds_read_b64_tr_b16 v[128:129], v19 offset:36864
ds_read_b64_tr_b16 v[130:131], v19 offset:37888
s_waitcnt lgkmcnt(8)
v_mfma_f32_32x32x16_bf16 v[72:87], a[80:83], v[112:115], v[72:87]
ds_read_b64_tr_b16 v[132:133], v20 offset:36864
ds_read_b64_tr_b16 v[134:135], v20 offset:37888
s_waitcnt lgkmcnt(8)
v_mfma_f32_32x32x16_bf16 v[88:103], a[80:83], v[116:119], v[88:103]
buffer_load_dwordx2 v[140:141], v23, s[8:11], s66 offen offset:512 sc1
ds_read_b64_tr_b16 v[104:105], v17 offset:40960
ds_read_b64_tr_b16 v[106:107], v17 offset:41984
s_waitcnt lgkmcnt(8)
v_mfma_f32_32x32x16_bf16 v[40:55], a[84:87], v[120:123], v[40:55]
ds_read_b64_tr_b16 v[108:109], v18 offset:40960
ds_read_b64_tr_b16 v[110:111], v18 offset:41984
s_waitcnt lgkmcnt(8)
v_mfma_f32_32x32x16_bf16 v[56:71], a[84:87], v[124:127], v[56:71]
ds_read_b64_tr_b16 v[112:113], v19 offset:40960
ds_read_b64_tr_b16 v[114:115], v19 offset:41984
s_waitcnt lgkmcnt(8)
v_mfma_f32_32x32x16_bf16 v[72:87], a[84:87], v[128:131], v[72:87]
ds_read_b64_tr_b16 v[116:117], v20 offset:40960
ds_read_b64_tr_b16 v[118:119], v20 offset:41984
s_waitcnt lgkmcnt(8)
v_mfma_f32_32x32x16_bf16 v[88:103], a[84:87], v[132:135], v[88:103]
buffer_load_dwordx2 v[142:143], v23, s[8:11], s66 offen offset:768 sc1
ds_read_b64_tr_b16 v[120:121], v17 offset:45056
ds_read_b64_tr_b16 v[122:123], v17 offset:46080
s_waitcnt lgkmcnt(8)
v_mfma_f32_32x32x16_bf16 v[40:55], a[88:91], v[104:107], v[40:55]
ds_read_b64_tr_b16 v[124:125], v18 offset:45056
ds_read_b64_tr_b16 v[126:127], v18 offset:46080
s_waitcnt lgkmcnt(8)
v_mfma_f32_32x32x16_bf16 v[56:71], a[88:91], v[108:111], v[56:71]
ds_read_b64_tr_b16 v[128:129], v19 offset:45056
ds_read_b64_tr_b16 v[130:131], v19 offset:46080
s_waitcnt lgkmcnt(8)
v_mfma_f32_32x32x16_bf16 v[72:87], a[88:91], v[112:115], v[72:87]
ds_read_b64_tr_b16 v[132:133], v20 offset:45056
ds_read_b64_tr_b16 v[134:135], v20 offset:46080
s_waitcnt lgkmcnt(8)
v_mfma_f32_32x32x16_bf16 v[88:103], a[88:91], v[116:119], v[88:103]
s_waitcnt vmcnt(9)
s_waitcnt vmcnt(3)
v_cmp_gt_u32 vcc, s57, v34
s_cbranch_vccz Lsd_1059
s_mov_b32 s80, 0
Lsq_1060:
buffer_load_dword v34, v2, s[8:11], s64 offen sc1
s_add_u32 s80, s80, 1
s_cmp_lt_u32 s80, 0x8000
s_cbranch_scc0 Lsd_1059
s_waitcnt vmcnt(0)
v_cmp_gt_u32 vcc, s57, v34
s_nop 1
s_cbranch_vccnz Lsq_1060
Lsd_1059:
s_barrier
ds_read_b64_tr_b16 v[104:105], v13 offset:0
ds_read_b64_tr_b16 v[106:107], v13 offset:1024
s_waitcnt lgkmcnt(8)
v_mfma_f32_32x32x16_bf16 v[40:55], a[92:95], v[120:123], v[40:55]
s_add_u32 m0, s29, 32768
s_add_u32 s59, s33, 8390656
ds_read_b64_tr_b16 v[108:109], v14 offset:0
ds_read_b64_tr_b16 v[110:111], v14 offset:1024
s_waitcnt lgkmcnt(8)
v_mfma_f32_32x32x16_bf16 v[56:71], a[92:95], v[124:127], v[56:71]
buffer_load_dwordx4 v21, s[8:11], s59 offen sc1 lds
ds_read_b64_tr_b16 v[112:113], v15 offset:0
ds_read_b64_tr_b16 v[114:115], v15 offset:1024
s_waitcnt lgkmcnt(8)
v_mfma_f32_32x32x16_bf16 v[72:87], a[92:95], v[128:131], v[72:87]
s_add_u32 m0, s29, 36864
s_add_u32 s59, s33, 8456192
ds_read_b64_tr_b16 v[116:117], v16 offset:0
ds_read_b64_tr_b16 v[118:119], v16 offset:1024
s_waitcnt lgkmcnt(8)
v_mfma_f32_32x32x16_bf16 v[88:103], a[92:95], v[132:135], v[88:103]
buffer_load_dwordx4 v21, s[8:11], s59 offen sc1 lds
ds_read_b64_tr_b16 v[120:121], v13 offset:4096
ds_read_b64_tr_b16 v[122:123], v13 offset:5120
s_waitcnt lgkmcnt(8)
v_mfma_f32_32x32x16_bf16 v[40:55], a[96:99], v[104:107], v[40:55]
s_add_u32 m0, s29, 40960
s_add_u32 s59, s33, 8521728
ds_read_b64_tr_b16 v[124:125], v14 offset:4096
ds_read_b64_tr_b16 v[126:127], v14 offset:5120
s_waitcnt lgkmcnt(8)
v_mfma_f32_32x32x16_bf16 v[56:71], a[96:99], v[108:111], v[56:71]
buffer_load_dwordx4 v21, s[8:11], s59 offen sc1 lds
ds_read_b64_tr_b16 v[128:129], v15 offset:4096
ds_read_b64_tr_b16 v[130:131], v15 offset:5120
s_waitcnt lgkmcnt(8)
v_mfma_f32_32x32x16_bf16 v[72:87], a[96:99], v[112:115], v[72:87]
s_add_u32 m0, s29, 45056
s_add_u32 s59, s33, 8587264
ds_read_b64_tr_b16 v[132:133], v16 offset:4096
ds_read_b64_tr_b16 v[134:135], v16 offset:5120
s_waitcnt lgkmcnt(8)
v_mfma_f32_32x32x16_bf16 v[88:103], a[96:99], v[116:119], v[88:103]
buffer_load_dwordx4 v21, s[8:11], s59 offen sc1 lds
ds_read_b64_tr_b16 v[104:105], v13 offset:8192
ds_read_b64_tr_b16 v[106:107], v13 offset:9216
s_waitcnt lgkmcnt(8)
v_mfma_f32_32x32x16_bf16 v[40:55], a[100:103], v[120:123], v[40:55]
s_add_u32 m0, s29, 49152
s_add_u32 s59, s33, 8652800
s_waitcnt vmcnt(4)
s_mov_b32 s62, 0x03020302
v_and_b32 v152, v136, v138
v_and_b32 v153, v140, v142
ds_read_b64_tr_b16 v[108:109], v14 offset:8192
ds_read_b64_tr_b16 v[110:111], v14 offset:9216
s_waitcnt lgkmcnt(8)
v_mfma_f32_32x32x16_bf16 v[56:71], a[100:103], v[124:127], v[56:71]
buffer_load_dwordx4 v21, s[8:11], s59 offen sc1 lds
v_and_b32 v152, v152, v153
v_and_b32 v152, 1, v152
v_cmp_eq_u32 vcc, 0, v152
ds_read_b64_tr_b16 v[112:113], v15 offset:8192
ds_read_b64_tr_b16 v[114:115], v15 offset:9216
s_waitcnt lgkmcnt(8)
v_mfma_f32_32x32x16_bf16 v[72:87], a[100:103], v[128:131], v[72:87]
s_add_u32 m0, s29, 53248
s_add_u32 s59, s33, 8718336
s_cbranch_vccnz Llg_1061
Llgd_1062:
v_perm_b32 v144, v136, v136, s62
ds_read_b64_tr_b16 v[116:117], v16 offset:8192
ds_read_b64_tr_b16 v[118:119], v16 offset:9216
s_waitcnt lgkmcnt(8)
v_mfma_f32_32x32x16_bf16 v[88:103], a[100:103], v[132:135], v[88:103]
buffer_load_dwordx4 v21, s[8:11], s59 offen sc1 lds
v_perm_b32 v145, v136, v136, s62
v_perm_b32 v146, v138, v138, s62
v_perm_b32 v147, v138, v138, s62
ds_read_b64_tr_b16 v[120:121], v13 offset:12288
ds_read_b64_tr_b16 v[122:123], v13 offset:13312
s_waitcnt lgkmcnt(8)
v_mfma_f32_32x32x16_bf16 v[40:55], a[104:107], v[104:107], v[40:55]
s_add_u32 m0, s29, 57344
s_add_u32 s59, s33, 8783872
v_perm_b32 v148, v140, v140, s62
v_perm_b32 v149, v140, v140, s62
v_perm_b32 v150, v142, v142, s62
ds_read_b64_tr_b16 v[124:125], v14 offset:12288
ds_read_b64_tr_b16 v[126:127], v14 offset:13312
s_waitcnt lgkmcnt(8)
v_mfma_f32_32x32x16_bf16 v[56:71], a[104:107], v[108:111], v[56:71]
buffer_load_dwordx4 v21, s[8:11], s59 offen sc1 lds
v_perm_b32 v151, v142, v142, s62
v_mov_b32 v152, 0
v_mov_b32 v153, 0
ds_read_b64_tr_b16 v[128:129], v15 offset:12288
ds_read_b64_tr_b16 v[130:131], v15 offset:13312
s_waitcnt lgkmcnt(8)
v_mfma_f32_32x32x16_bf16 v[72:87], a[104:107], v[112:115], v[72:87]
s_add_u32 m0, s29, 61440
s_add_u32 s59, s33, 8849408
ds_read_b64_tr_b16 v[132:133], v16 offset:12288
ds_read_b64_tr_b16 v[134:135], v16 offset:13312
s_waitcnt lgkmcnt(8)
v_mfma_f32_32x32x16_bf16 v[88:103], a[104:107], v[116:119], v[88:103]
buffer_load_dwordx4 v21, s[8:11], s59 offen sc1 lds
s_barrier
ds_read_b64_tr_b16 v[104:105], v13 offset:16384
ds_read_b64_tr_b16 v[106:107], v13 offset:17408
s_waitcnt lgkmcnt(8)
v_mfma_f32_32x32x16_bf16 v[40:55], a[108:111], v[120:123], v[40:55]
s_add_u32 m0, s29, 65536
s_add_u32 s59, s33, 8914944
ds_read_b64_tr_b16 v[108:109], v13 offset:20480
ds_read_b64_tr_b16 v[110:111], v13 offset:21504
s_waitcnt lgkmcnt(8)
v_mfma_f32_32x32x16_bf16 v[56:71], a[108:111], v[124:127], v[56:71]
buffer_load_dwordx4 v21, s[8:11], s59 offen sc1 lds
ds_read_b64_tr_b16 v[112:113], v13 offset:24576
ds_read_b64_tr_b16 v[114:115], v13 offset:25600
s_waitcnt lgkmcnt(8)
v_mfma_f32_32x32x16_bf16 v[72:87], a[108:111], v[128:131], v[72:87]
s_add_u32 m0, s29, 69632
s_add_u32 s59, s33, 8980480
ds_read_b64_tr_b16 v[116:117], v13 offset:28672
ds_read_b64_tr_b16 v[118:119], v13 offset:29696
s_waitcnt lgkmcnt(8)
v_mfma_f32_32x32x16_bf16 v[88:103], a[108:111], v[132:135], v[88:103]
buffer_load_dwordx4 v21, s[8:11], s59 offen sc1 lds
v_mfma_f32_32x32x16_bf16 v[40:55], v[156:159], v[144:147], v[40:55]
s_add_u32 m0, s29, 73728
s_add_u32 s59, s33, 9046016
v_mfma_f32_32x32x16_bf16 v[56:71], v[156:159], v[146:149], v[56:71]
buffer_load_dwordx4 v21, s[8:11], s59 offen sc1 lds
v_mfma_f32_32x32x16_bf16 v[72:87], v[156:159], v[148:151], v[72:87]
s_add_u32 m0, s29, 77824
s_add_u32 s59, s33, 9111552
v_mfma_f32_32x32x16_bf16 v[88:103], v[156:159], v[150:153], v[88:103]
buffer_load_dwordx4 v21, s[8:11], s59 offen sc1 lds
ds_read_b64_tr_b16 v[120:121], v14 offset:16384
ds_read_b64_tr_b16 v[122:123], v14 offset:17408
s_waitcnt lgkmcnt(8)
v_mfma_f32_32x32x16_bf16 v[40:55], a[112:115], v[104:107], v[40:55]
s_add_u32 m0, s29, 81920
s_add_u32 s59, s33, 9177088
ds_read_b64_tr_b16 v[124:125], v14 offset:20480
ds_read_b64_tr_b16 v[126:127], v14 offset:21504
s_waitcnt lgkmcnt(8)
v_mfma_f32_32x32x16_bf16 v[40:55], a[116:119], v[108:111], v[40:55]
buffer_load_dwordx4 v21, s[8:11], s59 offen sc1 lds
ds_read_b64_tr_b16 v[128:129], v14 offset:24576
ds_read_b64_tr_b16 v[130:131], v14 offset:25600
s_waitcnt lgkmcnt(8)
v_mfma_f32_32x32x16_bf16 v[40:55], a[120:123], v[112:115], v[40:55]
s_add_u32 m0, s29, 86016
s_add_u32 s59, s33, 9242624
ds_read_b64_tr_b16 v[132:133], v14 offset:28672
ds_read_b64_tr_b16 v[134:135], v14 offset:29696
s_waitcnt lgkmcnt(8)
v_mfma_f32_32x32x16_bf16 v[40:55], a[124:127], v[116:119], v[40:55]
buffer_load_dwordx4 v21, s[8:11], s59 offen sc1 lds
ds_read_b64_tr_b16 v[104:105], v15 offset:16384
ds_read_b64_tr_b16 v[106:107], v15 offset:17408
s_waitcnt lgkmcnt(8)
v_mfma_f32_32x32x16_bf16 v[56:71], a[112:115], v[120:123], v[56:71]
s_add_u32 m0, s29, 90112
s_add_u32 s59, s33, 9308160
ds_read_b64_tr_b16 v[108:109], v15 offset:20480
ds_read_b64_tr_b16 v[110:111], v15 offset:21504
s_waitcnt lgkmcnt(8)
v_mfma_f32_32x32x16_bf16 v[56:71], a[116:119], v[124:127], v[56:71]
buffer_load_dwordx4 v21, s[8:11], s59 offen sc1 lds
v_max_f32 v40, 0, v40
v_max_f32 v41, 0, v41
v_max_f32 v42, 0, v42
ds_read_b64_tr_b16 v[112:113], v15 offset:24576
ds_read_b64_tr_b16 v[114:115], v15 offset:25600
s_waitcnt lgkmcnt(8)
v_mfma_f32_32x32x16_bf16 v[56:71], a[120:123], v[128:131], v[56:71]
s_add_u32 m0, s29, 94208
s_add_u32 s59, s33, 9373696
v_max_f32 v43, 0, v43
v_max_f32 v44, 0, v44
v_max_f32 v45, 0, v45
ds_read_b64_tr_b16 v[116:117], v15 offset:28672
ds_read_b64_tr_b16 v[118:119], v15 offset:29696
s_waitcnt lgkmcnt(8)
v_mfma_f32_32x32x16_bf16 v[56:71], a[124:127], v[132:135], v[56:71]
buffer_load_dwordx4 v21, s[8:11], s59 offen sc1 lds
v_max_f32 v46, 0, v46
v_max_f32 v47, 0, v47
v_mul_f32 v40, v40, v48
ds_read_b64_tr_b16 v[120:121], v16 offset:16384
ds_read_b64_tr_b16 v[122:123], v16 offset:17408
s_waitcnt lgkmcnt(8)
v_mfma_f32_32x32x16_bf16 v[72:87], a[112:115], v[104:107], v[72:87]
s_add_u32 m0, s29, 0
s_add_u32 s59, s33, 9439232
v_mul_f32 v41, v41, v49
v_mul_f32 v42, v42, v50
v_mul_f32 v43, v43, v51
ds_read_b64_tr_b16 v[124:125], v16 offset:20480
ds_read_b64_tr_b16 v[126:127], v16 offset:21504
s_waitcnt lgkmcnt(8)
v_mfma_f32_32x32x16_bf16 v[72:87], a[116:119], v[108:111], v[72:87]
buffer_load_dwordx4 v21, s[8:11], s59 offen sc1 lds
v_mul_f32 v44, v44, v52
v_mul_f32 v45, v45, v53
v_mul_f32 v46, v46, v54
ds_read_b64_tr_b16 v[128:129], v16 offset:24576
ds_read_b64_tr_b16 v[130:131], v16 offset:25600
s_waitcnt lgkmcnt(8)
v_mfma_f32_32x32x16_bf16 v[72:87], a[120:123], v[112:115], v[72:87]
v_mul_f32 v47, v47, v55
v_cvt_pk_bf16_f32 v48, v40, v41
v_cvt_pk_bf16_f32 v49, v42, v43
ds_read_b64_tr_b16 v[132:133], v16 offset:28672
ds_read_b64_tr_b16 v[134:135], v16 offset:29696
s_waitcnt lgkmcnt(8)
v_mfma_f32_32x32x16_bf16 v[72:87], a[124:127], v[116:119], v[72:87]
v_cvt_pk_bf16_f32 v50, v44, v45
v_cvt_pk_bf16_f32 v51, v46, v47
s_add_u32 s67, s34, 25165824
s_waitcnt vmcnt(13)
s_barrier
ds_read_b64_tr_b16 v[104:105], v13 offset:32768
ds_read_b64_tr_b16 v[106:107], v13 offset:33792
s_waitcnt lgkmcnt(8)
v_mfma_f32_32x32x16_bf16 v[88:103], a[112:115], v[120:123], v[88:103]
s_add_u32 m0, s29, 4096
s_add_u32 s59, s33, 9504768
buffer_store_dwordx4 v[48:51], v22, s[8:11], s67 offen sc1
ds_read_b64_tr_b16 v[108:109], v13 offset:36864
ds_read_b64_tr_b16 v[110:111], v13 offset:37888
s_waitcnt lgkmcnt(8)
v_mfma_f32_32x32x16_bf16 v[88:103], a[116:119], v[124:127], v[88:103]
buffer_load_dwordx4 v21, s[8:11], s59 offen sc1 lds
ds_read_b64_tr_b16 v[112:113], v13 offset:40960
ds_read_b64_tr_b16 v[114:115], v13 offset:41984
s_waitcnt lgkmcnt(8)
v_mfma_f32_32x32x16_bf16 v[88:103], a[120:123], v[128:131], v[88:103]
v_max_f32 v56, 0, v56
v_max_f32 v57, 0, v57
v_max_f32 v58, 0, v58
ds_read_b64_tr_b16 v[116:117], v13 offset:45056
ds_read_b64_tr_b16 v[118:119], v13 offset:46080
s_waitcnt lgkmcnt(8)
v_mfma_f32_32x32x16_bf16 v[88:103], a[124:127], v[132:135], v[88:103]
v_max_f32 v59, 0, v59
v_max_f32 v60, 0, v60
v_max_f32 v61, 0, v61
ds_read_b64_tr_b16 v[120:121], v14 offset:32768
ds_read_b64_tr_b16 v[122:123], v14 offset:33792
s_waitcnt lgkmcnt(8)
v_mfma_f32_32x32x16_bf16 v[40:55], a[0:3], v[104:107], 0
s_add_u32 m0, s29, 8192
s_add_u32 s59, s33, 9570304
v_max_f32 v62, 0, v62
v_max_f32 v63, 0, v63
v_mul_f32 v56, v56, v64
ds_read_b64_tr_b16 v[124:125], v14 offset:36864
ds_read_b64_tr_b16 v[126:127], v14 offset:37888
s_waitcnt lgkmcnt(8)
v_mfma_f32_32x32x16_bf16 v[40:55], a[4:7], v[108:111], v[40:55]
buffer_load_dwordx4 v21, s[8:11], s59 offen sc1 lds
v_mul_f32 v57, v57, v65
v_mul_f32 v58, v58, v66
v_mul_f32 v59, v59, v67
ds_read_b64_tr_b16 v[128:129], v14 offset:40960
ds_read_b64_tr_b16 v[130:131], v14 offset:41984
s_waitcnt lgkmcnt(8)
v_mfma_f32_32x32x16_bf16 v[40:55], a[8:11], v[112:115], v[40:55]
s_add_u32 m0, s29, 12288
s_add_u32 s59, s33, 9635840
v_mul_f32 v60, v60, v68
v_mul_f32 v61, v61, v69
v_mul_f32 v62, v62, v70
ds_read_b64_tr_b16 v[132:133], v14 offset:45056
ds_read_b64_tr_b16 v[134:135], v14 offset:46080
s_waitcnt lgkmcnt(8)
v_mfma_f32_32x32x16_bf16 v[40:55], a[12:15], v[116:119], v[40:55]
buffer_load_dwordx4 v21, s[8:11], s59 offen sc1 lds
v_mul_f32 v63, v63, v71
v_cvt_pk_bf16_f32 v64, v56, v57
v_cvt_pk_bf16_f32 v65, v58, v59
ds_read_b64_tr_b16 v[104:105], v15 offset:32768
ds_read_b64_tr_b16 v[106:107], v15 offset:33792
s_waitcnt lgkmcnt(8)
v_cvt_pk_bf16_f32 v66, v60, v61
v_cvt_pk_bf16_f32 v67, v62, v63
s_add_u32 s67, s34, 25280512
buffer_store_dwordx4 v[64:67], v22, s[8:11], s67 offen sc1
s_nop 1
v_mfma_f32_32x32x16_bf16 v[56:71], a[0:3], v[120:123], 0
ds_read_b64_tr_b16 v[108:109], v15 offset:36864
ds_read_b64_tr_b16 v[110:111], v15 offset:37888
s_waitcnt lgkmcnt(8)
v_mfma_f32_32x32x16_bf16 v[56:71], a[4:7], v[124:127], v[56:71]
ds_read_b64_tr_b16 v[112:113], v15 offset:40960
ds_read_b64_tr_b16 v[114:115], v15 offset:41984
s_waitcnt lgkmcnt(8)
v_mfma_f32_32x32x16_bf16 v[56:71], a[8:11], v[128:131], v[56:71]
v_max_f32 v72, 0, v72
v_max_f32 v73, 0, v73
v_max_f32 v74, 0, v74
ds_read_b64_tr_b16 v[116:117], v15 offset:45056
ds_read_b64_tr_b16 v[118:119], v15 offset:46080
s_waitcnt lgkmcnt(8)
v_mfma_f32_32x32x16_bf16 v[56:71], a[12:15], v[132:135], v[56:71]
v_max_f32 v75, 0, v75
v_max_f32 v76, 0, v76
v_max_f32 v77, 0, v77
ds_read_b64_tr_b16 v[120:121], v16 offset:32768
ds_read_b64_tr_b16 v[122:123], v16 offset:33792
s_waitcnt lgkmcnt(8)
v_max_f32 v78, 0, v78
v_max_f32 v79, 0, v79
v_mul_f32 v72, v72, v80
v_mul_f32 v73, v73, v81
v_mul_f32 v74, v74, v82
v_mul_f32 v75, v75, v83
v_mul_f32 v76, v76, v84
v_mul_f32 v77, v77, v85
v_mul_f32 v78, v78, v86
v_mul_f32 v79, v79, v87
v_cvt_pk_bf16_f32 v80, v72, v73
v_cvt_pk_bf16_f32 v81, v74, v75
v_cvt_pk_bf16_f32 v82, v76, v77
v_cvt_pk_bf16_f32 v83, v78, v79
s_add_u32 s67, s34, 25395200
buffer_store_dwordx4 v[80:83], v22, s[8:11], s67 offen sc1
s_nop 1
v_mfma_f32_32x32x16_bf16 v[72:87], a[0:3], v[104:107], 0
ds_read_b64_tr_b16 v[124:125], v16 offset:36864
ds_read_b64_tr_b16 v[126:127], v16 offset:37888
s_waitcnt lgkmcnt(8)
v_mfma_f32_32x32x16_bf16 v[72:87], a[4:7], v[108:111], v[72:87]
ds_read_b64_tr_b16 v[128:129], v16 offset:40960
ds_read_b64_tr_b16 v[130:131], v16 offset:41984
s_waitcnt lgkmcnt(8)
v_mfma_f32_32x32x16_bf16 v[72:87], a[8:11], v[112:115], v[72:87]
v_max_f32 v88, 0, v88
v_max_f32 v89, 0, v89
v_max_f32 v90, 0, v90
ds_read_b64_tr_b16 v[132:133], v16 offset:45056
ds_read_b64_tr_b16 v[134:135], v16 offset:46080
s_waitcnt lgkmcnt(8)
v_mfma_f32_32x32x16_bf16 v[72:87], a[12:15], v[116:119], v[72:87]
v_max_f32 v91, 0, v91
v_max_f32 v92, 0, v92
v_max_f32 v93, 0, v93
s_waitcnt vmcnt(15)
s_barrier
ds_read_b64_tr_b16 v[104:105], v17 offset:0
ds_read_b64_tr_b16 v[106:107], v17 offset:1024
s_waitcnt lgkmcnt(8)
v_max_f32 v94, 0, v94
v_max_f32 v95, 0, v95
v_mul_f32 v88, v88, v96
v_mul_f32 v89, v89, v97
v_mul_f32 v90, v90, v98
v_mul_f32 v91, v91, v99
v_mul_f32 v92, v92, v100
v_mul_f32 v93, v93, v101
v_mul_f32 v94, v94, v102
v_mul_f32 v95, v95, v103
v_cvt_pk_bf16_f32 v96, v88, v89
v_cvt_pk_bf16_f32 v97, v90, v91
v_cvt_pk_bf16_f32 v98, v92, v93
v_cvt_pk_bf16_f32 v99, v94, v95
s_add_u32 s67, s34, 25509888
buffer_store_dwordx4 v[96:99], v22, s[8:11], s67 offen sc1
s_nop 1
v_mfma_f32_32x32x16_bf16 v[88:103], a[0:3], v[120:123], 0
s_add_u32 m0, s29, 16384
s_add_u32 s59, s33, 9701376
ds_read_b64_tr_b16 v[108:109], v18 offset:0
ds_read_b64_tr_b16 v[110:111], v18 offset:1024
s_waitcnt lgkmcnt(8)
v_mfma_f32_32x32x16_bf16 v[88:103], a[4:7], v[124:127], v[88:103]
buffer_load_dwordx4 v21, s[8:11], s59 offen sc1 lds
ds_read_b64_tr_b16 v[112:113], v19 offset:0
ds_read_b64_tr_b16 v[114:115], v19 offset:1024
s_waitcnt lgkmcnt(8)
v_mfma_f32_32x32x16_bf16 v[88:103], a[8:11], v[128:131], v[88:103]
ds_read_b64_tr_b16 v[116:117], v20 offset:0
ds_read_b64_tr_b16 v[118:119], v20 offset:1024
s_waitcnt lgkmcnt(8)
v_mfma_f32_32x32x16_bf16 v[88:103], a[12:15], v[132:135], v[88:103]
ds_read_b64_tr_b16 v[120:121], v17 offset:4096
ds_read_b64_tr_b16 v[122:123], v17 offset:5120
s_waitcnt lgkmcnt(8)
v_mfma_f32_32x32x16_bf16 v[40:55], a[16:19], v[104:107], v[40:55]
s_add_u32 m0, s29, 20480
s_add_u32 s59, s33, 9766912
ds_read_b64_tr_b16 v[124:125], v18 offset:4096
ds_read_b64_tr_b16 v[126:127], v18 offset:5120
s_waitcnt lgkmcnt(8)
v_mfma_f32_32x32x16_bf16 v[56:71], a[16:19], v[108:111], v[56:71]
buffer_load_dwordx4 v21, s[8:11], s59 offen sc1 lds
ds_read_b64_tr_b16 v[128:129], v19 offset:4096
ds_read_b64_tr_b16 v[130:131], v19 offset:5120
s_waitcnt lgkmcnt(8)
v_mfma_f32_32x32x16_bf16 v[72:87], a[16:19], v[112:115], v[72:87]
ds_read_b64_tr_b16 v[132:133], v20 offset:4096
ds_read_b64_tr_b16 v[134:135], v20 offset:5120
s_waitcnt lgkmcnt(8)
v_mfma_f32_32x32x16_bf16 v[88:103], a[16:19], v[116:119], v[88:103]
ds_read_b64_tr_b16 v[104:105], v17 offset:8192
ds_read_b64_tr_b16 v[106:107], v17 offset:9216
s_waitcnt lgkmcnt(8)
v_mfma_f32_32x32x16_bf16 v[40:55], a[20:23], v[120:123], v[40:55]
s_add_u32 m0, s29, 24576
s_add_u32 s59, s33, 9832448
ds_read_b64_tr_b16 v[108:109], v18 offset:8192
ds_read_b64_tr_b16 v[110:111], v18 offset:9216
s_waitcnt lgkmcnt(8)
v_mfma_f32_32x32x16_bf16 v[56:71], a[20:23], v[124:127], v[56:71]
buffer_load_dwordx4 v21, s[8:11], s59 offen sc1 lds
ds_read_b64_tr_b16 v[112:113], v19 offset:8192
ds_read_b64_tr_b16 v[114:115], v19 offset:9216
s_waitcnt lgkmcnt(8)
v_mfma_f32_32x32x16_bf16 v[72:87], a[20:23], v[128:131], v[72:87]
ds_read_b64_tr_b16 v[116:117], v20 offset:8192
ds_read_b64_tr_b16 v[118:119], v20 offset:9216
s_waitcnt lgkmcnt(8)
v_mfma_f32_32x32x16_bf16 v[88:103], a[20:23], v[132:135], v[88:103]
ds_read_b64_tr_b16 v[120:121], v17 offset:12288
ds_read_b64_tr_b16 v[122:123], v17 offset:13312
s_waitcnt lgkmcnt(8)
v_mfma_f32_32x32x16_bf16 v[40:55], a[24:27], v[104:107], v[40:55]
s_add_u32 m0, s29, 28672
s_add_u32 s59, s33, 9897984
ds_read_b64_tr_b16 v[124:125], v18 offset:12288
ds_read_b64_tr_b16 v[126:127], v18 offset:13312
s_waitcnt lgkmcnt(8)
v_mfma_f32_32x32x16_bf16 v[56:71], a[24:27], v[108:111], v[56:71]
buffer_load_dwordx4 v21, s[8:11], s59 offen sc1 lds
ds_read_b64_tr_b16 v[128:129], v19 offset:12288
ds_read_b64_tr_b16 v[130:131], v19 offset:13312
s_waitcnt lgkmcnt(8)
v_mfma_f32_32x32x16_bf16 v[72:87], a[24:27], v[112:115], v[72:87]
ds_read_b64_tr_b16 v[132:133], v20 offset:12288
ds_read_b64_tr_b16 v[134:135], v20 offset:13312
s_waitcnt lgkmcnt(8)
v_mfma_f32_32x32x16_bf16 v[88:103], a[24:27], v[116:119], v[88:103]
s_waitcnt vmcnt(16)
s_barrier
ds_read_b64_tr_b16 v[104:105], v17 offset:16384
ds_read_b64_tr_b16 v[106:107], v17 offset:17408
s_waitcnt lgkmcnt(8)
v_mfma_f32_32x32x16_bf16 v[40:55], a[28:31], v[120:123], v[40:55]
s_add_u32 m0, s29, 32768
s_add_u32 s59, s33, 9963520
ds_read_b64_tr_b16 v[108:109], v18 offset:16384
ds_read_b64_tr_b16 v[110:111], v18 offset:17408
s_waitcnt lgkmcnt(8)
v_mfma_f32_32x32x16_bf16 v[56:71], a[28:31], v[124:127], v[56:71]
buffer_load_dwordx4 v21, s[8:11], s59 offen sc1 lds
ds_read_b64_tr_b16 v[112:113], v19 offset:16384
ds_read_b64_tr_b16 v[114:115], v19 offset:17408
s_waitcnt lgkmcnt(8)
v_mfma_f32_32x32x16_bf16 v[72:87], a[28:31], v[128:131], v[72:87]
ds_read_b64_tr_b16 v[116:117], v20 offset:16384
ds_read_b64_tr_b16 v[118:119], v20 offset:17408
s_waitcnt lgkmcnt(8)
v_mfma_f32_32x32x16_bf16 v[88:103], a[28:31], v[132:135], v[88:103]
ds_read_b64_tr_b16 v[120:121], v17 offset:20480
ds_read_b64_tr_b16 v[122:123], v17 offset:21504
s_waitcnt lgkmcnt(8)
v_mfma_f32_32x32x16_bf16 v[40:55], a[32:35], v[104:107], v[40:55]
s_add_u32 m0, s29, 36864
s_add_u32 s59, s33, 10029056
ds_read_b64_tr_b16 v[124:125], v18 offset:20480
ds_read_b64_tr_b16 v[126:127], v18 offset:21504
s_waitcnt lgkmcnt(8)
v_mfma_f32_32x32x16_bf16 v[56:71], a[32:35], v[108:111], v[56:71]
buffer_load_dwordx4 v21, s[8:11], s59 offen sc1 lds
ds_read_b64_tr_b16 v[128:129], v19 offset:20480
ds_read_b64_tr_b16 v[130:131], v19 offset:21504
s_waitcnt lgkmcnt(8)
v_mfma_f32_32x32x16_bf16 v[72:87], a[32:35], v[112:115], v[72:87]
ds_read_b64_tr_b16 v[132:133], v20 offset:20480
ds_read_b64_tr_b16 v[134:135], v20 offset:21504
s_waitcnt lgkmcnt(8)
v_mfma_f32_32x32x16_bf16 v[88:103], a[32:35], v[116:119], v[88:103]
ds_read_b64_tr_b16 v[104:105], v17 offset:24576
ds_read_b64_tr_b16 v[106:107], v17 offset:25600
s_waitcnt lgkmcnt(8)
v_mfma_f32_32x32x16_bf16 v[40:55], a[36:39], v[120:123], v[40:55]
s_add_u32 m0, s29, 40960
s_add_u32 s59, s33, 10094592
ds_read_b64_tr_b16 v[108:109], v18 offset:24576
ds_read_b64_tr_b16 v[110:111], v18 offset:25600
s_waitcnt lgkmcnt(8)
v_mfma_f32_32x32x16_bf16 v[56:71], a[36:39], v[124:127], v[56:71]
buffer_load_dwordx4 v21, s[8:11], s59 offen sc1 lds
ds_read_b64_tr_b16 v[112:113], v19 offset:24576
ds_read_b64_tr_b16 v[114:115], v19 offset:25600
s_waitcnt lgkmcnt(8)
v_mfma_f32_32x32x16_bf16 v[72:87], a[36:39], v[128:131], v[72:87]
ds_read_b64_tr_b16 v[116:117], v20 offset:24576
ds_read_b64_tr_b16 v[118:119], v20 offset:25600
s_waitcnt lgkmcnt(8)
v_mfma_f32_32x32x16_bf16 v[88:103], a[36:39], v[132:135], v[88:103]
ds_read_b64_tr_b16 v[120:121], v17 offset:28672
ds_read_b64_tr_b16 v[122:123], v17 offset:29696
s_waitcnt lgkmcnt(8)
v_mfma_f32_32x32x16_bf16 v[40:55], a[40:43], v[104:107], v[40:55]
s_add_u32 m0, s29, 45056
s_add_u32 s59, s33, 10160128
s_waitcnt vmcnt(7)
s_add_u32 s63, s31, 32768
v_mov_b32 v38, 0
s_mov_b64 exec, 1
buffer_atomic_add v35, v38, s[8:11], s63 offen sc1
s_mov_b64 exec, -1
ds_read_b64_tr_b16 v[124:125], v18 offset:28672
ds_read_b64_tr_b16 v[126:127], v18 offset:29696
s_waitcnt lgkmcnt(8)
v_mfma_f32_32x32x16_bf16 v[56:71], a[40:43], v[108:111], v[56:71]
buffer_load_dwordx4 v21, s[8:11], s59 offen sc1 lds
ds_read_b64_tr_b16 v[128:129], v19 offset:28672
ds_read_b64_tr_b16 v[130:131], v19 offset:29696
s_waitcnt lgkmcnt(8)
v_mfma_f32_32x32x16_bf16 v[72:87], a[40:43], v[112:115], v[72:87]
ds_read_b64_tr_b16 v[132:133], v20 offset:28672
ds_read_b64_tr_b16 v[134:135], v20 offset:29696
s_waitcnt lgkmcnt(8)
v_mfma_f32_32x32x16_bf16 v[88:103], a[40:43], v[116:119], v[88:103]
s_barrier
ds_read_b64_tr_b16 v[104:105], v17 offset:32768
ds_read_b64_tr_b16 v[106:107], v17 offset:33792
s_waitcnt lgkmcnt(8)
v_mfma_f32_32x32x16_bf16 v[40:55], a[44:47], v[120:123], v[40:55]
s_add_u32 m0, s29, 49152
s_add_u32 s59, s33, 10225664
ds_read_b64_tr_b16 v[108:109], v18 offset:32768
ds_read_b64_tr_b16 v[110:111], v18 offset:33792
s_waitcnt lgkmcnt(8)
v_mfma_f32_32x32x16_bf16 v[56:71], a[44:47], v[124:127], v[56:71]
buffer_load_dwordx4 v21, s[8:11], s59 offen sc1 lds
ds_read_b64_tr_b16 v[112:113], v19 offset:32768
ds_read_b64_tr_b16 v[114:115], v19 offset:33792
s_waitcnt lgkmcnt(8)
v_mfma_f32_32x32x16_bf16 v[72:87], a[44:47], v[128:131], v[72:87]
s_add_u32 s66, s39, 155648
ds_read_b64_tr_b16 v[116:117], v20 offset:32768
ds_read_b64_tr_b16 v[118:119], v20 offset:33792
s_waitcnt lgkmcnt(8)
v_mfma_f32_32x32x16_bf16 v[88:103], a[44:47], v[132:135], v[88:103]
buffer_load_dwordx2 v[136:137], v23, s[8:11], s66 offen offset:0 sc1
ds_read_b64_tr_b16 v[120:121], v17 offset:36864
ds_read_b64_tr_b16 v[122:123], v17 offset:37888
s_waitcnt lgkmcnt(8)
v_mfma_f32_32x32x16_bf16 v[40:55], a[48:51], v[104:107], v[40:55]
s_add_u32 m0, s29, 53248
s_add_u32 s59, s33, 10291200
ds_read_b64_tr_b16 v[124:125], v18 offset:36864
ds_read_b64_tr_b16 v[126:127], v18 offset:37888
s_waitcnt lgkmcnt(8)
v_mfma_f32_32x32x16_bf16 v[56:71], a[48:51], v[108:111], v[56:71]
buffer_load_dwordx4 v21, s[8:11], s59 offen sc1 lds
ds_read_b64_tr_b16 v[128:129], v19 offset:36864
ds_read_b64_tr_b16 v[130:131], v19 offset:37888
s_waitcnt lgkmcnt(8)
v_mfma_f32_32x32x16_bf16 v[72:87], a[48:51], v[112:115], v[72:87]
ds_read_b64_tr_b16 v[132:133], v20 offset:36864
ds_read_b64_tr_b16 v[134:135], v20 offset:37888
s_waitcnt lgkmcnt(8)
v_mfma_f32_32x32x16_bf16 v[88:103], a[48:51], v[116:119], v[88:103]
buffer_load_dwordx2 v[138:139], v23, s[8:11], s66 offen offset:256 sc1
ds_read_b64_tr_b16 v[104:105], v17 offset:40960
ds_read_b64_tr_b16 v[106:107], v17 offset:41984
s_waitcnt lgkmcnt(8)
v_mfma_f32_32x32x16_bf16 v[40:55], a[52:55], v[120:123], v[40:55]
s_add_u32 m0, s29, 57344
s_add_u32 s59, s33, 10356736
ds_read_b64_tr_b16 v[108:109], v18 offset:40960
ds_read_b64_tr_b16 v[110:111], v18 offset:41984
s_waitcnt lgkmcnt(8)
v_mfma_f32_32x32x16_bf16 v[56:71], a[52:55], v[124:127], v[56:71]
buffer_load_dwordx4 v21, s[8:11], s59 offen sc1 lds
ds_read_b64_tr_b16 v[112:113], v19 offset:40960
ds_read_b64_tr_b16 v[114:115], v19 offset:41984
s_waitcnt lgkmcnt(8)
v_mfma_f32_32x32x16_bf16 v[72:87], a[52:55], v[128:131], v[72:87]
ds_read_b64_tr_b16 v[116:117], v20 offset:40960
ds_read_b64_tr_b16 v[118:119], v20 offset:41984
s_waitcnt lgkmcnt(8)
v_mfma_f32_32x32x16_bf16 v[88:103], a[52:55], v[132:135], v[88:103]
buffer_load_dwordx2 v[140:141], v23, s[8:11], s66 offen offset:512 sc1
ds_read_b64_tr_b16 v[120:121], v17 offset:45056
ds_read_b64_tr_b16 v[122:123], v17 offset:46080
s_waitcnt lgkmcnt(8)
v_mfma_f32_32x32x16_bf16 v[40:55], a[56:59], v[104:107], v[40:55]
s_add_u32 m0, s29, 61440
s_add_u32 s59, s33, 10422272
ds_read_b64_tr_b16 v[124:125], v18 offset:45056
ds_read_b64_tr_b16 v[126:127], v18 offset:46080
s_waitcnt lgkmcnt(8)
v_mfma_f32_32x32x16_bf16 v[56:71], a[56:59], v[108:111], v[56:71]
buffer_load_dwordx4 v21, s[8:11], s59 offen sc1 lds
ds_read_b64_tr_b16 v[128:129], v19 offset:45056
ds_read_b64_tr_b16 v[130:131], v19 offset:46080
s_waitcnt lgkmcnt(8)
v_mfma_f32_32x32x16_bf16 v[72:87], a[56:59], v[112:115], v[72:87]
ds_read_b64_tr_b16 v[132:133], v20 offset:45056
ds_read_b64_tr_b16 v[134:135], v20 offset:46080
s_waitcnt lgkmcnt(8)
v_mfma_f32_32x32x16_bf16 v[88:103], a[56:59], v[116:119], v[88:103]
buffer_load_dwordx2 v[142:143], v23, s[8:11], s66 offen offset:768 sc1
s_barrier
ds_read_b64_tr_b16 v[104:105], v13 offset:0
ds_read_b64_tr_b16 v[106:107], v13 offset:1024
s_waitcnt lgkmcnt(8)
v_mfma_f32_32x32x16_bf16 v[40:55], a[60:63], v[120:123], v[40:55]
ds_read_b64_tr_b16 v[108:109], v14 offset:0
ds_read_b64_tr_b16 v[110:111], v14 offset:1024
s_waitcnt lgkmcnt(8)
v_mfma_f32_32x32x16_bf16 v[56:71], a[60:63], v[124:127], v[56:71]
ds_read_b64_tr_b16 v[112:113], v15 offset:0
ds_read_b64_tr_b16 v[114:115], v15 offset:1024
s_waitcnt lgkmcnt(8)
v_mfma_f32_32x32x16_bf16 v[72:87], a[60:63], v[128:131], v[72:87]
ds_read_b64_tr_b16 v[116:117], v16 offset:0
ds_read_b64_tr_b16 v[118:119], v16 offset:1024
s_waitcnt lgkmcnt(8)
v_mfma_f32_32x32x16_bf16 v[88:103], a[60:63], v[132:135], v[88:103]
ds_read_b64_tr_b16 v[120:121], v13 offset:4096
ds_read_b64_tr_b16 v[122:123], v13 offset:5120
s_waitcnt lgkmcnt(8)
v_mfma_f32_32x32x16_bf16 v[40:55], a[64:67], v[104:107], v[40:55]
ds_read_b64_tr_b16 v[124:125], v14 offset:4096
ds_read_b64_tr_b16 v[126:127], v14 offset:5120
s_waitcnt lgkmcnt(8)
v_mfma_f32_32x32x16_bf16 v[56:71], a[64:67], v[108:111], v[56:71]
ds_read_b64_tr_b16 v[128:129], v15 offset:4096
ds_read_b64_tr_b16 v[130:131], v15 offset:5120
s_waitcnt lgkmcnt(8)
v_mfma_f32_32x32x16_bf16 v[72:87], a[64:67], v[112:115], v[72:87]
ds_read_b64_tr_b16 v[132:133], v16 offset:4096
ds_read_b64_tr_b16 v[134:135], v16 offset:5120
s_waitcnt lgkmcnt(8)
v_mfma_f32_32x32x16_bf16 v[88:103], a[64:67], v[116:119], v[88:103]
ds_read_b64_tr_b16 v[104:105], v13 offset:8192
ds_read_b64_tr_b16 v[106:107], v13 offset:9216
s_waitcnt lgkmcnt(8)
v_mfma_f32_32x32x16_bf16 v[40:55], a[68:71], v[120:123], v[40:55]
ds_read_b64_tr_b16 v[108:109], v14 offset:8192
ds_read_b64_tr_b16 v[110:111], v14 offset:9216
s_waitcnt lgkmcnt(8)
v_mfma_f32_32x32x16_bf16 v[56:71], a[68:71], v[124:127], v[56:71]
ds_read_b64_tr_b16 v[112:113], v15 offset:8192
ds_read_b64_tr_b16 v[114:115], v15 offset:9216
s_waitcnt lgkmcnt(8)
v_mfma_f32_32x32x16_bf16 v[72:87], a[68:71], v[128:131], v[72:87]
ds_read_b64_tr_b16 v[116:117], v16 offset:8192
ds_read_b64_tr_b16 v[118:119], v16 offset:9216
s_waitcnt lgkmcnt(8)
v_mfma_f32_32x32x16_bf16 v[88:103], a[68:71], v[132:135], v[88:103]
ds_read_b64_tr_b16 v[120:121], v13 offset:12288
ds_read_b64_tr_b16 v[122:123], v13 offset:13312
s_waitcnt lgkmcnt(8)
v_mfma_f32_32x32x16_bf16 v[40:55], a[72:75], v[104:107], v[40:55]
ds_read_b64_tr_b16 v[124:125], v14 offset:12288
ds_read_b64_tr_b16 v[126:127], v14 offset:13312
s_waitcnt lgkmcnt(8)
v_mfma_f32_32x32x16_bf16 v[56:71], a[72:75], v[108:111], v[56:71]
ds_read_b64_tr_b16 v[128:129], v15 offset:12288
ds_read_b64_tr_b16 v[130:131], v15 offset:13312
s_waitcnt lgkmcnt(8)
v_mfma_f32_32x32x16_bf16 v[72:87], a[72:75], v[112:115], v[72:87]
ds_read_b64_tr_b16 v[132:133], v16 offset:12288
ds_read_b64_tr_b16 v[134:135], v16 offset:13312
s_waitcnt lgkmcnt(8)
v_mfma_f32_32x32x16_bf16 v[88:103], a[72:75], v[116:119], v[88:103]
s_waitcnt vmcnt(13)
s_barrier
ds_read_b64_tr_b16 v[104:105], v13 offset:16384
ds_read_b64_tr_b16 v[106:107], v13 offset:17408
s_waitcnt lgkmcnt(8)
v_mfma_f32_32x32x16_bf16 v[40:55], a[76:79], v[120:123], v[40:55]
ds_read_b64_tr_b16 v[108:109], v14 offset:16384
ds_read_b64_tr_b16 v[110:111], v14 offset:17408
s_waitcnt lgkmcnt(8)
v_mfma_f32_32x32x16_bf16 v[56:71], a[76:79], v[124:127], v[56:71]
ds_read_b64_tr_b16 v[112:113], v15 offset:16384
ds_read_b64_tr_b16 v[114:115], v15 offset:17408
s_waitcnt lgkmcnt(8)
v_mfma_f32_32x32x16_bf16 v[72:87], a[76:79], v[128:131], v[72:87]
ds_read_b64_tr_b16 v[116:117], v16 offset:16384
ds_read_b64_tr_b16 v[118:119], v16 offset:17408
s_waitcnt lgkmcnt(8)
v_mfma_f32_32x32x16_bf16 v[88:103], a[76:79], v[132:135], v[88:103]
ds_read_b64_tr_b16 v[120:121], v13 offset:20480
ds_read_b64_tr_b16 v[122:123], v13 offset:21504
s_waitcnt lgkmcnt(8)
v_mfma_f32_32x32x16_bf16 v[40:55], a[80:83], v[104:107], v[40:55]
ds_read_b64_tr_b16 v[124:125], v14 offset:20480
ds_read_b64_tr_b16 v[126:127], v14 offset:21504
s_waitcnt lgkmcnt(8)
v_mfma_f32_32x32x16_bf16 v[56:71], a[80:83], v[108:111], v[56:71]
ds_read_b64_tr_b16 v[128:129], v15 offset:20480
ds_read_b64_tr_b16 v[130:131], v15 offset:21504
s_waitcnt lgkmcnt(8)
v_mfma_f32_32x32x16_bf16 v[72:87], a[80:83], v[112:115], v[72:87]
ds_read_b64_tr_b16 v[132:133], v16 offset:20480
ds_read_b64_tr_b16 v[134:135], v16 offset:21504
s_waitcnt lgkmcnt(8)
v_mfma_f32_32x32x16_bf16 v[88:103], a[80:83], v[116:119], v[88:103]
ds_read_b64_tr_b16 v[104:105], v13 offset:24576
ds_read_b64_tr_b16 v[106:107], v13 offset:25600
s_waitcnt lgkmcnt(8)
v_mfma_f32_32x32x16_bf16 v[40:55], a[84:87], v[120:123], v[40:55]
ds_read_b64_tr_b16 v[108:109], v14 offset:24576
ds_read_b64_tr_b16 v[110:111], v14 offset:25600
s_waitcnt lgkmcnt(8)
v_mfma_f32_32x32x16_bf16 v[56:71], a[84:87], v[124:127], v[56:71]
ds_read_b64_tr_b16 v[112:113], v15 offset:24576
ds_read_b64_tr_b16 v[114:115], v15 offset:25600
s_waitcnt lgkmcnt(8)
v_mfma_f32_32x32x16_bf16 v[72:87], a[84:87], v[128:131], v[72:87]
ds_read_b64_tr_b16 v[116:117], v16 offset:24576
ds_read_b64_tr_b16 v[118:119], v16 offset:25600
s_waitcnt lgkmcnt(8)
v_mfma_f32_32x32x16_bf16 v[88:103], a[84:87], v[132:135], v[88:103]
ds_read_b64_tr_b16 v[120:121], v13 offset:28672
ds_read_b64_tr_b16 v[122:123], v13 offset:29696
s_waitcnt lgkmcnt(8)
v_mfma_f32_32x32x16_bf16 v[40:55], a[88:91], v[104:107], v[40:55]
ds_read_b64_tr_b16 v[124:125], v14 offset:28672
ds_read_b64_tr_b16 v[126:127], v14 offset:29696
s_waitcnt lgkmcnt(8)
v_mfma_f32_32x32x16_bf16 v[56:71], a[88:91], v[108:111], v[56:71]
ds_read_b64_tr_b16 v[128:129], v15 offset:28672
ds_read_b64_tr_b16 v[130:131], v15 offset:29696
s_waitcnt lgkmcnt(8)
v_mfma_f32_32x32x16_bf16 v[72:87], a[88:91], v[112:115], v[72:87]
ds_read_b64_tr_b16 v[132:133], v16 offset:28672
ds_read_b64_tr_b16 v[134:135], v16 offset:29696
s_waitcnt lgkmcnt(8)
v_mfma_f32_32x32x16_bf16 v[88:103], a[88:91], v[116:119], v[88:103]
s_waitcnt vmcnt(8)
s_barrier
ds_read_b64_tr_b16 v[104:105], v13 offset:32768
ds_read_b64_tr_b16 v[106:107], v13 offset:33792
s_waitcnt lgkmcnt(8)
v_mfma_f32_32x32x16_bf16 v[40:55], a[92:95], v[120:123], v[40:55]
s_add_u32 s65, s40, 32768
buffer_load_dword v34, v4, s[8:11], s65 offen sc1
ds_read_b64_tr_b16 v[108:109], v14 offset:32768
ds_read_b64_tr_b16 v[110:111], v14 offset:33792
s_waitcnt lgkmcnt(8)
v_mfma_f32_32x32x16_bf16 v[56:71], a[92:95], v[124:127], v[56:71]
ds_read_b64_tr_b16 v[112:113], v15 offset:32768
ds_read_b64_tr_b16 v[114:115], v15 offset:33792
s_waitcnt lgkmcnt(8)
v_mfma_f32_32x32x16_bf16 v[72:87], a[92:95], v[128:131], v[72:87]
ds_read_b64_tr_b16 v[116:117], v16 offset:32768
ds_read_b64_tr_b16 v[118:119], v16 offset:33792
s_waitcnt lgkmcnt(8)
v_mfma_f32_32x32x16_bf16 v[88:103], a[92:95], v[132:135], v[88:103]
ds_read_b64_tr_b16 v[120:121], v13 offset:36864
ds_read_b64_tr_b16 v[122:123], v13 offset:37888
s_waitcnt lgkmcnt(8)
v_mfma_f32_32x32x16_bf16 v[40:55], a[96:99], v[104:107], v[40:55]
ds_read_b64_tr_b16 v[124:125], v14 offset:36864
ds_read_b64_tr_b16 v[126:127], v14 offset:37888
s_waitcnt lgkmcnt(8)
v_mfma_f32_32x32x16_bf16 v[56:71], a[96:99], v[108:111], v[56:71]
ds_read_b64_tr_b16 v[128:129], v15 offset:36864
ds_read_b64_tr_b16 v[130:131], v15 offset:37888
s_waitcnt lgkmcnt(8)
v_mfma_f32_32x32x16_bf16 v[72:87], a[96:99], v[112:115], v[72:87]
ds_read_b64_tr_b16 v[132:133], v16 offset:36864
ds_read_b64_tr_b16 v[134:135], v16 offset:37888
s_waitcnt lgkmcnt(8)
v_mfma_f32_32x32x16_bf16 v[88:103], a[96:99], v[116:119], v[88:103]
ds_read_b64_tr_b16 v[104:105], v13 offset:40960
ds_read_b64_tr_b16 v[106:107], v13 offset:41984
s_waitcnt lgkmcnt(8)
v_mfma_f32_32x32x16_bf16 v[40:55], a[100:103], v[120:123], v[40:55]
s_waitcnt vmcnt(1)
s_mov_b32 s62, 0x03020302
v_and_b32 v152, v136, v138
v_and_b32 v153, v140, v142
ds_read_b64_tr_b16 v[108:109], v14 offset:40960
ds_read_b64_tr_b16 v[110:111], v14 offset:41984
s_waitcnt lgkmcnt(8)
v_mfma_f32_32x32x16_bf16 v[56:71], a[100:103], v[124:127], v[56:71]
v_and_b32 v152, v152, v153
v_and_b32 v152, 1, v152
v_cmp_eq_u32 vcc, 0, v152
ds_read_b64_tr_b16 v[112:113], v15 offset:40960
ds_read_b64_tr_b16 v[114:115], v15 offset:41984
s_waitcnt lgkmcnt(8)
v_mfma_f32_32x32x16_bf16 v[72:87], a[100:103], v[128:131], v[72:87]
s_cbranch_vccnz Llg_1064
Llgd_1065:
v_perm_b32 v144, v136, v136, s62
ds_read_b64_tr_b16 v[116:117], v16 offset:40960
ds_read_b64_tr_b16 v[118:119], v16 offset:41984
s_waitcnt lgkmcnt(8)
v_mfma_f32_32x32x16_bf16 v[88:103], a[100:103], v[132:135], v[88:103]
v_perm_b32 v145, v136, v136, s62
v_perm_b32 v146, v138, v138, s62
v_perm_b32 v147, v138, v138, s62
ds_read_b64_tr_b16 v[120:121], v13 offset:45056
ds_read_b64_tr_b16 v[122:123], v13 offset:46080
s_waitcnt lgkmcnt(8)
v_mfma_f32_32x32x16_bf16 v[40:55], a[104:107], v[104:107], v[40:55]
v_perm_b32 v148, v140, v140, s62
v_perm_b32 v149, v140, v140, s62
v_perm_b32 v150, v142, v142, s62
ds_read_b64_tr_b16 v[124:125], v14 offset:45056
ds_read_b64_tr_b16 v[126:127], v14 offset:46080
s_waitcnt lgkmcnt(8)
v_mfma_f32_32x32x16_bf16 v[56:71], a[104:107], v[108:111], v[56:71]
v_perm_b32 v151, v142, v142, s62
v_mov_b32 v152, 0
v_mov_b32 v153, 0
ds_read_b64_tr_b16 v[128:129], v15 offset:45056
ds_read_b64_tr_b16 v[130:131], v15 offset:46080
s_waitcnt lgkmcnt(8)
v_mfma_f32_32x32x16_bf16 v[72:87], a[104:107], v[112:115], v[72:87]
ds_read_b64_tr_b16 v[132:133], v16 offset:45056
ds_read_b64_tr_b16 v[134:135], v16 offset:46080
s_waitcnt lgkmcnt(8)
v_mfma_f32_32x32x16_bf16 v[88:103], a[104:107], v[116:119], v[88:103]
s_waitcnt vmcnt(0)
v_cmp_gt_u32 vcc, s101, v34
s_cbranch_vccz Lsd_1068
s_mov_b32 s80, 0
Lsq_1069:
buffer_load_dword v34, v4, s[8:11], s65 offen sc1
s_add_u32 s80, s80, 1
s_cmp_lt_u32 s80, 0x8000
s_cbranch_scc0 Lsd_1068
s_waitcnt vmcnt(0)
v_cmp_gt_u32 vcc, s101, v34
s_nop 1
s_cbranch_vccnz Lsq_1069
Lsd_1068:
s_barrier
ds_read_b64_tr_b16 v[104:105], v17 offset:0
ds_read_b64_tr_b16 v[106:107], v17 offset:1024
s_waitcnt lgkmcnt(8)
v_mfma_f32_32x32x16_bf16 v[40:55], a[108:111], v[120:123], v[40:55]
s_add_u32 m0, s29, 65536
s_add_u32 s59, s35, 25165824
ds_read_b64_tr_b16 v[108:109], v17 offset:4096
ds_read_b64_tr_b16 v[110:111], v17 offset:5120
s_waitcnt lgkmcnt(8)
v_mfma_f32_32x32x16_bf16 v[56:71], a[108:111], v[124:127], v[56:71]
buffer_load_dwordx4 v22, s[8:11], s59 offen sc1 lds
ds_read_b64_tr_b16 v[112:113], v17 offset:8192
ds_read_b64_tr_b16 v[114:115], v17 offset:9216
s_waitcnt lgkmcnt(8)
v_mfma_f32_32x32x16_bf16 v[72:87], a[108:111], v[128:131], v[72:87]
s_add_u32 m0, s29, 69632
s_add_u32 s59, s35, 25166848
ds_read_b64_tr_b16 v[116:117], v17 offset:12288
ds_read_b64_tr_b16 v[118:119], v17 offset:13312
s_waitcnt lgkmcnt(8)
v_mfma_f32_32x32x16_bf16 v[88:103], a[108:111], v[132:135], v[88:103]
buffer_load_dwordx4 v22, s[8:11], s59 offen sc1 lds
v_mfma_f32_32x32x16_bf16 v[40:55], v[156:159], v[144:147], v[40:55]
s_add_u32 m0, s29, 73728
s_add_u32 s59, s35, 25167872
v_mfma_f32_32x32x16_bf16 v[56:71], v[156:159], v[146:149], v[56:71]
buffer_load_dwordx4 v22, s[8:11], s59 offen sc1 lds
v_mfma_f32_32x32x16_bf16 v[72:87], v[156:159], v[148:151], v[72:87]
s_add_u32 m0, s29, 77824
s_add_u32 s59, s35, 25168896
v_mfma_f32_32x32x16_bf16 v[88:103], v[156:159], v[150:153], v[88:103]
buffer_load_dwordx4 v22, s[8:11], s59 offen sc1 lds
ds_read_b64_tr_b16 v[120:121], v18 offset:0
ds_read_b64_tr_b16 v[122:123], v18 offset:1024
s_waitcnt lgkmcnt(8)
v_mfma_f32_32x32x16_bf16 v[40:55], a[112:115], v[104:107], v[40:55]
s_add_u32 m0, s29, 81920
s_add_u32 s59, s35, 25169920
ds_read_b64_tr_b16 v[124:125], v18 offset:4096
ds_read_b64_tr_b16 v[126:127], v18 offset:5120
s_waitcnt lgkmcnt(8)
v_mfma_f32_32x32x16_bf16 v[40:55], a[116:119], v[108:111], v[40:55]
buffer_load_dwordx4 v22, s[8:11], s59 offen sc1 lds
ds_read_b64_tr_b16 v[128:129], v18 offset:8192
ds_read_b64_tr_b16 v[130:131], v18 offset:9216
s_waitcnt lgkmcnt(8)
v_mfma_f32_32x32x16_bf16 v[40:55], a[120:123], v[112:115], v[40:55]
s_add_u32 m0, s29, 86016
s_add_u32 s59, s35, 25170944
ds_read_b64_tr_b16 v[132:133], v18 offset:12288
ds_read_b64_tr_b16 v[134:135], v18 offset:13312
s_waitcnt lgkmcnt(8)
v_mfma_f32_32x32x16_bf16 v[40:55], a[124:127], v[116:119], v[40:55]
buffer_load_dwordx4 v22, s[8:11], s59 offen sc1 lds
ds_read_b64_tr_b16 v[104:105], v19 offset:0
ds_read_b64_tr_b16 v[106:107], v19 offset:1024
s_waitcnt lgkmcnt(8)
v_mfma_f32_32x32x16_bf16 v[56:71], a[112:115], v[120:123], v[56:71]
s_add_u32 m0, s29, 90112
s_add_u32 s59, s35, 25171968
ds_read_b64_tr_b16 v[108:109], v19 offset:4096
ds_read_b64_tr_b16 v[110:111], v19 offset:5120
s_waitcnt lgkmcnt(8)
v_mfma_f32_32x32x16_bf16 v[56:71], a[116:119], v[124:127], v[56:71]
buffer_load_dwordx4 v22, s[8:11], s59 offen sc1 lds
v_max_f32 v40, 0, v40
v_max_f32 v41, 0, v41
v_max_f32 v42, 0, v42
v_max_f32 v43, 0, v43
v_max_f32 v44, 0, v44
v_max_f32 v45, 0, v45
v_max_f32 v46, 0, v46
v_max_f32 v47, 0, v47
ds_read_b64_tr_b16 v[112:113], v19 offset:8192
ds_read_b64_tr_b16 v[114:115], v19 offset:9216
s_waitcnt lgkmcnt(8)
v_mfma_f32_32x32x16_bf16 v[56:71], a[120:123], v[128:131], v[56:71]
s_add_u32 m0, s29, 94208
s_add_u32 s59, s35, 25172992
v_mul_f32 v40, v40, v48
v_mul_f32 v41, v41, v49
v_mul_f32 v42, v42, v50
v_mul_f32 v43, v43, v51
v_mul_f32 v44, v44, v52
v_mul_f32 v45, v45, v53
v_mul_f32 v46, v46, v54
v_mul_f32 v47, v47, v55
ds_read_b64_tr_b16 v[116:117], v19 offset:12288
ds_read_b64_tr_b16 v[118:119], v19 offset:13312
s_waitcnt lgkmcnt(8)
v_mfma_f32_32x32x16_bf16 v[56:71], a[124:127], v[132:135], v[56:71]
buffer_load_dwordx4 v22, s[8:11], s59 offen sc1 lds
v_cvt_pk_bf16_f32 v48, v40, v41
v_cvt_pk_bf16_f32 v49, v42, v43
v_cvt_pk_bf16_f32 v50, v44, v45
v_cvt_pk_bf16_f32 v51, v46, v47
s_add_u32 s67, s34, 28835840
buffer_store_dwordx4 v[48:51], v22, s[8:11], s67 offen sc1
ds_read_b64_tr_b16 v[120:121], v20 offset:0
ds_read_b64_tr_b16 v[122:123], v20 offset:1024
s_waitcnt lgkmcnt(8)
v_mfma_f32_32x32x16_bf16 v[72:87], a[112:115], v[104:107], v[72:87]
s_add_u32 m0, s29, 0
s_add_u32 s59, s35, 25174016
ds_read_b64_tr_b16 v[124:125], v20 offset:4096
ds_read_b64_tr_b16 v[126:127], v20 offset:5120
s_waitcnt lgkmcnt(8)
v_mfma_f32_32x32x16_bf16 v[72:87], a[116:119], v[108:111], v[72:87]
buffer_load_dwordx4 v22, s[8:11], s59 offen sc1 lds
v_max_f32 v56, 0, v56
v_max_f32 v57, 0, v57
v_max_f32 v58, 0, v58
v_max_f32 v59, 0, v59
v_max_f32 v60, 0, v60
v_max_f32 v61, 0, v61
v_max_f32 v62, 0, v62
v_max_f32 v63, 0, v63
ds_read_b64_tr_b16 v[128:129], v20 offset:8192
ds_read_b64_tr_b16 v[130:131], v20 offset:9216
s_waitcnt lgkmcnt(8)
v_mfma_f32_32x32x16_bf16 v[72:87], a[120:123], v[112:115], v[72:87]
s_add_u32 m0, s29, 4096
s_add_u32 s59, s35, 25175040
v_mul_f32 v56, v56, v64
v_mul_f32 v57, v57, v65
v_mul_f32 v58, v58, v66
v_mul_f32 v59, v59, v67
v_mul_f32 v60, v60, v68
v_mul_f32 v61, v61, v69
v_mul_f32 v62, v62, v70
v_mul_f32 v63, v63, v71
ds_read_b64_tr_b16 v[132:133], v20 offset:12288
ds_read_b64_tr_b16 v[134:135], v20 offset:13312
s_waitcnt lgkmcnt(8)
v_mfma_f32_32x32x16_bf16 v[72:87], a[124:127], v[116:119], v[72:87]
buffer_load_dwordx4 v22, s[8:11], s59 offen sc1 lds
v_cvt_pk_bf16_f32 v64, v56, v57
v_cvt_pk_bf16_f32 v65, v58, v59
v_cvt_pk_bf16_f32 v66, v60, v61
v_cvt_pk_bf16_f32 v67, v62, v63
s_add_u32 s67, s34, 28950528
buffer_store_dwordx4 v[64:67], v22, s[8:11], s67 offen sc1
s_waitcnt lgkmcnt(6)
v_mfma_f32_32x32x16_bf16 v[88:103], a[112:115], v[120:123], v[88:103]
s_add_u32 m0, s29, 8192
s_add_u32 s59, s35, 25176064
s_waitcnt lgkmcnt(4)
v_mfma_f32_32x32x16_bf16 v[88:103], a[116:119], v[124:127], v[88:103]
buffer_load_dwordx4 v22, s[8:11], s59 offen sc1 lds
v_max_f32 v72, 0, v72
v_max_f32 v73, 0, v73
v_max_f32 v74, 0, v74
v_max_f32 v75, 0, v75
v_max_f32 v76, 0, v76
v_max_f32 v77, 0, v77
v_max_f32 v78, 0, v78
v_max_f32 v79, 0, v79
s_waitcnt lgkmcnt(2)
v_mfma_f32_32x32x16_bf16 v[88:103], a[120:123], v[128:131], v[88:103]
s_add_u32 m0, s29, 12288
s_add_u32 s59, s35, 25177088
v_mul_f32 v72, v72, v80
v_mul_f32 v73, v73, v81
v_mul_f32 v74, v74, v82
v_mul_f32 v75, v75, v83
v_mul_f32 v76, v76, v84
v_mul_f32 v77, v77, v85
v_mul_f32 v78, v78, v86
v_mul_f32 v79, v79, v87
s_waitcnt lgkmcnt(0)
v_mfma_f32_32x32x16_bf16 v[88:103], a[124:127], v[132:135], v[88:103]
buffer_load_dwordx4 v22, s[8:11], s59 offen sc1 lds
v_cvt_pk_bf16_f32 v80, v72, v73
v_cvt_pk_bf16_f32 v81, v74, v75
v_cvt_pk_bf16_f32 v82, v76, v77
v_cvt_pk_bf16_f32 v83, v78, v79
s_add_u32 s67, s34, 29065216
buffer_store_dwordx4 v[80:83], v22, s[8:11], s67 offen sc1
s_barrier
s_branch Ljoin_1057
Lst_1056:
v_and_b32 v41, 3, v1
v_lshrrev_b32 v42, 5, v1
v_bfe_u32 v43, v1, 2, 2
v_lshlrev_b32 v42, 9, v42
v_lshl_add_u32 v42, v43, 6, v42
v_bfe_u32 v43, v1, 4, 1
v_lshl_add_u32 v42, v43, 5, v42
v_lshl_add_u32 v42, v41, 3, v42
v_add_u32 v42, s29, v42
v_lshrrev_b32 v43, 5, v1
v_lshl_add_u32 v43, v43, 2, v23
s_lshl_b32 s60, s28, 8
s_add_u32 s60, s60, 33280
v_add_u32 v43, s60, v43
s_mov_b32 s62, 0x3f803f80
v_mov_b32 v44, 0
v_mov_b32 v45, 0
v_mov_b32 v46, 0
v_mov_b32 v47, 0
s_waitcnt vmcnt(8)
ds_read_b64_tr_b16 v[48:49], v42 offset:0
ds_read_b64_tr_b16 v[50:51], v42 offset:256
s_waitcnt vmcnt(7)
ds_read_b64_tr_b16 v[52:53], v42 offset:4096
ds_read_b64_tr_b16 v[54:55], v42 offset:4352
s_waitcnt vmcnt(6)
ds_read_b64_tr_b16 v[56:57], v42 offset:8192
ds_read_b64_tr_b16 v[58:59], v42 offset:8448
s_waitcnt vmcnt(5)
ds_read_b64_tr_b16 v[60:61], v42 offset:12288
ds_read_b64_tr_b16 v[62:63], v42 offset:12544
s_waitcnt vmcnt(4)
ds_read_b64_tr_b16 v[64:65], v42 offset:16384
ds_read_b64_tr_b16 v[66:67], v42 offset:16640
s_waitcnt vmcnt(3)
ds_read_b64_tr_b16 v[68:69], v42 offset:20480
ds_read_b64_tr_b16 v[70:71], v42 offset:20736
s_waitcnt vmcnt(2)
ds_read_b64_tr_b16 v[72:73], v42 offset:24576
ds_read_b64_tr_b16 v[74:75], v42 offset:24832
s_waitcnt vmcnt(1)
ds_read_b64_tr_b16 v[76:77], v42 offset:28672
ds_read_b64_tr_b16 v[78:79], v42 offset:28928
s_waitcnt lgkmcnt(14)
v_dot2_f32_bf16 v44, v48, s62, v44
v_dot2_f32_bf16 v45, v48, v48, v45
v_dot2_f32_bf16 v46, v49, s62, v46
v_dot2_f32_bf16 v47, v49, v49, v47
v_dot2_f32_bf16 v44, v50, s62, v44
v_dot2_f32_bf16 v45, v50, v50, v45
v_dot2_f32_bf16 v46, v51, s62, v46
v_dot2_f32_bf16 v47, v51, v51, v47
s_waitcnt lgkmcnt(12)
v_dot2_f32_bf16 v44, v52, s62, v44
v_dot2_f32_bf16 v45, v52, v52, v45
v_dot2_f32_bf16 v46, v53, s62, v46
v_dot2_f32_bf16 v47, v53, v53, v47
v_dot2_f32_bf16 v44, v54, s62, v44
v_dot2_f32_bf16 v45, v54, v54, v45
v_dot2_f32_bf16 v46, v55, s62, v46
v_dot2_f32_bf16 v47, v55, v55, v47
s_waitcnt lgkmcnt(10)
v_dot2_f32_bf16 v44, v56, s62, v44
v_dot2_f32_bf16 v45, v56, v56, v45
v_dot2_f32_bf16 v46, v57, s62, v46
v_dot2_f32_bf16 v47, v57, v57, v47
v_dot2_f32_bf16 v44, v58, s62, v44
v_dot2_f32_bf16 v45, v58, v58, v45
v_dot2_f32_bf16 v46, v59, s62, v46
v_dot2_f32_bf16 v47, v59, v59, v47
s_waitcnt lgkmcnt(8)
v_dot2_f32_bf16 v44, v60, s62, v44
v_dot2_f32_bf16 v45, v60, v60, v45
v_dot2_f32_bf16 v46, v61, s62, v46
v_dot2_f32_bf16 v47, v61, v61, v47
v_dot2_f32_bf16 v44, v62, s62, v44
v_dot2_f32_bf16 v45, v62, v62, v45
v_dot2_f32_bf16 v46, v63, s62, v46
v_dot2_f32_bf16 v47, v63, v63, v47
s_waitcnt lgkmcnt(6)
v_dot2_f32_bf16 v44, v64, s62, v44
v_dot2_f32_bf16 v45, v64, v64, v45
v_dot2_f32_bf16 v46, v65, s62, v46
v_dot2_f32_bf16 v47, v65, v65, v47
v_dot2_f32_bf16 v44, v66, s62, v44
v_dot2_f32_bf16 v45, v66, v66, v45
v_dot2_f32_bf16 v46, v67, s62, v46
v_dot2_f32_bf16 v47, v67, v67, v47
s_waitcnt lgkmcnt(4)
v_dot2_f32_bf16 v44, v68, s62, v44
v_dot2_f32_bf16 v45, v68, v68, v45
v_dot2_f32_bf16 v46, v69, s62, v46
v_dot2_f32_bf16 v47, v69, v69, v47
v_dot2_f32_bf16 v44, v70, s62, v44
v_dot2_f32_bf16 v45, v70, v70, v45
v_dot2_f32_bf16 v46, v71, s62, v46
v_dot2_f32_bf16 v47, v71, v71, v47
s_waitcnt lgkmcnt(2)
v_dot2_f32_bf16 v44, v72, s62, v44
v_dot2_f32_bf16 v45, v72, v72, v45
v_dot2_f32_bf16 v46, v73, s62, v46
v_dot2_f32_bf16 v47, v73, v73, v47
v_dot2_f32_bf16 v44, v74, s62, v44
v_dot2_f32_bf16 v45, v74, v74, v45
v_dot2_f32_bf16 v46, v75, s62, v46
v_dot2_f32_bf16 v47, v75, v75, v47
s_waitcnt lgkmcnt(0)
v_dot2_f32_bf16 v44, v76, s62, v44
v_dot2_f32_bf16 v45, v76, v76, v45
v_dot2_f32_bf16 v46, v77, s62, v46
v_dot2_f32_bf16 v47, v77, v77, v47
v_dot2_f32_bf16 v44, v78, s62, v44
v_dot2_f32_bf16 v45, v78, v78, v45
v_dot2_f32_bf16 v46, v79, s62, v46
v_dot2_f32_bf16 v47, v79, v79, v47
s_nop 1
v_add_f32 v44, v44, v46
v_add_f32 v45, v45, v47
s_nop 1
v_permlane32_swap_b32 v44, v45
v_add_f32 v44, v44, v45
ds_write_b32 v43, v44 offset:0
s_waitcnt vmcnt(0)
s_waitcnt lgkmcnt(0)
s_barrier
s_add_u32 s63, s56, 49152
s_mov_b64 exec, 255
buffer_atomic_add v35, v3, s[8:11], s63 offen sc1
s_mov_b64 exec, -1
s_cmp_lg_u32 s28, 0
s_cbranch_scc1 Lc_2070
ds_read_b64 v[48:49], v23 offset:33280
ds_read_b64 v[50:51], v23 offset:33536
ds_read_b64 v[52:53], v23 offset:33792
ds_read_b64 v[54:55], v23 offset:34048
s_waitcnt lgkmcnt(0)
v_add_f32 v48, v48, v50
v_add_f32 v49, v49, v51
v_add_f32 v52, v52, v54
v_add_f32 v53, v53, v55
v_add_f32 v48, v48, v52
v_add_f32 v49, v49, v53
v_mul_f32 v48, 0x3b000000, v48
v_mul_f32 v49, 0x3b000000, v49
v_fma_f32 v49, -v48, v48, v49
v_max_f32 v49, 0, v49
v_cvt_pk_bf16_f32 v50, v48, v49
v_lshlrev_b32 v48, 16, v50
v_and_b32 v49, 0xffff0000, v50
v_add_f32 v49, 0x3727c5ac, v49
v_cvt_pk_bf16_f32 v49, v49, v49
v_lshlrev_b32 v49, 16, v49
v_sqrt_f32 v49, v49
s_nop 0
v_cvt_pk_bf16_f32 v49, v49, v49
v_lshlrev_b32 v49, 16, v49
v_rcp_f32 v49, v49
v_or_b32 v48, 1, v48
s_and_b32 s60, s45, 0x7ff
s_lshl_b32 s60, s60, 2
s_add_u32 s60, s60, 147456
s_mov_b32 exec_hi, 0
buffer_store_dwordx2 v[48:49], v23, s[8:11], s60 offen sc1
s_mov_b64 exec, -1
Lc_2070:
s_add_u32 s64, s56, 49152
buffer_load_dword v34, v2, s[8:11], s64 offen sc1
s_waitcnt vmcnt(0)
v_cmp_gt_u32 vcc, s57, v34
s_cbranch_vccnz Lsp_2071
Lsd_2072:
s_barrier
s_add_u32 m0, s29, 0
s_add_u32 s61, s45, 8390656
buffer_load_dwordx4 v21, s[8:11], s61 offen sc1 lds
s_add_u32 m0, s29, 4096
s_add_u32 s61, s45, 8456192
buffer_load_dwordx4 v21, s[8:11], s61 offen sc1 lds
s_add_u32 m0, s29, 8192
s_add_u32 s61, s45, 8521728
buffer_load_dwordx4 v21, s[8:11], s61 offen sc1 lds
s_add_u32 m0, s29, 12288
s_add_u32 s61, s45, 8587264
buffer_load_dwordx4 v21, s[8:11], s61 offen sc1 lds
s_add_u32 m0, s29, 16384
s_add_u32 s61, s45, 8652800
buffer_load_dwordx4 v21, s[8:11], s61 offen sc1 lds
s_add_u32 m0, s29, 20480
s_add_u32 s61, s45, 8718336
buffer_load_dwordx4 v21, s[8:11], s61 offen sc1 lds
s_add_u32 m0, s29, 24576
s_add_u32 s61, s45, 8783872
buffer_load_dwordx4 v21, s[8:11], s61 offen sc1 lds
s_add_u32 m0, s29, 28672
s_add_u32 s61, s45, 8849408
buffer_load_dwordx4 v21, s[8:11], s61 offen sc1 lds
s_waitcnt vmcnt(0)
s_mov_b32 s62, 0x3f803f80
v_mov_b32 v44, 0
v_mov_b32 v45, 0
v_mov_b32 v46, 0
v_mov_b32 v47, 0
ds_read_b64_tr_b16 v[48:49], v42 offset:0
ds_read_b64_tr_b16 v[50:51], v42 offset:256
ds_read_b64_tr_b16 v[52:53], v42 offset:4096
ds_read_b64_tr_b16 v[54:55], v42 offset:4352
ds_read_b64_tr_b16 v[56:57], v42 offset:8192
ds_read_b64_tr_b16 v[58:59], v42 offset:8448
ds_read_b64_tr_b16 v[60:61], v42 offset:12288
ds_read_b64_tr_b16 v[62:63], v42 offset:12544
ds_read_b64_tr_b16 v[64:65], v42 offset:16384
ds_read_b64_tr_b16 v[66:67], v42 offset:16640
ds_read_b64_tr_b16 v[68:69], v42 offset:20480
ds_read_b64_tr_b16 v[70:71], v42 offset:20736
ds_read_b64_tr_b16 v[72:73], v42 offset:24576
ds_read_b64_tr_b16 v[74:75], v42 offset:24832
ds_read_b64_tr_b16 v[76:77], v42 offset:28672
ds_read_b64_tr_b16 v[78:79], v42 offset:28928
s_waitcnt lgkmcnt(14)
v_dot2_f32_bf16 v44, v48, s62, v44
v_dot2_f32_bf16 v45, v48, v48, v45
v_dot2_f32_bf16 v46, v49, s62, v46
v_dot2_f32_bf16 v47, v49, v49, v47
v_dot2_f32_bf16 v44, v50, s62, v44
v_dot2_f32_bf16 v45, v50, v50, v45
v_dot2_f32_bf16 v46, v51, s62, v46
v_dot2_f32_bf16 v47, v51, v51, v47
s_waitcnt lgkmcnt(12)
v_dot2_f32_bf16 v44, v52, s62, v44
v_dot2_f32_bf16 v45, v52, v52, v45
v_dot2_f32_bf16 v46, v53, s62, v46
v_dot2_f32_bf16 v47, v53, v53, v47
v_dot2_f32_bf16 v44, v54, s62, v44
v_dot2_f32_bf16 v45, v54, v54, v45
v_dot2_f32_bf16 v46, v55, s62, v46
v_dot2_f32_bf16 v47, v55, v55, v47
s_waitcnt lgkmcnt(10)
v_dot2_f32_bf16 v44, v56, s62, v44
v_dot2_f32_bf16 v45, v56, v56, v45
v_dot2_f32_bf16 v46, v57, s62, v46
v_dot2_f32_bf16 v47, v57, v57, v47
v_dot2_f32_bf16 v44, v58, s62, v44
v_dot2_f32_bf16 v45, v58, v58, v45
v_dot2_f32_bf16 v46, v59, s62, v46
v_dot2_f32_bf16 v47, v59, v59, v47
s_waitcnt lgkmcnt(8)
v_dot2_f32_bf16 v44, v60, s62, v44
v_dot2_f32_bf16 v45, v60, v60, v45
v_dot2_f32_bf16 v46, v61, s62, v46
v_dot2_f32_bf16 v47, v61, v61, v47
v_dot2_f32_bf16 v44, v62, s62, v44
v_dot2_f32_bf16 v45, v62, v62, v45
v_dot2_f32_bf16 v46, v63, s62, v46
v_dot2_f32_bf16 v47, v63, v63, v47
s_waitcnt lgkmcnt(6)
v_dot2_f32_bf16 v44, v64, s62, v44
v_dot2_f32_bf16 v45, v64, v64, v45
v_dot2_f32_bf16 v46, v65, s62, v46
v_dot2_f32_bf16 v47, v65, v65, v47
v_dot2_f32_bf16 v44, v66, s62, v44
v_dot2_f32_bf16 v45, v66, v66, v45
v_dot2_f32_bf16 v46, v67, s62, v46
v_dot2_f32_bf16 v47, v67, v67, v47
s_waitcnt lgkmcnt(4)
v_dot2_f32_bf16 v44, v68, s62, v44
v_dot2_f32_bf16 v45, v68, v68, v45
v_dot2_f32_bf16 v46, v69, s62, v46
v_dot2_f32_bf16 v47, v69, v69, v47
v_dot2_f32_bf16 v44, v70, s62, v44
v_dot2_f32_bf16 v45, v70, v70, v45
v_dot2_f32_bf16 v46, v71, s62, v46
v_dot2_f32_bf16 v47, v71, v71, v47
s_waitcnt lgkmcnt(2)
v_dot2_f32_bf16 v44, v72, s62, v44
v_dot2_f32_bf16 v45, v72, v72, v45
v_dot2_f32_bf16 v46, v73, s62, v46
v_dot2_f32_bf16 v47, v73, v73, v47
v_dot2_f32_bf16 v44, v74, s62, v44
v_dot2_f32_bf16 v45, v74, v74, v45
v_dot2_f32_bf16 v46, v75, s62, v46
v_dot2_f32_bf16 v47, v75, v75, v47
s_waitcnt lgkmcnt(0)
v_dot2_f32_bf16 v44, v76, s62, v44
v_dot2_f32_bf16 v45, v76, v76, v45
v_dot2_f32_bf16 v46, v77, s62, v46
v_dot2_f32_bf16 v47, v77, v77, v47
v_dot2_f32_bf16 v44, v78, s62, v44
v_dot2_f32_bf16 v45, v78, v78, v45
v_dot2_f32_bf16 v46, v79, s62, v46
v_dot2_f32_bf16 v47, v79, v79, v47
s_nop 1
v_add_f32 v44, v44, v46
v_add_f32 v45, v45, v47
s_nop 1
v_permlane32_swap_b32 v44, v45
v_add_f32 v44, v44, v45
ds_write_b32 v43, v44 offset:1024
s_waitcnt lgkmcnt(0)
s_barrier
s_cmp_lg_u32 s28, 0
s_cbranch_scc1 Lc_2074
ds_read_b64 v[48:49], v23 offset:34304
ds_read_b64 v[50:51], v23 offset:34560
ds_read_b64 v[52:53], v23 offset:34816
ds_read_b64 v[54:55], v23 offset:35072
s_waitcnt lgkmcnt(0)
v_add_f32 v48, v48, v50
v_add_f32 v49, v49, v51
v_add_f32 v52, v52, v54
v_add_f32 v53, v53, v55
v_add_f32 v48, v48, v52
v_add_f32 v49, v49, v53
v_mul_f32 v48, 0x3b000000, v48
v_mul_f32 v49, 0x3b000000, v49
v_fma_f32 v49, -v48, v48, v49
v_max_f32 v49, 0, v49
v_cvt_pk_bf16_f32 v50, v48, v49
v_lshlrev_b32 v48, 16, v50
v_and_b32 v49, 0xffff0000, v50
v_add_f32 v49, 0x3727c5ac, v49
v_cvt_pk_bf16_f32 v49, v49, v49
v_lshlrev_b32 v49, 16, v49
v_sqrt_f32 v49, v49
s_nop 0
v_cvt_pk_bf16_f32 v49, v49, v49
v_lshlrev_b32 v49, 16, v49
v_rcp_f32 v49, v49
v_or_b32 v48, 1, v48
s_and_b32 s60, s45, 0x7ff
s_lshl_b32 s60, s60, 2
s_add_u32 s60, s60, 155648
s_mov_b32 exec_hi, 0
buffer_store_dwordx2 v[48:49], v23, s[8:11], s60 offen sc1
s_mov_b64 exec, -1
Lc_2074:
s_add_u32 s65, s40, 32768
buffer_load_dword v34, v4, s[8:11], s65 offen sc1
s_waitcnt vmcnt(0)
v_cmp_gt_u32 vcc, s101, v34
s_cbranch_vccnz Lsp_2075
Lsd_2076:
s_barrier
s_add_u32 m0, s29, 65536
s_add_u32 s59, s35, 25165824
buffer_load_dwordx4 v22, s[8:11], s59 offen sc1 lds
s_add_u32 m0, s29, 69632
s_add_u32 s59, s35, 25166848
buffer_load_dwordx4 v22, s[8:11], s59 offen sc1 lds
s_add_u32 m0, s29, 73728
s_add_u32 s59, s35, 25167872
buffer_load_dwordx4 v22, s[8:11], s59 offen sc1 lds
s_add_u32 m0, s29, 77824
s_add_u32 s59, s35, 25168896
buffer_load_dwordx4 v22, s[8:11], s59 offen sc1 lds
s_add_u32 m0, s29, 81920
s_add_u32 s59, s35, 25169920
buffer_load_dwordx4 v22, s[8:11], s59 offen sc1 lds
s_add_u32 m0, s29, 86016
s_add_u32 s59, s35, 25170944
buffer_load_dwordx4 v22, s[8:11], s59 offen sc1 lds
s_add_u32 m0, s29, 90112
s_add_u32 s59, s35, 25171968
buffer_load_dwordx4 v22, s[8:11], s59 offen sc1 lds
s_add_u32 m0, s29, 94208
s_add_u32 s59, s35, 25172992
buffer_load_dwordx4 v22, s[8:11], s59 offen sc1 lds
s_add_u32 m0, s29, 0
s_add_u32 s59, s35, 25174016
buffer_load_dwordx4 v22, s[8:11], s59 offen sc1 lds
s_add_u32 m0, s29, 4096
s_add_u32 s59, s35, 25175040
buffer_load_dwordx4 v22, s[8:11], s59 offen sc1 lds
s_add_u32 m0, s29, 8192
s_add_u32 s59, s35, 25176064
buffer_load_dwordx4 v22, s[8:11], s59 offen sc1 lds
s_add_u32 m0, s29, 12288
s_add_u32 s59, s35, 25177088
buffer_load_dwordx4 v22, s[8:11], s59 offen sc1 lds
s_waitcnt vmcnt(0)
s_waitcnt lgkmcnt(0)
Ljoin_1057:
s_nop 7
s_nop 1
s_waitcnt vmcnt(14)
ds_read_b128 v[104:107], v25 offset:16384
s_waitcnt vmcnt(13)
ds_read_b128 v[108:111], v25 offset:20480
s_waitcnt vmcnt(12)
ds_read_b128 v[112:115], v25 offset:24576
s_waitcnt vmcnt(11)
ds_read_b128 v[116:119], v25 offset:28672
v_max_f32 v88, 0, v88
v_max_f32 v89, 0, v89
v_max_f32 v90, 0, v90
v_max_f32 v91, 0, v91
v_max_f32 v92, 0, v92
v_max_f32 v93, 0, v93
v_max_f32 v94, 0, v94
v_max_f32 v95, 0, v95
v_mul_f32 v88, v88, v96
v_mul_f32 v89, v89, v97
v_mul_f32 v90, v90, v98
v_mul_f32 v91, v91, v99
v_mul_f32 v92, v92, v100
v_mul_f32 v93, v93, v101
v_mul_f32 v94, v94, v102
v_mul_f32 v95, v95, v103
v_cvt_pk_bf16_f32 v96, v88, v89
v_cvt_pk_bf16_f32 v97, v90, v91
v_cvt_pk_bf16_f32 v98, v92, v93
v_cvt_pk_bf16_f32 v99, v94, v95
s_add_u32 s67, s34, 29179904
buffer_store_dwordx4 v[96:99], v22, s[8:11], s67 offen sc1
s_waitcnt vmcnt(11)
ds_read_b128 v[120:123], v25 offset:32768
s_waitcnt lgkmcnt(4)
v_mfma_f32_32x32x16_bf16 v[40:55], a[128:131], v[104:107], 0
s_add_u32 m0, s29, 16384
s_add_u32 s59, s35, 25178112
v_mfma_f32_32x32x16_bf16 v[56:71], a[132:135], v[104:107], 0
buffer_load_dwordx4 v22, s[8:11], s59 offen sc1 lds
s_waitcnt vmcnt(11)
ds_read_b128 v[124:127], v25 offset:36864
s_waitcnt lgkmcnt(4)
v_mfma_f32_32x32x16_bf16 v[40:55], a[136:139], v[108:111], v[40:55]
s_add_u32 m0, s29, 20480
s_add_u32 s59, s35, 25179136
v_mfma_f32_32x32x16_bf16 v[56:71], a[140:143], v[108:111], v[56:71]
buffer_load_dwordx4 v22, s[8:11], s59 offen sc1 lds
s_waitcnt vmcnt(11)
ds_read_b128 v[128:131], v25 offset:40960
s_waitcnt lgkmcnt(4)
v_mfma_f32_32x32x16_bf16 v[40:55], a[144:147], v[112:115], v[40:55]
s_add_u32 m0, s29, 24576
s_add_u32 s59, s35, 25180160
v_mfma_f32_32x32x16_bf16 v[56:71], a[148:151], v[112:115], v[56:71]
buffer_load_dwordx4 v22, s[8:11], s59 offen sc1 lds
s_waitcnt vmcnt(11)
ds_read_b128 v[132:135], v25 offset:45056
s_waitcnt lgkmcnt(4)
v_mfma_f32_32x32x16_bf16 v[40:55], a[152:155], v[116:119], v[40:55]
s_add_u32 m0, s29, 28672
s_add_u32 s59, s35, 25181184
v_mfma_f32_32x32x16_bf16 v[56:71], a[156:159], v[116:119], v[56:71]
buffer_load_dwordx4 v22, s[8:11], s59 offen sc1 lds
s_waitcnt vmcnt(10)
ds_read_b128 v[104:107], v24 offset:0
s_waitcnt lgkmcnt(4)
v_mfma_f32_32x32x16_bf16 v[40:55], a[160:163], v[120:123], v[40:55]
s_add_u32 m0, s29, 32768
s_add_u32 s59, s35, 25182208
v_mfma_f32_32x32x16_bf16 v[56:71], a[164:167], v[120:123], v[56:71]
buffer_load_dwordx4 v22, s[8:11], s59 offen sc1 lds
s_waitcnt vmcnt(10)
ds_read_b128 v[108:111], v24 offset:4096
s_waitcnt lgkmcnt(4)
v_mfma_f32_32x32x16_bf16 v[40:55], a[168:171], v[124:127], v[40:55]
s_add_u32 m0, s29, 36864
s_add_u32 s59, s35, 25183232
v_mfma_f32_32x32x16_bf16 v[56:71], a[172:175], v[124:127], v[56:71]
buffer_load_dwordx4 v22, s[8:11], s59 offen sc1 lds
s_waitcnt vmcnt(6)
s_add_u32 s63, s31, 49152
v_mov_b32 v38, 0
s_mov_b64 exec, 1
buffer_atomic_add v35, v38, s[8:11], s63 offen sc1
s_mov_b64 exec, -1
ds_read_b128 v[112:115], v24 offset:8192
s_waitcnt lgkmcnt(4)
v_mfma_f32_32x32x16_bf16 v[40:55], a[176:179], v[128:131], v[40:55]
s_add_u32 m0, s29, 40960
s_add_u32 s59, s35, 25184256
v_mfma_f32_32x32x16_bf16 v[56:71], a[180:183], v[128:131], v[56:71]
buffer_load_dwordx4 v22, s[8:11], s59 offen sc1 lds
ds_read_b128 v[116:119], v24 offset:12288
s_waitcnt lgkmcnt(4)
v_mfma_f32_32x32x16_bf16 v[40:55], a[184:187], v[132:135], v[40:55]
s_add_u32 m0, s29, 45056
s_add_u32 s59, s35, 25185280
v_mfma_f32_32x32x16_bf16 v[56:71], a[188:191], v[132:135], v[56:71]
buffer_load_dwordx4 v22, s[8:11], s59 offen sc1 lds
s_waitcnt vmcnt(8)
ds_read_b128 v[120:123], v24 offset:16384
s_waitcnt lgkmcnt(4)
v_mfma_f32_32x32x16_bf16 v[40:55], a[192:195], v[104:107], v[40:55]
s_add_u32 m0, s29, 49152
s_add_u32 s59, s35, 25186304
v_mfma_f32_32x32x16_bf16 v[56:71], a[196:199], v[104:107], v[56:71]
buffer_load_dwordx4 v22, s[8:11], s59 offen sc1 lds
s_waitcnt vmcnt(8)
ds_read_b128 v[124:127], v24 offset:20480
s_waitcnt lgkmcnt(4)
v_mfma_f32_32x32x16_bf16 v[40:55], a[200:203], v[108:111], v[40:55]
s_add_u32 m0, s29, 53248
s_add_u32 s59, s35, 25187328
v_mfma_f32_32x32x16_bf16 v[56:71], a[204:207], v[108:111], v[56:71]
buffer_load_dwordx4 v22, s[8:11], s59 offen sc1 lds
s_waitcnt vmcnt(8)
ds_read_b128 v[128:131], v24 offset:24576
s_waitcnt lgkmcnt(4)
v_mfma_f32_32x32x16_bf16 v[40:55], a[208:211], v[112:115], v[40:55]
s_add_u32 m0, s29, 57344
s_add_u32 s59, s35, 25188352
v_mfma_f32_32x32x16_bf16 v[56:71], a[212:215], v[112:115], v[56:71]
buffer_load_dwordx4 v22, s[8:11], s59 offen sc1 lds
s_waitcnt vmcnt(8)
ds_read_b128 v[132:135], v24 offset:28672
s_waitcnt lgkmcnt(4)
v_mfma_f32_32x32x16_bf16 v[40:55], a[216:219], v[116:119], v[40:55]
s_add_u32 m0, s29, 61440
s_add_u32 s59, s35, 25189376
v_mfma_f32_32x32x16_bf16 v[56:71], a[220:223], v[116:119], v[56:71]
buffer_load_dwordx4 v22, s[8:11], s59 offen sc1 lds
s_waitcnt vmcnt(8)
ds_read_b128 v[104:107], v24 offset:32768
s_waitcnt lgkmcnt(4)
v_mfma_f32_32x32x16_bf16 v[40:55], a[224:227], v[120:123], v[40:55]
s_add_u32 m0, s29, 65536
s_add_u32 s59, s35, 25190400
v_mfma_f32_32x32x16_bf16 v[56:71], a[228:231], v[120:123], v[56:71]
buffer_load_dwordx4 v22, s[8:11], s59 offen sc1 lds
s_waitcnt vmcnt(8)
ds_read_b128 v[108:111], v24 offset:36864
s_waitcnt lgkmcnt(4)
v_mfma_f32_32x32x16_bf16 v[40:55], a[232:235], v[124:127], v[40:55]
s_add_u32 m0, s29, 69632
s_add_u32 s59, s35, 25191424
v_mov_b32 v136, 0
v_mov_b32 v137, 0
v_mov_b32 v138, 0
v_mov_b32 v139, 0
v_mfma_f32_32x32x16_bf16 v[56:71], a[236:239], v[124:127], v[56:71]
buffer_load_dwordx4 v22, s[8:11], s59 offen sc1 lds
v_mov_b32 v140, 0
v_mov_b32 v141, 0
v_mov_b32 v142, 0
v_mov_b32 v143, 0
s_waitcnt vmcnt(7)
ds_read_b128 v[112:115], v24 offset:40960
s_waitcnt lgkmcnt(4)
v_mfma_f32_32x32x16_bf16 v[40:55], a[240:243], v[128:131], v[40:55]
s_add_u32 m0, s29, 73728
s_add_u32 s59, s35, 25192448
s_add_u32 s60, s36, 8388608
buffer_load_short_d16_hi v136, v26, s[8:11], s60 offen sc1
s_add_u32 s60, s36, 8392704
buffer_load_short_d16_hi v137, v26, s[8:11], s60 offen sc1
v_mfma_f32_32x32x16_bf16 v[56:71], a[244:247], v[128:131], v[56:71]
buffer_load_dwordx4 v22, s[8:11], s59 offen sc1 lds
s_add_u32 s60, s36, 8396800
buffer_load_short_d16_hi v138, v26, s[8:11], s60 offen sc1
s_waitcnt vmcnt(10)
ds_read_b128 v[116:119], v24 offset:45056
s_waitcnt lgkmcnt(4)
v_mfma_f32_32x32x16_bf16 v[40:55], a[248:251], v[132:135], v[40:55]
s_add_u32 m0, s29, 77824
s_add_u32 s59, s35, 25193472
s_add_u32 s60, s36, 8400896
buffer_load_short_d16_hi v139, v26, s[8:11], s60 offen sc1
v_mfma_f32_32x32x16_bf16 v[56:71], a[252:255], v[132:135], v[56:71]
buffer_load_dwordx4 v22, s[8:11], s59 offen sc1 lds
s_add_u32 s60, s36, 8421376
buffer_load_short_d16_hi v140, v26, s[8:11], s60 offen sc1
s_add_u32 s60, s36, 8425472
buffer_load_short_d16_hi v141, v26, s[8:11], s60 offen sc1
s_waitcnt vmcnt(13)
ds_read_b128 v[120:123], v25 offset:0
s_waitcnt lgkmcnt(4)
v_mfma_f32_32x32x16_bf16 v[40:55], v[160:163], v[104:107], v[40:55]
s_add_u32 s60, s36, 8429568
buffer_load_short_d16_hi v142, v26, s[8:11], s60 offen sc1
v_mfma_f32_32x32x16_bf16 v[56:71], v[164:167], v[104:107], v[56:71]
s_add_u32 s60, s36, 8433664
buffer_load_short_d16_hi v143, v26, s[8:11], s60 offen sc1
s_waitcnt vmcnt(14)
ds_read_b128 v[124:127], v25 offset:4096
s_waitcnt lgkmcnt(4)
v_mfma_f32_32x32x16_bf16 v[40:55], v[168:171], v[108:111], v[40:55]
s_add_u32 s60, s38, 147456
buffer_load_dword v148, v23, s[8:11], s60 offen offset:4 sc1
v_and_b32 v152, 31, v1
v_lshrrev_b32 v153, 5, v1
v_mul_u32_u24 v28, 144, v152
v_mfma_f32_32x32x16_bf16 v[56:71], v[172:175], v[108:111], v[56:71]
v_lshl_add_u32 v28, v153, 3, v28
s_lshl_b32 s60, s28, 5
v_add_u32 v28, s60, v28
v_lshrrev_b32 v154, 3, v0
s_waitcnt vmcnt(14)
ds_read_b128 v[128:131], v25 offset:8192
s_waitcnt lgkmcnt(4)
v_mfma_f32_32x32x16_bf16 v[40:55], v[176:179], v[112:115], v[40:55]
v_and_b32 v155, 7, v0
v_mul_u32_u24 v27, 144, v154
v_lshl_add_u32 v27, v155, 4, v27
v_lshlrev_b32 v29, 10, v154
v_mfma_f32_32x32x16_bf16 v[56:71], v[180:183], v[112:115], v[56:71]
v_lshl_add_u32 v29, v155, 4, v29
v_add_u32 v149, s86, v22
v_add_u32 v150, s87, v22
v_add_u32 v151, s88, v22
s_waitcnt vmcnt(13)
ds_read_b128 v[132:135], v25 offset:12288
s_waitcnt lgkmcnt(4)
v_mfma_f32_32x32x16_bf16 v[40:55], v[184:187], v[116:119], v[40:55]
v_add_u32 v152, s89, v22
v_mfma_f32_32x32x16_bf16 v[56:71], v[188:191], v[116:119], v[56:71]
s_waitcnt vmcnt(12)
ds_read_b128 v[104:107], v25 offset:16384
s_waitcnt lgkmcnt(4)
v_mfma_f32_32x32x16_bf16 v[40:55], v[192:195], v[120:123], v[40:55]
v_mfma_f32_32x32x16_bf16 v[56:71], v[196:199], v[120:123], v[56:71]
s_waitcnt vmcnt(11)
ds_read_b128 v[108:111], v25 offset:20480
s_waitcnt lgkmcnt(4)
v_mfma_f32_32x32x16_bf16 v[40:55], v[200:203], v[124:127], v[40:55]
v_mfma_f32_32x32x16_bf16 v[56:71], v[204:207], v[124:127], v[56:71]
s_waitcnt vmcnt(8)
ds_read_b128 v[112:115], v25 offset:24576
s_waitcnt lgkmcnt(4)
v_mfma_f32_32x32x16_bf16 v[40:55], v[208:211], v[128:131], v[40:55]
v_mfma_f32_32x32x16_bf16 v[56:71], v[212:215], v[128:131], v[56:71]
s_waitcnt vmcnt(5)
ds_read_b128 v[116:119], v25 offset:28672
s_waitcnt lgkmcnt(4)
v_mfma_f32_32x32x16_bf16 v[40:55], v[216:219], v[132:135], v[40:55]
v_mfma_f32_32x32x16_bf16 v[56:71], v[220:223], v[132:135], v[56:71]
s_add_u32 s65, s40, 49152
buffer_load_dword v34, v4, s[8:11], s65 offen sc1
s_waitcnt lgkmcnt(3)
v_mfma_f32_32x32x16_bf16 v[56:71], v[228:231], v[104:107], v[56:71]
s_waitcnt lgkmcnt(2)
v_mfma_f32_32x32x16_bf16 v[56:71], v[236:239], v[108:111], v[56:71]
s_waitcnt lgkmcnt(1)
v_mfma_f32_32x32x16_bf16 v[56:71], v[244:247], v[112:115], v[56:71]
s_waitcnt lgkmcnt(0)
v_mfma_f32_32x32x16_bf16 v[56:71], v[252:255], v[116:119], v[56:71]
v_mfma_f32_32x32x16_bf16 v[40:55], v[224:227], v[104:107], v[40:55]
s_nop 4
v_mfma_f32_32x32x16_bf16 v[40:55], v[232:235], v[108:111], v[40:55]
s_nop 4
v_mfma_f32_32x32x16_bf16 v[40:55], v[240:243], v[112:115], v[40:55]
ds_write_b128 v149, v[56:59] offset:2048
v_mfma_f32_32x32x16_bf16 v[40:55], v[248:251], v[116:119], v[40:55]
ds_write_b128 v149, v[60:63] offset:3072
ds_write_b128 v149, v[64:67] offset:4096
ds_write_b128 v149, v[68:71] offset:5120
s_nop 8
ds_write_b128 v149, v[48:51] offset:0
ds_write_b128 v149, v[52:55] offset:1024
s_waitcnt vmcnt(1)
v_mul_f32 v148, v148, v148
s_waitcnt vmcnt(0)
v_cmp_gt_u32 vcc, s101, v34
s_cbranch_vccz Lsd_2080
s_mov_b32 s80, 0
Lsq_2081:
buffer_load_dword v34, v4, s[8:11], s65 offen sc1
s_add_u32 s80, s80, 1
s_cmp_lt_u32 s80, 0x8000
s_cbranch_scc0 Lsd_2080
s_waitcnt vmcnt(0)
v_cmp_gt_u32 vcc, s101, v34
s_nop 1
s_cbranch_vccnz Lsq_2081
Lsd_2080:
s_waitcnt lgkmcnt(0)
s_barrier
ds_read_b128 v[72:75], v150 offset:0
ds_read_b128 v[76:79], v150 offset:1024
ds_read_b128 v[80:83], v151 offset:0
ds_read_b128 v[84:87], v151 offset:1024
ds_read_b128 v[88:91], v152 offset:0
ds_read_b128 v[92:95], v152 offset:1024
s_add_u32 m0, s29, 81920
s_add_u32 s59, s35, 28835840
buffer_load_dwordx4 v22, s[8:11], s59 offen sc1 lds
s_add_u32 m0, s29, 86016
s_add_u32 s59, s35, 28836864
buffer_load_dwordx4 v22, s[8:11], s59 offen sc1 lds
s_add_u32 m0, s29, 90112
s_add_u32 s59, s35, 28837888
buffer_load_dwordx4 v22, s[8:11], s59 offen sc1 lds
s_waitcnt lgkmcnt(4)
v_pk_add_f32 v[40:41], v[40:41], v[72:73]
v_pk_add_f32 v[42:43], v[42:43], v[74:75]
v_pk_add_f32 v[44:45], v[44:45], v[76:77]
v_pk_add_f32 v[46:47], v[46:47], v[78:79]
s_waitcnt lgkmcnt(0)
v_pk_add_f32 v[80:81], v[80:81], v[88:89]
v_pk_add_f32 v[82:83], v[82:83], v[90:91]
v_pk_add_f32 v[84:85], v[84:85], v[92:93]
v_pk_add_f32 v[86:87], v[86:87], v[94:95]
v_pk_add_f32 v[40:41], v[40:41], v[80:81]
v_pk_add_f32 v[42:43], v[42:43], v[82:83]
v_pk_add_f32 v[44:45], v[44:45], v[84:85]
v_pk_add_f32 v[46:47], v[46:47], v[86:87]
v_fmac_f32 v136, v40, v148
v_fmac_f32 v137, v41, v148
v_fmac_f32 v138, v42, v148
v_fmac_f32 v139, v43, v148
v_fmac_f32 v140, v44, v148
v_fmac_f32 v141, v45, v148
v_fmac_f32 v142, v46, v148
v_fmac_f32 v143, v47, v148
v_cvt_pk_bf16_f32 v96, v136, v137
v_cvt_pk_bf16_f32 v97, v138, v139
v_cvt_pk_bf16_f32 v98, v140, v141
v_cvt_pk_bf16_f32 v99, v142, v143
ds_write_b64 v28, v[96:97] offset:57856
ds_write_b64 v28, v[98:99] offset:57872
s_waitcnt lgkmcnt(0)
s_barrier
ds_read_b128 v[100:103], v27 offset:57856
s_add_u32 s60, s42, 0
s_waitcnt lgkmcnt(0)
buffer_store_dwordx4 v[100:103], v29, s[12:15], s60 offen sc1
s_add_u32 m0, s29, 94208
s_add_u32 s59, s35, 28838912
buffer_load_dwordx4 v22, s[8:11], s59 offen sc1 lds
s_add_u32 m0, s29, 0
s_add_u32 s59, s35, 28839936
buffer_load_dwordx4 v22, s[8:11], s59 offen sc1 lds
s_add_u32 m0, s29, 4096
s_add_u32 s59, s35, 28840960
buffer_load_dwordx4 v22, s[8:11], s59 offen sc1 lds
s_add_u32 m0, s29, 8192
s_add_u32 s59, s35, 28841984
buffer_load_dwordx4 v22, s[8:11], s59 offen sc1 lds
s_add_u32 m0, s29, 12288
s_add_u32 s59, s35, 28843008
buffer_load_dwordx4 v22, s[8:11], s59 offen sc1 lds
s_add_u32 m0, s29, 16384
s_add_u32 s59, s35, 28844032
buffer_load_dwordx4 v22, s[8:11], s59 offen sc1 lds
s_add_u32 m0, s29, 20480
s_add_u32 s59, s35, 28845056
buffer_load_dwordx4 v22, s[8:11], s59 offen sc1 lds
s_add_u32 m0, s29, 24576
s_add_u32 s59, s35, 28846080
buffer_load_dwordx4 v22, s[8:11], s59 offen sc1 lds
s_add_u32 m0, s29, 28672
s_add_u32 s59, s35, 28847104
buffer_load_dwordx4 v22, s[8:11], s59 offen sc1 lds
s_add_u32 m0, s29, 32768
s_add_u32 s59, s35, 28848128
buffer_load_dwordx4 v22, s[8:11], s59 offen sc1 lds
s_waitcnt vmcnt(13)
ds_read_b128 v[104:107], v25 offset:32768
s_waitcnt vmcnt(12)
ds_read_b128 v[108:111], v25 offset:36864
s_waitcnt vmcnt(11)
ds_read_b128 v[112:115], v25 offset:40960
s_waitcnt vmcnt(9)
ds_read_b128 v[116:119], v25 offset:45056
s_waitcnt vmcnt(8)
ds_read_b128 v[120:123], v24 offset:0
s_waitcnt lgkmcnt(4)
v_mfma_f32_32x32x16_bf16 v[40:55], a[128:131], v[104:107], 0
s_add_u32 m0, s29, 36864
s_add_u32 s59, s35, 28849152
v_mfma_f32_32x32x16_bf16 v[56:71], a[132:135], v[104:107], 0
buffer_load_dwordx4 v22, s[8:11], s59 offen sc1 lds
s_waitcnt vmcnt(8)
ds_read_b128 v[124:127], v24 offset:4096
s_waitcnt lgkmcnt(4)
v_mfma_f32_32x32x16_bf16 v[40:55], a[136:139], v[108:111], v[40:55]
s_add_u32 m0, s29, 40960
s_add_u32 s59, s35, 28850176
v_mfma_f32_32x32x16_bf16 v[56:71], a[140:143], v[108:111], v[56:71]
buffer_load_dwordx4 v22, s[8:11], s59 offen sc1 lds
s_waitcnt vmcnt(8)
ds_read_b128 v[128:131], v24 offset:8192
s_waitcnt lgkmcnt(4)
v_mfma_f32_32x32x16_bf16 v[40:55], a[144:147], v[112:115], v[40:55]
s_add_u32 m0, s29, 45056
s_add_u32 s59, s35, 28851200
v_mfma_f32_32x32x16_bf16 v[56:71], a[148:151], v[112:115], v[56:71]
buffer_load_dwordx4 v22, s[8:11], s59 offen sc1 lds
s_waitcnt vmcnt(8)
ds_read_b128 v[132:135], v24 offset:12288
s_waitcnt lgkmcnt(4)
v_mfma_f32_32x32x16_bf16 v[40:55], a[152:155], v[116:119], v[40:55]
s_add_u32 m0, s29, 49152
s_add_u32 s59, s35, 28852224
v_mfma_f32_32x32x16_bf16 v[56:71], a[156:159], v[116:119], v[56:71]
buffer_load_dwordx4 v22, s[8:11], s59 offen sc1 lds
s_waitcnt vmcnt(8)
ds_read_b128 v[104:107], v24 offset:16384
s_waitcnt lgkmcnt(4)
v_mfma_f32_32x32x16_bf16 v[40:55], a[160:163], v[120:123], v[40:55]
s_add_u32 m0, s29, 53248
s_add_u32 s59, s35, 28853248
v_mfma_f32_32x32x16_bf16 v[56:71], a[164:167], v[120:123], v[56:71]
buffer_load_dwordx4 v22, s[8:11], s59 offen sc1 lds
s_waitcnt vmcnt(8)
ds_read_b128 v[108:111], v24 offset:20480
s_waitcnt lgkmcnt(4)
v_mfma_f32_32x32x16_bf16 v[40:55], a[168:171], v[124:127], v[40:55]
s_add_u32 m0, s29, 57344
s_add_u32 s59, s35, 28854272
v_mfma_f32_32x32x16_bf16 v[56:71], a[172:175], v[124:127], v[56:71]
buffer_load_dwordx4 v22, s[8:11], s59 offen sc1 lds
s_waitcnt vmcnt(8)
ds_read_b128 v[112:115], v24 offset:24576
s_waitcnt lgkmcnt(4)
v_mfma_f32_32x32x16_bf16 v[40:55], a[176:179], v[128:131], v[40:55]
s_add_u32 m0, s29, 61440
s_add_u32 s59, s35, 28855296
v_mfma_f32_32x32x16_bf16 v[56:71], a[180:183], v[128:131], v[56:71]
buffer_load_dwordx4 v22, s[8:11], s59 offen sc1 lds
s_waitcnt vmcnt(8)
ds_read_b128 v[116:119], v24 offset:28672
s_waitcnt lgkmcnt(4)
v_mfma_f32_32x32x16_bf16 v[40:55], a[184:187], v[132:135], v[40:55]
s_add_u32 m0, s29, 65536
s_add_u32 s59, s35, 28856320
v_mfma_f32_32x32x16_bf16 v[56:71], a[188:191], v[132:135], v[56:71]
buffer_load_dwordx4 v22, s[8:11], s59 offen sc1 lds
s_waitcnt vmcnt(8)
ds_read_b128 v[120:123], v24 offset:32768
s_waitcnt lgkmcnt(4)
v_mfma_f32_32x32x16_bf16 v[40:55], a[192:195], v[104:107], v[40:55]
s_add_u32 m0, s29, 69632
s_add_u32 s59, s35, 28857344
v_mfma_f32_32x32x16_bf16 v[56:71], a[196:199], v[104:107], v[56:71]
buffer_load_dwordx4 v22, s[8:11], s59 offen sc1 lds
s_waitcnt vmcnt(8)
ds_read_b128 v[124:127], v24 offset:36864
s_waitcnt lgkmcnt(4)
v_mfma_f32_32x32x16_bf16 v[40:55], a[200:203], v[108:111], v[40:55]
s_add_u32 m0, s29, 73728
s_add_u32 s59, s35, 28858368
v_mfma_f32_32x32x16_bf16 v[56:71], a[204:207], v[108:111], v[56:71]
buffer_load_dwordx4 v22, s[8:11], s59 offen sc1 lds
s_waitcnt vmcnt(8)
ds_read_b128 v[128:131], v24 offset:40960
s_waitcnt lgkmcnt(4)
v_mfma_f32_32x32x16_bf16 v[40:55], a[208:211], v[112:115], v[40:55]
s_add_u32 m0, s29, 77824
s_add_u32 s59, s35, 28859392
v_mfma_f32_32x32x16_bf16 v[56:71], a[212:215], v[112:115], v[56:71]
buffer_load_dwordx4 v22, s[8:11], s59 offen sc1 lds
s_waitcnt vmcnt(8)
ds_read_b128 v[132:135], v24 offset:45056
s_waitcnt lgkmcnt(4)
v_mfma_f32_32x32x16_bf16 v[40:55], a[216:219], v[116:119], v[40:55]
s_add_u32 m0, s29, 81920
s_add_u32 s59, s35, 28860416
v_mfma_f32_32x32x16_bf16 v[56:71], a[220:223], v[116:119], v[56:71]
buffer_load_dwordx4 v22, s[8:11], s59 offen sc1 lds
s_waitcnt vmcnt(8)
ds_read_b128 v[104:107], v25 offset:0
s_waitcnt lgkmcnt(4)
v_mfma_f32_32x32x16_bf16 v[40:55], a[224:227], v[120:123], v[40:55]
s_add_u32 m0, s29, 86016
s_add_u32 s59, s35, 28861440
v_mfma_f32_32x32x16_bf16 v[56:71], a[228:231], v[120:123], v[56:71]
buffer_load_dwordx4 v22, s[8:11], s59 offen sc1 lds
s_waitcnt vmcnt(8)
ds_read_b128 v[108:111], v25 offset:4096
s_waitcnt lgkmcnt(4)
v_mfma_f32_32x32x16_bf16 v[40:55], a[232:235], v[124:127], v[40:55]
s_add_u32 m0, s29, 90112
s_add_u32 s59, s35, 28862464
v_mov_b32 v136, 0
v_mov_b32 v137, 0
v_mov_b32 v138, 0
v_mov_b32 v139, 0
v_mfma_f32_32x32x16_bf16 v[56:71], a[236:239], v[124:127], v[56:71]
buffer_load_dwordx4 v22, s[8:11], s59 offen sc1 lds
v_mov_b32 v140, 0
v_mov_b32 v141, 0
v_mov_b32 v142, 0
v_mov_b32 v143, 0
s_waitcnt vmcnt(8)
ds_read_b128 v[112:115], v25 offset:8192
s_waitcnt lgkmcnt(4)
v_mfma_f32_32x32x16_bf16 v[40:55], a[240:243], v[128:131], v[40:55]
s_add_u32 m0, s29, 94208
s_add_u32 s59, s35, 28863488
s_add_u32 s60, s36, 8390656
buffer_load_short_d16_hi v136, v26, s[8:11], s60 offen sc1
s_add_u32 s60, s36, 8394752
buffer_load_short_d16_hi v137, v26, s[8:11], s60 offen sc1
v_mfma_f32_32x32x16_bf16 v[56:71], a[244:247], v[128:131], v[56:71]
buffer_load_dwordx4 v22, s[8:11], s59 offen sc1 lds
s_add_u32 s60, s36, 8398848
buffer_load_short_d16_hi v138, v26, s[8:11], s60 offen sc1
s_waitcnt vmcnt(11)
ds_read_b128 v[116:119], v25 offset:12288
s_waitcnt lgkmcnt(4)
v_mfma_f32_32x32x16_bf16 v[40:55], a[248:251], v[132:135], v[40:55]
s_add_u32 s60, s36, 8402944
buffer_load_short_d16_hi v139, v26, s[8:11], s60 offen sc1
v_mfma_f32_32x32x16_bf16 v[56:71], a[252:255], v[132:135], v[56:71]
s_add_u32 s60, s36, 8423424
buffer_load_short_d16_hi v140, v26, s[8:11], s60 offen sc1
s_add_u32 s60, s36, 8427520
buffer_load_short_d16_hi v141, v26, s[8:11], s60 offen sc1
s_waitcnt vmcnt(13)
ds_read_b128 v[120:123], v25 offset:16384
s_waitcnt lgkmcnt(4)
v_mfma_f32_32x32x16_bf16 v[40:55], v[160:163], v[104:107], v[40:55]
s_add_u32 s60, s36, 8431616
buffer_load_short_d16_hi v142, v26, s[8:11], s60 offen sc1
v_mfma_f32_32x32x16_bf16 v[56:71], v[164:167], v[104:107], v[56:71]
s_add_u32 s60, s36, 8435712
buffer_load_short_d16_hi v143, v26, s[8:11], s60 offen sc1
s_waitcnt vmcnt(14)
ds_read_b128 v[124:127], v25 offset:20480
s_waitcnt lgkmcnt(4)
v_mfma_f32_32x32x16_bf16 v[40:55], v[168:171], v[108:111], v[40:55]
s_add_u32 s60, s38, 155648
buffer_load_dword v148, v23, s[8:11], s60 offen offset:4 sc1
v_add_u32 v149, s86, v22
v_add_u32 v150, s87, v22
v_add_u32 v151, s88, v22
v_mfma_f32_32x32x16_bf16 v[56:71], v[172:175], v[108:111], v[56:71]
v_add_u32 v152, s89, v22
s_waitcnt vmcnt(14)
ds_read_b128 v[128:131], v25 offset:24576
s_waitcnt lgkmcnt(4)
v_mfma_f32_32x32x16_bf16 v[40:55], v[176:179], v[112:115], v[40:55]
v_mfma_f32_32x32x16_bf16 v[56:71], v[180:183], v[112:115], v[56:71]
s_waitcnt vmcnt(13)
ds_read_b128 v[132:135], v25 offset:28672
s_waitcnt lgkmcnt(4)
v_mfma_f32_32x32x16_bf16 v[40:55], v[184:187], v[116:119], v[40:55]
v_mfma_f32_32x32x16_bf16 v[56:71], v[188:191], v[116:119], v[56:71]
s_waitcnt vmcnt(12)
ds_read_b128 v[104:107], v25 offset:32768
s_waitcnt lgkmcnt(4)
v_mfma_f32_32x32x16_bf16 v[40:55], v[192:195], v[120:123], v[40:55]
v_mfma_f32_32x32x16_bf16 v[56:71], v[196:199], v[120:123], v[56:71]
s_waitcnt vmcnt(11)
ds_read_b128 v[108:111], v25 offset:36864
s_waitcnt lgkmcnt(4)
v_mfma_f32_32x32x16_bf16 v[40:55], v[200:203], v[124:127], v[40:55]
v_mfma_f32_32x32x16_bf16 v[56:71], v[204:207], v[124:127], v[56:71]
s_waitcnt vmcnt(10)
ds_read_b128 v[112:115], v25 offset:40960
s_waitcnt lgkmcnt(4)
v_mfma_f32_32x32x16_bf16 v[40:55], v[208:211], v[128:131], v[40:55]
v_mfma_f32_32x32x16_bf16 v[56:71], v[212:215], v[128:131], v[56:71]
s_waitcnt vmcnt(7)
ds_read_b128 v[116:119], v25 offset:45056
s_waitcnt lgkmcnt(4)
v_mfma_f32_32x32x16_bf16 v[40:55], v[216:219], v[132:135], v[40:55]
v_mfma_f32_32x32x16_bf16 v[56:71], v[220:223], v[132:135], v[56:71]
s_waitcnt lgkmcnt(3)
v_mfma_f32_32x32x16_bf16 v[56:71], v[228:231], v[104:107], v[56:71]
s_waitcnt lgkmcnt(2)
v_mfma_f32_32x32x16_bf16 v[56:71], v[236:239], v[108:111], v[56:71]
s_waitcnt lgkmcnt(1)
v_mfma_f32_32x32x16_bf16 v[56:71], v[244:247], v[112:115], v[56:71]
s_waitcnt lgkmcnt(0)
v_mfma_f32_32x32x16_bf16 v[56:71], v[252:255], v[116:119], v[56:71]
v_mfma_f32_32x32x16_bf16 v[40:55], v[224:227], v[104:107], v[40:55]
s_nop 4
v_mfma_f32_32x32x16_bf16 v[40:55], v[232:235], v[108:111], v[40:55]
s_nop 4
v_mfma_f32_32x32x16_bf16 v[40:55], v[240:243], v[112:115], v[40:55]
ds_write_b128 v149, v[56:59] offset:2048
v_mfma_f32_32x32x16_bf16 v[40:55], v[248:251], v[116:119], v[40:55]
ds_write_b128 v149, v[60:63] offset:3072
ds_write_b128 v149, v[64:67] offset:4096
ds_write_b128 v149, v[68:71] offset:5120
s_nop 8
ds_write_b128 v149, v[48:51] offset:0
ds_write_b128 v149, v[52:55] offset:1024
s_waitcnt vmcnt(0)
v_mul_f32 v148, v148, v148
s_waitcnt lgkmcnt(0)
s_barrier
ds_read_b128 v[72:75], v150 offset:0
ds_read_b128 v[76:79], v150 offset:1024
ds_read_b128 v[80:83], v151 offset:0
ds_read_b128 v[84:87], v151 offset:1024
ds_read_b128 v[88:91], v152 offset:0
ds_read_b128 v[92:95], v152 offset:1024
s_waitcnt lgkmcnt(4)
v_pk_add_f32 v[40:41], v[40:41], v[72:73]
v_pk_add_f32 v[42:43], v[42:43], v[74:75]
v_pk_add_f32 v[44:45], v[44:45], v[76:77]
v_pk_add_f32 v[46:47], v[46:47], v[78:79]
s_waitcnt lgkmcnt(0)
v_pk_add_f32 v[80:81], v[80:81], v[88:89]
v_pk_add_f32 v[82:83], v[82:83], v[90:91]
v_pk_add_f32 v[84:85], v[84:85], v[92:93]
v_pk_add_f32 v[86:87], v[86:87], v[94:95]
v_pk_add_f32 v[40:41], v[40:41], v[80:81]
v_pk_add_f32 v[42:43], v[42:43], v[82:83]
v_pk_add_f32 v[44:45], v[44:45], v[84:85]
v_pk_add_f32 v[46:47], v[46:47], v[86:87]
v_fmac_f32 v136, v40, v148
v_fmac_f32 v137, v41, v148
v_fmac_f32 v138, v42, v148
v_fmac_f32 v139, v43, v148
v_fmac_f32 v140, v44, v148
v_fmac_f32 v141, v45, v148
v_fmac_f32 v142, v46, v148
v_fmac_f32 v143, v47, v148
v_cvt_pk_bf16_f32 v96, v136, v137
v_cvt_pk_bf16_f32 v97, v138, v139
v_cvt_pk_bf16_f32 v98, v140, v141
v_cvt_pk_bf16_f32 v99, v142, v143
ds_write_b64 v28, v[96:97] offset:57856
ds_write_b64 v28, v[98:99] offset:57872
s_waitcnt lgkmcnt(0)
s_barrier
ds_read_b128 v[100:103], v27 offset:57856
s_add_u32 s60, s42, 1048576
s_waitcnt lgkmcnt(0)
buffer_store_dwordx4 v[100:103], v29, s[12:15], s60 offen sc1
Lfin:
Lend:
s_endpgm
Lsp_4:
s_mov_b32 s80, 0
Lsq_6:
buffer_load_dword v34, v68, s[16:19], 0 offen sc1
s_waitcnt vmcnt(0)
v_cmp_gt_u32 vcc, 1, v34
s_nop 1
s_cbranch_vccz Lsd_5
s_add_u32 s80, s80, 1
s_cmp_lt_u32 s80, 0x8000
s_cbranch_scc1 Lsq_6
v_mov_b32 v34, 9
v_mov_b32 v38, 4
buffer_store_dword v34, v38, s[16:19], 0 offen
s_waitcnt vmcnt(0)
s_branch Lsd_5
Llg_25:
s_mov_b32 s80, 0
Llq_27:
buffer_load_dwordx2 v[136:137], v23, s[8:11], s66 offen offset:0 sc1
buffer_load_dwordx2 v[138:139], v23, s[8:11], s66 offen offset:256 sc1
buffer_load_dwordx2 v[140:141], v23, s[8:11], s66 offen offset:512 sc1
buffer_load_dwordx2 v[142:143], v23, s[8:11], s66 offen offset:768 sc1
s_waitcnt vmcnt(0)
v_and_b32 v152, v136, v138
v_and_b32 v153, v140, v142
v_and_b32 v152, v152, v153
v_and_b32 v152, 1, v152
v_cmp_eq_u32 vcc, 0, v152
s_nop 1
s_cbranch_vccz Llgd_26
s_add_u32 s80, s80, 1
s_cmp_lt_u32 s80, 0x8000
s_cbranch_scc1 Llq_27
s_branch Llgd_26
Llg_28:
s_mov_b32 s80, 0
Llq_30:
buffer_load_dwordx2 v[136:137], v23, s[8:11], s66 offen offset:0 sc1
buffer_load_dwordx2 v[138:139], v23, s[8:11], s66 offen offset:256 sc1
buffer_load_dwordx2 v[140:141], v23, s[8:11], s66 offen offset:512 sc1
buffer_load_dwordx2 v[142:143], v23, s[8:11], s66 offen offset:768 sc1
s_waitcnt vmcnt(0)
v_and_b32 v152, v136, v138
v_and_b32 v153, v140, v142
v_and_b32 v152, v152, v153
v_and_b32 v152, 1, v152
v_cmp_eq_u32 vcc, 0, v152
s_nop 1
s_cbranch_vccz Llgd_29
s_add_u32 s80, s80, 1
s_cmp_lt_u32 s80, 0x8000
s_cbranch_scc1 Llq_30
s_branch Llgd_29
Lsp_1035:
s_mov_b32 s80, 0
Lsq_1037:
buffer_load_dword v34, v2, s[8:11], s64 offen sc1
s_waitcnt vmcnt(0)
v_cmp_gt_u32 vcc, s57, v34
s_nop 1
s_cbranch_vccz Lsd_1036
s_add_u32 s80, s80, 1
s_cmp_lt_u32 s80, 0x8000
s_cbranch_scc1 Lsq_1037
v_mov_b32 v34, 30
v_mov_b32 v38, 4
buffer_store_dword v34, v38, s[16:19], 0 offen
s_waitcnt vmcnt(0)
s_branch Lsd_1036
Lsp_1039:
s_mov_b32 s80, 0
Lsq_1041:
buffer_load_dword v34, v4, s[8:11], s65 offen sc1
s_waitcnt vmcnt(0)
v_cmp_gt_u32 vcc, s101, v34
s_nop 1
s_cbranch_vccz Lsd_1040
s_add_u32 s80, s80, 1
s_cmp_lt_u32 s80, 0x8000
s_cbranch_scc1 Lsq_1041
v_mov_b32 v34, 32
v_mov_b32 v38, 4
buffer_store_dword v34, v38, s[16:19], 0 offen
s_waitcnt vmcnt(0)
s_branch Lsd_1040
Llg_1061:
s_mov_b32 s80, 0
Llq_1063:
buffer_load_dwordx2 v[136:137], v23, s[8:11], s66 offen offset:0 sc1
buffer_load_dwordx2 v[138:139], v23, s[8:11], s66 offen offset:256 sc1
buffer_load_dwordx2 v[140:141], v23, s[8:11], s66 offen offset:512 sc1
buffer_load_dwordx2 v[142:143], v23, s[8:11], s66 offen offset:768 sc1
s_waitcnt vmcnt(0)
v_and_b32 v152, v136, v138
v_and_b32 v153, v140, v142
v_and_b32 v152, v152, v153
v_and_b32 v152, 1, v152
v_cmp_eq_u32 vcc, 0, v152
s_nop 1
s_cbranch_vccz Llgd_1062
s_add_u32 s80, s80, 1
s_cmp_lt_u32 s80, 0x8000
s_cbranch_scc1 Llq_1063
s_branch Llgd_1062
Llg_1064:
s_mov_b32 s80, 0
Llq_1066:
buffer_load_dwordx2 v[136:137], v23, s[8:11], s66 offen offset:0 sc1
buffer_load_dwordx2 v[138:139], v23, s[8:11], s66 offen offset:256 sc1
buffer_load_dwordx2 v[140:141], v23, s[8:11], s66 offen offset:512 sc1
buffer_load_dwordx2 v[142:143], v23, s[8:11], s66 offen offset:768 sc1
s_waitcnt vmcnt(0)
v_and_b32 v152, v136, v138
v_and_b32 v153, v140, v142
v_and_b32 v152, v152, v153
v_and_b32 v152, 1, v152
v_cmp_eq_u32 vcc, 0, v152
s_nop 1
s_cbranch_vccz Llgd_1065
s_add_u32 s80, s80, 1
s_cmp_lt_u32 s80, 0x8000
s_cbranch_scc1 Llq_1066
s_branch Llgd_1065
Lsp_2071:
s_mov_b32 s80, 0
Lsq_2073:
buffer_load_dword v34, v2, s[8:11], s64 offen sc1
s_waitcnt vmcnt(0)
v_cmp_gt_u32 vcc, s57, v34
s_nop 1
s_cbranch_vccz Lsd_2072
s_add_u32 s80, s80, 1
s_cmp_lt_u32 s80, 0x8000
s_cbranch_scc1 Lsq_2073
v_mov_b32 v34, 31
v_mov_b32 v38, 4
buffer_store_dword v34, v38, s[16:19], 0 offen
s_waitcnt vmcnt(0)
s_branch Lsd_2072
Lsp_2075:
s_mov_b32 s80, 0
Lsq_2077:
buffer_load_dword v34, v4, s[8:11], s65 offen sc1
s_waitcnt vmcnt(0)
v_cmp_gt_u32 vcc, s101, v34
s_nop 1
s_cbranch_vccz Lsd_2076
s_add_u32 s80, s80, 1
s_cmp_lt_u32 s80, 0x8000
s_cbranch_scc1 Lsq_2077
v_mov_b32 v34, 33
v_mov_b32 v38, 4
buffer_store_dword v34, v38, s[16:19], 0 offen
s_waitcnt vmcnt(0)
s_branch Lsd_2076
Lcode_end:
.section .rodata,"a"
.p2align 6
.amdhsa_kernel interleave_layers__ssm_conv_s4d__glu_gated_reglu__prompt_kernel
  .amdhsa_next_free_vgpr 512
  .amdhsa_next_free_sgpr 102
  .amdhsa_accum_offset 256
  .amdhsa_group_segment_fixed_size 0
  .amdhsa_kernarg_size 112
  .amdhsa_user_sgpr_count 2
  .amdhsa_user_sgpr_kernarg_segment_ptr 1
  .amdhsa_system_sgpr_workgroup_id_x 1
  .amdhsa_float_denorm_mode_32 3
.end_amdhsa_kernel
```
